```python
import torch

def _softmax(x, axis=-1):
    return torch.softmax(x, dim=axis)
def _gelu(x):
    return torch.nn.functional.gelu(x, approximate="tanh")
def _silu(x):
    return torch.nn.functional.silu(x)
def _sigmoid(x):
    return torch.sigmoid(x)
def _layernorm(x, axis=-1, eps=1e-5):
    m = x.mean(dim=axis, keepdim=True)
    v = x.var(dim=axis, keepdim=True, unbiased=False)
    return (x - m) / torch.sqrt(v + eps)
def _scatter_add(tgt, idx, src, axis=0):
    return tgt.clone().index_add_(axis, idx, src)
def _segment_sum(src, seg, n):
    out = torch.zeros((n,) + src.shape[1:], dtype=src.dtype)
    return out.index_add_(0, seg, src)
def _pad(x, pw):
    flat = tuple(v for pair in reversed(pw) for v in pair)
    return torch.nn.functional.pad(x, flat)

kernel_name = 'recurrent_scan__grouped_kv_mqa__dense_activation_squared_relu__prompt'

def setup_inputs():

    _w = (lambda a: (lambda t: t.to(torch.bfloat16) if t.is_floating_point() else t)(torch.as_tensor(a)))
    def _A_setup():
        B, S, D, H = 1, 2048, 1024, 32
        Dh = D // H
        return {
            "x": _w((lambda *s: torch.randn(*s, dtype=torch.bfloat16) * 0.05)(B, S, D)),
            "wq": _w((lambda *s: torch.randn(*s, dtype=torch.bfloat16) * 0.05)(D, H * Dh)),
            "wk": _w((lambda *s: torch.randn(*s, dtype=torch.bfloat16) * 0.05)(D, Dh)),
            "wv": _w((lambda *s: torch.randn(*s, dtype=torch.bfloat16) * 0.05)(D, Dh)),
            "wo": _w((lambda *s: torch.randn(*s, dtype=torch.bfloat16) * 0.05)(H * Dh, D)),
        }
    _A_in = _A_setup()

    def _B_setup():
        B, S, D, F = 1, 2048, 1024, 3584
        return {
            "x": _w((lambda *s: torch.randn(*s, dtype=torch.bfloat16) * 0.05)(B, S, D)),
            "w1": _w((lambda *s: torch.randn(*s, dtype=torch.bfloat16) * 0.05)(D, F)),
            "b1": _w((lambda *s: torch.randn(*s, dtype=torch.bfloat16) * 0.8)(F)),
            "w2": _w((lambda *s: torch.randn(*s, dtype=torch.bfloat16) * 0.05)(F, D)),
            "b2": _w((lambda *s: torch.randn(*s, dtype=torch.bfloat16) * 6.4)(D)),
        }
    _B_in = _B_setup()

    return {
        "A_x": _A_in["x"],
        "A_wq": _A_in["wq"],
        "A_wk": _A_in["wk"],
        "A_wv": _A_in["wv"],
        "A_wo": _A_in["wo"],
        "B_x": _B_in["x"],
        "B_w1": _B_in["w1"],
        "B_b1": _B_in["b1"],
        "B_w2": _B_in["w2"],
        "B_b2": _B_in["b2"],
    }

def reference(A_x, A_wq, A_wk, A_wv, A_wo, B_x, B_w1, B_b1, B_w2, B_b2):
    def _A_ref(x, wq, wk, wv, wo):
        B, S, D = x.shape
        H = 32
        Dh = D // H
        q = (lambda x, *d: x.permute(*d))((x @ wq).reshape(B, S, H, Dh), 0, 2, 1, 3)
        k = x @ wk
        v = x @ wv
        scores = torch.einsum("bhqd,bkd->bhqk", q, k) * (Dh ** -0.5)
        p = _softmax(scores, axis=-1)
        o = torch.einsum("bhqk,bkd->bhqd", p, v)
        return (lambda x, *d: x.permute(*d))(o, 0, 2, 1, 3).reshape(B, S, H * Dh) @ wo

    def _B_ref(x, w1, b1, w2, b2):
        h = torch.einsum("bsd,df->bsf", x, w1) + b1
        zero = torch.zeros_like(h)
        r = torch.where(h > zero, h, zero)
        h = r * r
        out = torch.einsum("bsf,fd->bsd", h, w2) + b2
        return out

    x = A_x
    xn = _layernorm(x, axis=-1)
    s = _A_ref(xn, A_wq, A_wk, A_wv, A_wo)
    g = _silu(_B_ref(xn, B_w1, B_b1, B_w2, B_b2))
    return x + s * g
```

```asm
; @launch kernel=ln_kernel grid=(256,1,1) block=(256,1,1) lds=1024
; @launch kernel=mega_kernel grid=(256,1,1) block=(512,1,1) lds=163840
.amdgcn_target "amdgcn-amd-amdhsa--gfx950"
.text
.globl ln_kernel
.p2align 8
.type ln_kernel,@function
ln_kernel:
    s_cmp_ge_u32 s2, 256
    s_cbranch_scc1 LN_done
    s_load_dwordx2 s[4:5], s[0:1], 0
    s_load_dwordx2 s[6:7], s[0:1], 96
    s_load_dwordx4 s[24:27], s[0:1], 16
    v_and_b32 v1, 63, v0
    v_lshrrev_b32 v2, 6, v0
    v_and_b32 v3, 7, v1
    v_lshrrev_b32 v4, 3, v1
    s_waitcnt lgkmcnt(0)
    s_mov_b32 s8, s4
    s_and_b32 s9, s5, 0xffff
    s_mov_b32 s10, 4194304
    s_mov_b32 s11, 0x00020000
    s_mov_b32 s12, s6
    s_and_b32 s13, s7, 0xffff
    s_mov_b32 s14, 268435456
    s_mov_b32 s15, 0x00020000
    s_mov_b32 s16, s24
    s_and_b32 s17, s25, 0xffff
    s_mov_b32 s18, 65536
    s_mov_b32 s19, 0x00020000
    s_mov_b32 s20, s26
    s_and_b32 s21, s27, 0xffff
    s_mov_b32 s22, 65536
    s_mov_b32 s23, 0x00020000
    s_lshl_b32 s3, s2, 14
    v_lshlrev_b32 v5, 11, v3
    v_lshlrev_b32 v6, 9, v2
    v_lshlrev_b32 v7, 6, v4
    v_add3_u32 v5, v5, v6, v7
    buffer_load_dwordx4 v[16:19], v5, s[8:11], s3 offen
    buffer_load_dwordx4 v[20:23], v5, s[8:11], s3 offen offset:16
    buffer_load_dwordx4 v[24:27], v5, s[8:11], s3 offen offset:32
    buffer_load_dwordx4 v[28:31], v5, s[8:11], s3 offen offset:48
    v_and_b32 v8, 15, v0
    v_lshlrev_b32 v8, 4, v8
    s_lshl_b32 s28, s2, 8
    v_cmp_gt_u32 vcc, 16, v0
    s_nop 0
    s_and_saveexec_b64 s[30:31], vcc
    s_cbranch_execz LN_nok
    buffer_load_dwordx4 v[32:35], v8, s[16:19], s28 offen
LN_nok:
    s_mov_b64 exec, s[30:31]
    v_subrev_u32 v9, 16, v0
    v_cmp_gt_u32 vcc, 16, v9
    s_nop 0
    s_and_saveexec_b64 s[30:31], vcc
    s_cbranch_execz LN_nov
    buffer_load_dwordx4 v[32:35], v8, s[20:23], s28 offen
LN_nov:
    s_mov_b64 exec, s[30:31]
    v_bfe_u32 v9, v0, 2, 2
    v_lshlrev_b32 v9, 7, v9
    v_bfe_u32 v10, v0, 4, 1
    v_lshlrev_b32 v10, 6, v10
    v_and_b32 v11, 3, v0
    v_lshlrev_b32 v11, 4, v11
    v_add3_u32 v9, v9, v10, v11
    s_lshl_b32 s28, s2, 9
    s_add_u32 s28, s28, 9437184
    v_mov_b32 v12, 0x3f803f80
    v_mov_b32 v14, 0
    v_mov_b32 v15, 0
    s_lshl_b32 s29, s2, 8
    s_add_u32 s29, s29, 10485760
    v_lshlrev_b32 v36, 2, v0
    v_cmp_gt_u32 vcc, 64, v0
    s_nop 0
    s_and_saveexec_b64 s[30:31], vcc
    s_cbranch_execz LN_nofl
    buffer_store_dword v14, v36, s[12:15], s29 offen
LN_nofl:
    s_mov_b64 exec, s[30:31]
    s_load_dwordx2 s[32:33], s[0:1], 48
    s_load_dwordx2 s[36:37], s[0:1], 8
    s_lshl_b32 s40, s2, 15
    v_lshlrev_b32 v38, 7, v0
    v_add_u32 v38, s40, v38
    s_waitcnt lgkmcnt(0)
    s_and_b32 s33, s33, 0xffff
    s_mov_b32 s34, 7340032
    s_mov_b32 s35, 0x00020000
    s_mov_b32 s40, 0
    buffer_load_dword v39, v38, s[32:35], s40 offen
    s_and_b32 s37, s37, 0xffff
    s_mov_b32 s38, 2097152
    s_mov_b32 s39, 0x00020000
    s_mov_b32 s40, 0
    buffer_load_dword v39, v38, s[36:39], s40 offen
    s_min_u32 s29, s2, 4096
    s_getpc_b64 s[32:33]
LN_pc:
    s_add_u32 s32, s32, mega_kernel-LN_pc
    s_addc_u32 s33, s33, 0
    s_and_b32 s33, s33, 0xffff
    s_mov_b32 s34, MG_end-mega_kernel
    s_mov_b32 s35, 0x00020000
    v_and_b32 v38, 63, v0
    v_lshlrev_b32 v38, 7, v38
    s_lshl_b32 s36, s29, 13
    buffer_load_dword v39, v38, s[32:35], s36 offen
    s_waitcnt vmcnt(3)
    v_cmp_gt_u32 vcc, 32, v0
    s_nop 0
    s_and_saveexec_b64 s[30:31], vcc
    s_cbranch_execz LN_nost
    buffer_store_dwordx4 v[32:35], v9, s[12:15], s28 offen
LN_nost:
    s_mov_b64 exec, s[30:31]
    v_dot2_f32_bf16 v14, v16, v12, v14
    v_dot2_f32_bf16 v15, v16, v16, v15
    v_dot2_f32_bf16 v14, v17, v12, v14
    v_dot2_f32_bf16 v15, v17, v17, v15
    v_dot2_f32_bf16 v14, v18, v12, v14
    v_dot2_f32_bf16 v15, v18, v18, v15
    v_dot2_f32_bf16 v14, v19, v12, v14
    v_dot2_f32_bf16 v15, v19, v19, v15
    v_dot2_f32_bf16 v14, v20, v12, v14
    v_dot2_f32_bf16 v15, v20, v20, v15
    v_dot2_f32_bf16 v14, v21, v12, v14
    v_dot2_f32_bf16 v15, v21, v21, v15
    v_dot2_f32_bf16 v14, v22, v12, v14
    v_dot2_f32_bf16 v15, v22, v22, v15
    v_dot2_f32_bf16 v14, v23, v12, v14
    v_dot2_f32_bf16 v15, v23, v23, v15
    v_dot2_f32_bf16 v14, v24, v12, v14
    v_dot2_f32_bf16 v15, v24, v24, v15
    v_dot2_f32_bf16 v14, v25, v12, v14
    v_dot2_f32_bf16 v15, v25, v25, v15
    v_dot2_f32_bf16 v14, v26, v12, v14
    v_dot2_f32_bf16 v15, v26, v26, v15
    v_dot2_f32_bf16 v14, v27, v12, v14
    v_dot2_f32_bf16 v15, v27, v27, v15
    v_dot2_f32_bf16 v14, v28, v12, v14
    v_dot2_f32_bf16 v15, v28, v28, v15
    v_dot2_f32_bf16 v14, v29, v12, v14
    v_dot2_f32_bf16 v15, v29, v29, v15
    v_dot2_f32_bf16 v14, v30, v12, v14
    v_dot2_f32_bf16 v15, v30, v30, v15
    v_dot2_f32_bf16 v14, v31, v12, v14
    v_dot2_f32_bf16 v15, v31, v31, v15
    s_nop 1
    v_add_f32_dpp v14, v14, v14 row_ror:8 row_mask:0xf bank_mask:0xf
    v_add_f32_dpp v15, v15, v15 row_ror:8 row_mask:0xf bank_mask:0xf
    v_mov_b32 v64, v14
    v_mov_b32 v65, v15
    s_nop 0
    v_permlane16_swap_b32 v64, v14
    v_permlane16_swap_b32 v65, v15
    v_add_f32 v14, v14, v64
    v_add_f32 v15, v15, v65
    v_mov_b32 v64, v14
    v_mov_b32 v65, v15
    s_nop 0
    v_permlane32_swap_b32 v64, v14
    v_permlane32_swap_b32 v65, v15
    v_add_f32 v14, v14, v64
    v_add_f32 v15, v15, v65
    v_lshlrev_b32 v36, 5, v3
    v_lshl_add_u32 v37, v2, 3, v36
    ds_write_b64 v37, v[14:15]
    s_waitcnt lgkmcnt(0)
    s_barrier
    ds_read_b128 v[40:43], v36
    ds_read_b128 v[44:47], v36 offset:16
    s_waitcnt lgkmcnt(0)
    v_add_f32 v40, v40, v42
    v_add_f32 v41, v41, v43
    v_add_f32 v44, v44, v46
    v_add_f32 v45, v45, v47
    v_add_f32 v40, v40, v44
    v_add_f32 v41, v41, v45
    v_mul_f32 v40, 0x3a800000, v40
    v_mul_f32 v41, 0x3a800000, v41
    v_fma_f32 v41, -v40, v40, v41
    v_max_f32 v41, 0, v41
    v_cvt_pk_bf16_f32 v42, v40, v41
    v_lshlrev_b32 v40, 16, v42
    v_and_b32 v41, 0xffff0000, v42
    v_add_f32 v41, 0x3727c5ac, v41
    v_cvt_pk_bf16_f32 v41, v41, v41
    v_lshlrev_b32 v41, 16, v41
    v_sqrt_f32 v41, v41
    s_nop 0
    v_cvt_pk_bf16_f32 v41, v41, v41
    v_lshlrev_b32 v41, 16, v41
    v_rcp_f32 v41, v41
    v_lshlrev_b32 v42, 16, v16
    v_and_b32 v43, 0xffff0000, v16
    v_sub_f32 v42, v42, v40
    v_sub_f32 v43, v43, v40
    v_cvt_pk_bf16_f32 v44, v42, v43
    v_lshlrev_b32 v42, 16, v44
    v_and_b32 v43, 0xffff0000, v44
    v_mul_f32 v42, v42, v41
    v_mul_f32 v43, v43, v41
    v_cvt_pk_bf16_f32 v48, v42, v43
    v_lshlrev_b32 v42, 16, v17
    v_and_b32 v43, 0xffff0000, v17
    v_sub_f32 v42, v42, v40
    v_sub_f32 v43, v43, v40
    v_cvt_pk_bf16_f32 v44, v42, v43
    v_lshlrev_b32 v42, 16, v44
    v_and_b32 v43, 0xffff0000, v44
    v_mul_f32 v42, v42, v41
    v_mul_f32 v43, v43, v41
    v_cvt_pk_bf16_f32 v49, v42, v43
    v_lshlrev_b32 v42, 16, v24
    v_and_b32 v43, 0xffff0000, v24
    v_sub_f32 v42, v42, v40
    v_sub_f32 v43, v43, v40
    v_cvt_pk_bf16_f32 v44, v42, v43
    v_lshlrev_b32 v42, 16, v44
    v_and_b32 v43, 0xffff0000, v44
    v_mul_f32 v42, v42, v41
    v_mul_f32 v43, v43, v41
    v_cvt_pk_bf16_f32 v50, v42, v43
    v_lshlrev_b32 v42, 16, v25
    v_and_b32 v43, 0xffff0000, v25
    v_sub_f32 v42, v42, v40
    v_sub_f32 v43, v43, v40
    v_cvt_pk_bf16_f32 v44, v42, v43
    v_lshlrev_b32 v42, 16, v44
    v_and_b32 v43, 0xffff0000, v44
    v_mul_f32 v42, v42, v41
    v_mul_f32 v43, v43, v41
    v_cvt_pk_bf16_f32 v51, v42, v43
    v_lshlrev_b32 v42, 16, v18
    v_and_b32 v43, 0xffff0000, v18
    v_sub_f32 v42, v42, v40
    v_sub_f32 v43, v43, v40
    v_cvt_pk_bf16_f32 v44, v42, v43
    v_lshlrev_b32 v42, 16, v44
    v_and_b32 v43, 0xffff0000, v44
    v_mul_f32 v42, v42, v41
    v_mul_f32 v43, v43, v41
    v_cvt_pk_bf16_f32 v52, v42, v43
    v_lshlrev_b32 v42, 16, v19
    v_and_b32 v43, 0xffff0000, v19
    v_sub_f32 v42, v42, v40
    v_sub_f32 v43, v43, v40
    v_cvt_pk_bf16_f32 v44, v42, v43
    v_lshlrev_b32 v42, 16, v44
    v_and_b32 v43, 0xffff0000, v44
    v_mul_f32 v42, v42, v41
    v_mul_f32 v43, v43, v41
    v_cvt_pk_bf16_f32 v53, v42, v43
    v_lshlrev_b32 v42, 16, v26
    v_and_b32 v43, 0xffff0000, v26
    v_sub_f32 v42, v42, v40
    v_sub_f32 v43, v43, v40
    v_cvt_pk_bf16_f32 v44, v42, v43
    v_lshlrev_b32 v42, 16, v44
    v_and_b32 v43, 0xffff0000, v44
    v_mul_f32 v42, v42, v41
    v_mul_f32 v43, v43, v41
    v_cvt_pk_bf16_f32 v54, v42, v43
    v_lshlrev_b32 v42, 16, v27
    v_and_b32 v43, 0xffff0000, v27
    v_sub_f32 v42, v42, v40
    v_sub_f32 v43, v43, v40
    v_cvt_pk_bf16_f32 v44, v42, v43
    v_lshlrev_b32 v42, 16, v44
    v_and_b32 v43, 0xffff0000, v44
    v_mul_f32 v42, v42, v41
    v_mul_f32 v43, v43, v41
    v_cvt_pk_bf16_f32 v55, v42, v43
    v_lshlrev_b32 v42, 16, v20
    v_and_b32 v43, 0xffff0000, v20
    v_sub_f32 v42, v42, v40
    v_sub_f32 v43, v43, v40
    v_cvt_pk_bf16_f32 v44, v42, v43
    v_lshlrev_b32 v42, 16, v44
    v_and_b32 v43, 0xffff0000, v44
    v_mul_f32 v42, v42, v41
    v_mul_f32 v43, v43, v41
    v_cvt_pk_bf16_f32 v56, v42, v43
    v_lshlrev_b32 v42, 16, v21
    v_and_b32 v43, 0xffff0000, v21
    v_sub_f32 v42, v42, v40
    v_sub_f32 v43, v43, v40
    v_cvt_pk_bf16_f32 v44, v42, v43
    v_lshlrev_b32 v42, 16, v44
    v_and_b32 v43, 0xffff0000, v44
    v_mul_f32 v42, v42, v41
    v_mul_f32 v43, v43, v41
    v_cvt_pk_bf16_f32 v57, v42, v43
    v_lshlrev_b32 v42, 16, v28
    v_and_b32 v43, 0xffff0000, v28
    v_sub_f32 v42, v42, v40
    v_sub_f32 v43, v43, v40
    v_cvt_pk_bf16_f32 v44, v42, v43
    v_lshlrev_b32 v42, 16, v44
    v_and_b32 v43, 0xffff0000, v44
    v_mul_f32 v42, v42, v41
    v_mul_f32 v43, v43, v41
    v_cvt_pk_bf16_f32 v58, v42, v43
    v_lshlrev_b32 v42, 16, v29
    v_and_b32 v43, 0xffff0000, v29
    v_sub_f32 v42, v42, v40
    v_sub_f32 v43, v43, v40
    v_cvt_pk_bf16_f32 v44, v42, v43
    v_lshlrev_b32 v42, 16, v44
    v_and_b32 v43, 0xffff0000, v44
    v_mul_f32 v42, v42, v41
    v_mul_f32 v43, v43, v41
    v_cvt_pk_bf16_f32 v59, v42, v43
    v_lshlrev_b32 v42, 16, v22
    v_and_b32 v43, 0xffff0000, v22
    v_sub_f32 v42, v42, v40
    v_sub_f32 v43, v43, v40
    v_cvt_pk_bf16_f32 v44, v42, v43
    v_lshlrev_b32 v42, 16, v44
    v_and_b32 v43, 0xffff0000, v44
    v_mul_f32 v42, v42, v41
    v_mul_f32 v43, v43, v41
    v_cvt_pk_bf16_f32 v60, v42, v43
    v_lshlrev_b32 v42, 16, v23
    v_and_b32 v43, 0xffff0000, v23
    v_sub_f32 v42, v42, v40
    v_sub_f32 v43, v43, v40
    v_cvt_pk_bf16_f32 v44, v42, v43
    v_lshlrev_b32 v42, 16, v44
    v_and_b32 v43, 0xffff0000, v44
    v_mul_f32 v42, v42, v41
    v_mul_f32 v43, v43, v41
    v_cvt_pk_bf16_f32 v61, v42, v43
    v_lshlrev_b32 v42, 16, v30
    v_and_b32 v43, 0xffff0000, v30
    v_sub_f32 v42, v42, v40
    v_sub_f32 v43, v43, v40
    v_cvt_pk_bf16_f32 v44, v42, v43
    v_lshlrev_b32 v42, 16, v44
    v_and_b32 v43, 0xffff0000, v44
    v_mul_f32 v42, v42, v41
    v_mul_f32 v43, v43, v41
    v_cvt_pk_bf16_f32 v62, v42, v43
    v_lshlrev_b32 v42, 16, v31
    v_and_b32 v43, 0xffff0000, v31
    v_sub_f32 v42, v42, v40
    v_sub_f32 v43, v43, v40
    v_cvt_pk_bf16_f32 v44, v42, v43
    v_lshlrev_b32 v42, 16, v44
    v_and_b32 v43, 0xffff0000, v44
    v_mul_f32 v42, v42, v41
    v_mul_f32 v43, v43, v41
    v_cvt_pk_bf16_f32 v63, v42, v43
    s_lshr_b32 s28, s2, 1
    s_lshl_b32 s28, s28, 15
    s_and_b32 s29, s2, 1
    s_lshl_b32 s29, s29, 7
    s_add_u32 s28, s28, s29
    s_add_u32 s28, s28, 0
    v_lshlrev_b32 v5, 13, v2
    v_lshlrev_b32 v6, 10, v4
    v_lshlrev_b32 v7, 4, v3
    v_add3_u32 v5, v5, v6, v7
    buffer_store_dwordx4 v[48:51], v5, s[12:15], s28 offen
    buffer_store_dwordx4 v[52:55], v5, s[12:15], s28 offen offset:256
    buffer_store_dwordx4 v[56:59], v5, s[12:15], s28 offen offset:512
    buffer_store_dwordx4 v[60:63], v5, s[12:15], s28 offen offset:768
LN_done:
    s_endpgm

.globl mega_kernel
.p2align 8
.type mega_kernel,@function
mega_kernel:
    s_cmp_ge_u32 s2, 256
    s_cbranch_scc1 MG_done
    s_lshr_b32 s3, s2, 3
    s_cmp_ge_u32 s3, 8
    s_cbranch_scc1 MG_nocp
    v_readfirstlane_b32 s4, v0
    s_nop 0
    s_cmp_lg_u32 s4, 0
    s_cbranch_scc1 MG_nocp
    s_getpc_b64 s[4:5]
MG_pc:
    s_add_u32 s4, s4, MG_code-MG_pc
    s_addc_u32 s5, s5, 0
    s_and_b32 s5, s5, 0xffff
    s_mov_b32 s6, MG_end-MG_code
    s_mov_b32 s7, 0x00020000
    v_and_b32 v1, 63, v0
    v_lshlrev_b32 v1, 7, v1
    s_lshl_b32 s8, s3, 13
    buffer_load_dword v255, v1, s[4:7], s8 offen
MG_nocp:
MG_code:
    s_load_dwordx2 s[56:57], s[0:1], 8
    s_load_dwordx4 s[52:55], s[0:1], 48
    s_load_dwordx2 s[58:59], s[0:1], 96
    v_lshrrev_b32 v1, 6, v0
    s_nop 0
    v_readfirstlane_b32 s45, v1
    s_nop 0
    s_lshr_b32 s48, s45, 2
    s_and_b32 s45, s45, 3
    s_lshr_b32 s46, s45, 1
    s_and_b32 s47, s45, 1
    s_and_b32 s68, s2, 1
    s_lshl_b32 s68, s68, 3
    s_bfe_u32 s71, s2, 0x30003
    s_add_u32 s68, s68, s71
    s_bfe_u32 s69, s2, 0x20001
    s_lshr_b32 s71, s2, 6
    s_lshl_b32 s71, s71, 2
    s_add_u32 s69, s69, s71
    s_lshl_b32 s70, s69, 2
    s_max_u32 s71, s69, 5
    s_min_u32 s71, s71, 14
    s_sub_u32 s71, s71, 5
    s_add_u32 s70, s70, s71
    s_waitcnt lgkmcnt(0)
    s_mov_b32 s64, s58
    s_and_b32 s65, s59, 0xffff
    s_mov_b32 s66, 268435456
    s_mov_b32 s67, 0x00020000
    s_sub_u32 s71, s69, 5
    s_cmp_lt_u32 s71, 9
    s_cbranch_scc0 G4_entry
    s_cmp_eq_u32 s48, 0
    s_cbranch_scc1 G5_compute
    s_lshl_b32 s71, s68, 3
    s_lshl_b32 s72, s45, 1
    s_add_u32 s71, s71, s72
    s_lshl_b32 s71, s71, 15
    s_add_u32 s71, s71, 0
    s_add_u32 s8, s58, s71
    s_addc_u32 s72, s59, 0
    s_and_b32 s9, s72, 0xffff
    s_mov_b32 s10, 65536
    s_mov_b32 s11, 0x00020000
    s_add_u32 s72, s70, -17
    s_lshl_b32 s72, s72, 7
    s_sub_u32 s74, 7340032, s72
    s_add_u32 s12, s52, s72
    s_addc_u32 s73, s53, 0
    s_mov_b32 s37, 7168
    s_and_b32 s13, s73, 0xffff
    s_mov_b32 s14, s74
    s_mov_b32 s15, 0x00020000
    s_add_u32 s72, s70, -16
    s_lshl_b32 s72, s72, 7
    s_sub_u32 s74, 7340032, s72
    s_add_u32 s16, s52, s72
    s_addc_u32 s73, s53, 0
    s_mov_b32 s38, 7168
    s_and_b32 s17, s73, 0xffff
    s_mov_b32 s18, s74
    s_mov_b32 s19, 0x00020000
    s_add_u32 s72, s70, -15
    s_lshl_b32 s72, s72, 7
    s_sub_u32 s74, 7340032, s72
    s_add_u32 s20, s52, s72
    s_addc_u32 s73, s53, 0
    s_mov_b32 s39, 7168
    s_and_b32 s21, s73, 0xffff
    s_mov_b32 s22, s74
    s_mov_b32 s23, 0x00020000
    s_add_u32 s72, s70, -14
    s_lshl_b32 s72, s72, 7
    s_sub_u32 s74, 7340032, s72
    s_add_u32 s24, s52, s72
    s_addc_u32 s73, s53, 0
    s_mov_b32 s40, 7168
    s_and_b32 s25, s73, 0xffff
    s_mov_b32 s26, s74
    s_mov_b32 s27, 0x00020000
    s_add_u32 s72, s70, -13
    s_lshl_b32 s72, s72, 7
    s_sub_u32 s74, 7340032, s72
    s_add_u32 s28, s52, s72
    s_addc_u32 s73, s53, 0
    s_mov_b32 s41, 7168
    s_and_b32 s29, s73, 0xffff
    s_mov_b32 s30, s74
    s_mov_b32 s31, 0x00020000
    v_and_b32 v1, 63, v0
    v_lshrrev_b32 v2, 3, v1
    v_and_b32 v3, 7, v1
    v_bfe_u32 v4, v1, 4, 2
    v_lshlrev_b32 v4, 1, v4
    v_xor_b32 v3, v3, v4
    v_lshlrev_b32 v3, 4, v3
    s_lshl_b32 s49, s45, 3
    v_add_u32 v2, s49, v2
    v_lshlrev_b32 v8, 4, v1
    v_add_u32 v9, 32768, v8
    v_mul_lo_u32 v10, v2, s37
    v_add_u32 v10, v10, v3
    v_mul_lo_u32 v11, v2, s38
    v_add_u32 v11, v11, v3
    v_mul_lo_u32 v12, v2, s39
    v_add_u32 v12, v12, v3
    v_mul_lo_u32 v13, v2, s40
    v_add_u32 v13, v13, v3
    v_mul_lo_u32 v14, v2, s41
    v_add_u32 v14, v14, v3
    s_lshl_b32 s37, s37, 5
    s_mov_b32 s32, 0
    s_lshl_b32 s38, s38, 5
    s_mov_b32 s33, 0
    s_lshl_b32 s39, s39, 5
    s_mov_b32 s34, 0
    s_lshl_b32 s40, s40, 5
    s_mov_b32 s35, 0
    s_lshl_b32 s41, s41, 5
    s_mov_b32 s36, 0
    s_mov_b32 s42, 0
    s_mul_i32 s43, s45, 7168
    s_add_u32 s43, s43, 16384
    s_add_u32 m0, s43, 0
    s_nop 0
    buffer_load_dwordx4 v8, s[8:11], s42 offen lds
    s_add_u32 m0, s43, 1024
    s_nop 0
    buffer_load_dwordx4 v9, s[8:11], s42 offen lds
    s_add_u32 s42, s42, 1024
    s_add_u32 m0, s43, 2048
    s_nop 0
    buffer_load_dwordx4 v10, s[12:15], s32 offen lds
    s_add_u32 s32, s32, s37
    s_add_u32 m0, s43, 3072
    s_nop 0
    buffer_load_dwordx4 v11, s[16:19], s33 offen lds
    s_add_u32 s33, s33, s38
    s_add_u32 m0, s43, 4096
    s_nop 0
    buffer_load_dwordx4 v12, s[20:23], s34 offen lds
    s_add_u32 s34, s34, s39
    s_add_u32 m0, s43, 5120
    s_nop 0
    buffer_load_dwordx4 v13, s[24:27], s35 offen lds
    s_add_u32 s35, s35, s40
    s_add_u32 m0, s43, 6144
    s_nop 0
    buffer_load_dwordx4 v14, s[28:31], s36 offen lds
    s_add_u32 s36, s36, s41
    s_add_u32 m0, s43, 28672
    s_nop 0
    buffer_load_dwordx4 v8, s[8:11], s42 offen lds
    s_add_u32 m0, s43, 29696
    s_nop 0
    buffer_load_dwordx4 v9, s[8:11], s42 offen lds
    s_add_u32 s42, s42, 1024
    s_add_u32 m0, s43, 30720
    s_nop 0
    buffer_load_dwordx4 v10, s[12:15], s32 offen lds
    s_add_u32 s32, s32, s37
    s_add_u32 m0, s43, 31744
    s_nop 0
    buffer_load_dwordx4 v11, s[16:19], s33 offen lds
    s_add_u32 s33, s33, s38
    s_add_u32 m0, s43, 32768
    s_nop 0
    buffer_load_dwordx4 v12, s[20:23], s34 offen lds
    s_add_u32 s34, s34, s39
    s_add_u32 m0, s43, 33792
    s_nop 0
    buffer_load_dwordx4 v13, s[24:27], s35 offen lds
    s_add_u32 s35, s35, s40
    s_add_u32 m0, s43, 34816
    s_nop 0
    buffer_load_dwordx4 v14, s[28:31], s36 offen lds
    s_add_u32 s36, s36, s41
    s_add_u32 m0, s43, 57344
    s_nop 0
    buffer_load_dwordx4 v8, s[8:11], s42 offen lds
    s_add_u32 m0, s43, 58368
    s_nop 0
    buffer_load_dwordx4 v9, s[8:11], s42 offen lds
    s_add_u32 s42, s42, 1024
    s_add_u32 m0, s43, 59392
    s_nop 0
    buffer_load_dwordx4 v10, s[12:15], s32 offen lds
    s_add_u32 s32, s32, s37
    s_add_u32 m0, s43, 60416
    s_nop 0
    buffer_load_dwordx4 v11, s[16:19], s33 offen lds
    s_add_u32 s33, s33, s38
    s_add_u32 m0, s43, 61440
    s_nop 0
    buffer_load_dwordx4 v12, s[20:23], s34 offen lds
    s_add_u32 s34, s34, s39
    s_add_u32 m0, s43, 62464
    s_nop 0
    buffer_load_dwordx4 v13, s[24:27], s35 offen lds
    s_add_u32 s35, s35, s40
    s_add_u32 m0, s43, 63488
    s_nop 0
    buffer_load_dwordx4 v14, s[28:31], s36 offen lds
    s_add_u32 s36, s36, s41
    s_add_u32 m0, s43, 86016
    s_nop 0
    buffer_load_dwordx4 v8, s[8:11], s42 offen lds
    s_add_u32 m0, s43, 87040
    s_nop 0
    buffer_load_dwordx4 v9, s[8:11], s42 offen lds
    s_add_u32 s42, s42, 1024
    s_add_u32 m0, s43, 88064
    s_nop 0
    buffer_load_dwordx4 v10, s[12:15], s32 offen lds
    s_add_u32 s32, s32, s37
    s_add_u32 m0, s43, 89088
    s_nop 0
    buffer_load_dwordx4 v11, s[16:19], s33 offen lds
    s_add_u32 s33, s33, s38
    s_add_u32 m0, s43, 90112
    s_nop 0
    buffer_load_dwordx4 v12, s[20:23], s34 offen lds
    s_add_u32 s34, s34, s39
    s_add_u32 m0, s43, 91136
    s_nop 0
    buffer_load_dwordx4 v13, s[24:27], s35 offen lds
    s_add_u32 s35, s35, s40
    s_add_u32 m0, s43, 92160
    s_nop 0
    buffer_load_dwordx4 v14, s[28:31], s36 offen lds
    s_add_u32 s36, s36, s41
    s_waitcnt vmcnt(21)
    s_barrier
    s_mov_b32 s44, 8
G5_lloop:
    s_waitcnt vmcnt(14)
    s_barrier
    s_add_u32 m0, s43, 0
    s_nop 0
    buffer_load_dwordx4 v8, s[8:11], s42 offen lds
    s_add_u32 m0, s43, 1024
    s_nop 0
    buffer_load_dwordx4 v9, s[8:11], s42 offen lds
    s_add_u32 s42, s42, 1024
    s_add_u32 m0, s43, 2048
    s_nop 0
    buffer_load_dwordx4 v10, s[12:15], s32 offen lds
    s_add_u32 s32, s32, s37
    s_add_u32 m0, s43, 3072
    s_nop 0
    buffer_load_dwordx4 v11, s[16:19], s33 offen lds
    s_add_u32 s33, s33, s38
    s_add_u32 m0, s43, 4096
    s_nop 0
    buffer_load_dwordx4 v12, s[20:23], s34 offen lds
    s_add_u32 s34, s34, s39
    s_add_u32 m0, s43, 5120
    s_nop 0
    buffer_load_dwordx4 v13, s[24:27], s35 offen lds
    s_add_u32 s35, s35, s40
    s_add_u32 m0, s43, 6144
    s_nop 0
    buffer_load_dwordx4 v14, s[28:31], s36 offen lds
    s_add_u32 s36, s36, s41
    s_waitcnt vmcnt(14)
    s_barrier
    s_add_u32 m0, s43, 28672
    s_nop 0
    buffer_load_dwordx4 v8, s[8:11], s42 offen lds
    s_add_u32 m0, s43, 29696
    s_nop 0
    buffer_load_dwordx4 v9, s[8:11], s42 offen lds
    s_add_u32 s42, s42, 1024
    s_add_u32 m0, s43, 30720
    s_nop 0
    buffer_load_dwordx4 v10, s[12:15], s32 offen lds
    s_add_u32 s32, s32, s37
    s_add_u32 m0, s43, 31744
    s_nop 0
    buffer_load_dwordx4 v11, s[16:19], s33 offen lds
    s_add_u32 s33, s33, s38
    s_add_u32 m0, s43, 32768
    s_nop 0
    buffer_load_dwordx4 v12, s[20:23], s34 offen lds
    s_add_u32 s34, s34, s39
    s_add_u32 m0, s43, 33792
    s_nop 0
    buffer_load_dwordx4 v13, s[24:27], s35 offen lds
    s_add_u32 s35, s35, s40
    s_add_u32 m0, s43, 34816
    s_nop 0
    buffer_load_dwordx4 v14, s[28:31], s36 offen lds
    s_add_u32 s36, s36, s41
    s_waitcnt vmcnt(14)
    s_barrier
    s_add_u32 m0, s43, 57344
    s_nop 0
    buffer_load_dwordx4 v8, s[8:11], s42 offen lds
    s_add_u32 m0, s43, 58368
    s_nop 0
    buffer_load_dwordx4 v9, s[8:11], s42 offen lds
    s_add_u32 s42, s42, 1024
    s_add_u32 m0, s43, 59392
    s_nop 0
    buffer_load_dwordx4 v10, s[12:15], s32 offen lds
    s_add_u32 s32, s32, s37
    s_add_u32 m0, s43, 60416
    s_nop 0
    buffer_load_dwordx4 v11, s[16:19], s33 offen lds
    s_add_u32 s33, s33, s38
    s_add_u32 m0, s43, 61440
    s_nop 0
    buffer_load_dwordx4 v12, s[20:23], s34 offen lds
    s_add_u32 s34, s34, s39
    s_add_u32 m0, s43, 62464
    s_nop 0
    buffer_load_dwordx4 v13, s[24:27], s35 offen lds
    s_add_u32 s35, s35, s40
    s_add_u32 m0, s43, 63488
    s_nop 0
    buffer_load_dwordx4 v14, s[28:31], s36 offen lds
    s_add_u32 s36, s36, s41
    s_waitcnt vmcnt(14)
    s_barrier
    s_add_u32 m0, s43, 86016
    s_nop 0
    buffer_load_dwordx4 v8, s[8:11], s42 offen lds
    s_add_u32 m0, s43, 87040
    s_nop 0
    buffer_load_dwordx4 v9, s[8:11], s42 offen lds
    s_add_u32 s42, s42, 1024
    s_add_u32 m0, s43, 88064
    s_nop 0
    buffer_load_dwordx4 v10, s[12:15], s32 offen lds
    s_add_u32 s32, s32, s37
    s_add_u32 m0, s43, 89088
    s_nop 0
    buffer_load_dwordx4 v11, s[16:19], s33 offen lds
    s_add_u32 s33, s33, s38
    s_add_u32 m0, s43, 90112
    s_nop 0
    buffer_load_dwordx4 v12, s[20:23], s34 offen lds
    s_add_u32 s34, s34, s39
    s_add_u32 m0, s43, 91136
    s_nop 0
    buffer_load_dwordx4 v13, s[24:27], s35 offen lds
    s_add_u32 s35, s35, s40
    s_add_u32 m0, s43, 92160
    s_nop 0
    buffer_load_dwordx4 v14, s[28:31], s36 offen lds
    s_add_u32 s36, s36, s41
    s_sub_u32 s44, s44, 1
    s_cmp_lg_u32 s44, 0
    s_cbranch_scc1 G5_lloop
    s_waitcnt vmcnt(0)
    s_branch G5_join
G5_compute:
    v_bfe_u32 v1, v0, 4, 2
    v_lshlrev_b32 v1, 3, v1
    s_lshl_b32 s71, s70, 1
    s_mul_i32 s72, s47, 5
    s_add_u32 s71, s71, s72
    s_sub_u32 s71, s71, 34
    s_mov_b32 s60, s54
    s_and_b32 s61, s55, 0xffff
    s_mov_b32 s62, 7168
    s_mov_b32 s63, 0x00020000
    s_add_u32 s73, s71, 0
    s_lshl_b32 s72, s73, 6
    s_cmp_lt_u32 s73, 112
    s_cselect_b32 s72, s72, 0x100000
    buffer_load_dwordx2 v[168:169], v1, s[60:63], s72 offen
    buffer_load_dwordx2 v[170:171], v1, s[60:63], s72 offen offset:32
    s_add_u32 s73, s71, 1
    s_lshl_b32 s72, s73, 6
    s_cmp_lt_u32 s73, 112
    s_cselect_b32 s72, s72, 0x100000
    buffer_load_dwordx2 v[172:173], v1, s[60:63], s72 offen
    buffer_load_dwordx2 v[174:175], v1, s[60:63], s72 offen offset:32
    s_add_u32 s73, s71, 2
    s_lshl_b32 s72, s73, 6
    s_cmp_lt_u32 s73, 112
    s_cselect_b32 s72, s72, 0x100000
    buffer_load_dwordx2 v[176:177], v1, s[60:63], s72 offen
    buffer_load_dwordx2 v[178:179], v1, s[60:63], s72 offen offset:32
    s_add_u32 s73, s71, 3
    s_lshl_b32 s72, s73, 6
    s_cmp_lt_u32 s73, 112
    s_cselect_b32 s72, s72, 0x100000
    buffer_load_dwordx2 v[180:181], v1, s[60:63], s72 offen
    buffer_load_dwordx2 v[182:183], v1, s[60:63], s72 offen offset:32
    s_add_u32 s73, s71, 4
    s_lshl_b32 s72, s73, 6
    s_cmp_lt_u32 s73, 112
    s_cselect_b32 s72, s72, 0x100000
    buffer_load_dwordx2 v[184:185], v1, s[60:63], s72 offen
    buffer_load_dwordx2 v[186:187], v1, s[60:63], s72 offen offset:32
    v_and_b32 v1, 63, v0
    v_lshrrev_b32 v2, 5, v1
    v_mul_u32_u24 v4, 7168, v2
    v_bfe_u32 v3, v1, 2, 3
    v_lshl_add_u32 v4, v3, 7, v4
    v_and_b32 v6, 3, v1
    v_lshl_add_u32 v4, v6, 3, v4
    v_lshrrev_b32 v5, 1, v3
    s_mul_i32 s49, s47, 10
    s_add_u32 s49, s49, 0
    s_lshr_b32 s50, s49, 2
    s_lshl_b32 s50, s50, 10
    s_add_u32 s50, s50, 18432
    s_and_b32 s49, s49, 3
    v_xor_b32 v6, s49, v5
    v_lshl_add_u32 v6, v6, 5, v4
    v_add_u32 v242, s50, v6
    v_add_u32 v246, s50, v6
    v_add_u32 v246, 57344, v246
    s_mul_i32 s49, s47, 10
    s_add_u32 s49, s49, 1
    s_lshr_b32 s50, s49, 2
    s_lshl_b32 s50, s50, 10
    s_add_u32 s50, s50, 18432
    s_and_b32 s49, s49, 3
    v_xor_b32 v6, s49, v5
    v_lshl_add_u32 v6, v6, 5, v4
    v_add_u32 v243, s50, v6
    v_add_u32 v247, s50, v6
    v_add_u32 v247, 57344, v247
    s_mul_i32 s49, s47, 10
    s_add_u32 s49, s49, 2
    s_lshr_b32 s50, s49, 2
    s_lshl_b32 s50, s50, 10
    s_add_u32 s50, s50, 18432
    s_and_b32 s49, s49, 3
    v_xor_b32 v6, s49, v5
    v_lshl_add_u32 v6, v6, 5, v4
    v_add_u32 v244, s50, v6
    v_add_u32 v248, s50, v6
    v_add_u32 v248, 57344, v248
    s_mul_i32 s49, s47, 10
    s_add_u32 s49, s49, 3
    s_lshr_b32 s50, s49, 2
    s_lshl_b32 s50, s50, 10
    s_add_u32 s50, s50, 18432
    s_and_b32 s49, s49, 3
    v_xor_b32 v6, s49, v5
    v_lshl_add_u32 v6, v6, 5, v4
    v_add_u32 v245, s50, v6
    v_add_u32 v249, s50, v6
    v_add_u32 v249, 57344, v249
    s_mul_i32 s49, s46, 14336
    s_add_u32 s49, s49, 16384
    v_lshlrev_b32 v6, 4, v1
    v_add_u32 v240, s49, v6
    v_add_u32 v241, s49, v6
    v_add_u32 v241, 57344, v241
    s_waitcnt vmcnt(0)
    v_lshlrev_b32 v8, 16, v168
    v_and_b32 v9, 0xffff0000, v168
    v_lshlrev_b32 v10, 16, v169
    v_and_b32 v11, 0xffff0000, v169
    v_pk_mov_b32 v[12:13], v[8:9], v[8:9] op_sel:[0,1]
    v_pk_mov_b32 v[14:15], v[10:11], v[10:11] op_sel:[0,1]
    v_pk_mov_b32 v[16:17], v[8:9], v[8:9] op_sel:[0,1]
    v_pk_mov_b32 v[18:19], v[10:11], v[10:11] op_sel:[0,1]
    v_pk_mov_b32 v[20:21], v[8:9], v[8:9] op_sel:[0,1]
    v_pk_mov_b32 v[22:23], v[10:11], v[10:11] op_sel:[0,1]
    v_lshlrev_b32 v24, 16, v170
    v_and_b32 v25, 0xffff0000, v170
    v_lshlrev_b32 v26, 16, v171
    v_and_b32 v27, 0xffff0000, v171
    v_pk_mov_b32 v[28:29], v[24:25], v[24:25] op_sel:[0,1]
    v_pk_mov_b32 v[30:31], v[26:27], v[26:27] op_sel:[0,1]
    v_pk_mov_b32 v[32:33], v[24:25], v[24:25] op_sel:[0,1]
    v_pk_mov_b32 v[34:35], v[26:27], v[26:27] op_sel:[0,1]
    v_pk_mov_b32 v[36:37], v[24:25], v[24:25] op_sel:[0,1]
    v_pk_mov_b32 v[38:39], v[26:27], v[26:27] op_sel:[0,1]
    v_lshlrev_b32 v40, 16, v172
    v_and_b32 v41, 0xffff0000, v172
    v_lshlrev_b32 v42, 16, v173
    v_and_b32 v43, 0xffff0000, v173
    v_pk_mov_b32 v[44:45], v[40:41], v[40:41] op_sel:[0,1]
    v_pk_mov_b32 v[46:47], v[42:43], v[42:43] op_sel:[0,1]
    v_pk_mov_b32 v[48:49], v[40:41], v[40:41] op_sel:[0,1]
    v_pk_mov_b32 v[50:51], v[42:43], v[42:43] op_sel:[0,1]
    v_pk_mov_b32 v[52:53], v[40:41], v[40:41] op_sel:[0,1]
    v_pk_mov_b32 v[54:55], v[42:43], v[42:43] op_sel:[0,1]
    v_lshlrev_b32 v56, 16, v174
    v_and_b32 v57, 0xffff0000, v174
    v_lshlrev_b32 v58, 16, v175
    v_and_b32 v59, 0xffff0000, v175
    v_pk_mov_b32 v[60:61], v[56:57], v[56:57] op_sel:[0,1]
    v_pk_mov_b32 v[62:63], v[58:59], v[58:59] op_sel:[0,1]
    v_pk_mov_b32 v[64:65], v[56:57], v[56:57] op_sel:[0,1]
    v_pk_mov_b32 v[66:67], v[58:59], v[58:59] op_sel:[0,1]
    v_pk_mov_b32 v[68:69], v[56:57], v[56:57] op_sel:[0,1]
    v_pk_mov_b32 v[70:71], v[58:59], v[58:59] op_sel:[0,1]
    v_lshlrev_b32 v72, 16, v176
    v_and_b32 v73, 0xffff0000, v176
    v_lshlrev_b32 v74, 16, v177
    v_and_b32 v75, 0xffff0000, v177
    v_pk_mov_b32 v[76:77], v[72:73], v[72:73] op_sel:[0,1]
    v_pk_mov_b32 v[78:79], v[74:75], v[74:75] op_sel:[0,1]
    v_pk_mov_b32 v[80:81], v[72:73], v[72:73] op_sel:[0,1]
    v_pk_mov_b32 v[82:83], v[74:75], v[74:75] op_sel:[0,1]
    v_pk_mov_b32 v[84:85], v[72:73], v[72:73] op_sel:[0,1]
    v_pk_mov_b32 v[86:87], v[74:75], v[74:75] op_sel:[0,1]
    v_lshlrev_b32 v88, 16, v178
    v_and_b32 v89, 0xffff0000, v178
    v_lshlrev_b32 v90, 16, v179
    v_and_b32 v91, 0xffff0000, v179
    v_pk_mov_b32 v[92:93], v[88:89], v[88:89] op_sel:[0,1]
    v_pk_mov_b32 v[94:95], v[90:91], v[90:91] op_sel:[0,1]
    v_pk_mov_b32 v[96:97], v[88:89], v[88:89] op_sel:[0,1]
    v_pk_mov_b32 v[98:99], v[90:91], v[90:91] op_sel:[0,1]
    v_pk_mov_b32 v[100:101], v[88:89], v[88:89] op_sel:[0,1]
    v_pk_mov_b32 v[102:103], v[90:91], v[90:91] op_sel:[0,1]
    v_lshlrev_b32 v104, 16, v180
    v_and_b32 v105, 0xffff0000, v180
    v_lshlrev_b32 v106, 16, v181
    v_and_b32 v107, 0xffff0000, v181
    v_pk_mov_b32 v[108:109], v[104:105], v[104:105] op_sel:[0,1]
    v_pk_mov_b32 v[110:111], v[106:107], v[106:107] op_sel:[0,1]
    v_pk_mov_b32 v[112:113], v[104:105], v[104:105] op_sel:[0,1]
    v_pk_mov_b32 v[114:115], v[106:107], v[106:107] op_sel:[0,1]
    v_pk_mov_b32 v[116:117], v[104:105], v[104:105] op_sel:[0,1]
    v_pk_mov_b32 v[118:119], v[106:107], v[106:107] op_sel:[0,1]
    v_lshlrev_b32 v120, 16, v182
    v_and_b32 v121, 0xffff0000, v182
    v_lshlrev_b32 v122, 16, v183
    v_and_b32 v123, 0xffff0000, v183
    v_pk_mov_b32 v[124:125], v[120:121], v[120:121] op_sel:[0,1]
    v_pk_mov_b32 v[126:127], v[122:123], v[122:123] op_sel:[0,1]
    v_pk_mov_b32 v[128:129], v[120:121], v[120:121] op_sel:[0,1]
    v_pk_mov_b32 v[130:131], v[122:123], v[122:123] op_sel:[0,1]
    v_pk_mov_b32 v[132:133], v[120:121], v[120:121] op_sel:[0,1]
    v_pk_mov_b32 v[134:135], v[122:123], v[122:123] op_sel:[0,1]
    v_lshlrev_b32 v136, 16, v184
    v_and_b32 v137, 0xffff0000, v184
    v_lshlrev_b32 v138, 16, v185
    v_and_b32 v139, 0xffff0000, v185
    v_pk_mov_b32 v[140:141], v[136:137], v[136:137] op_sel:[0,1]
    v_pk_mov_b32 v[142:143], v[138:139], v[138:139] op_sel:[0,1]
    v_pk_mov_b32 v[144:145], v[136:137], v[136:137] op_sel:[0,1]
    v_pk_mov_b32 v[146:147], v[138:139], v[138:139] op_sel:[0,1]
    v_pk_mov_b32 v[148:149], v[136:137], v[136:137] op_sel:[0,1]
    v_pk_mov_b32 v[150:151], v[138:139], v[138:139] op_sel:[0,1]
    v_lshlrev_b32 v152, 16, v186
    v_and_b32 v153, 0xffff0000, v186
    v_lshlrev_b32 v154, 16, v187
    v_and_b32 v155, 0xffff0000, v187
    v_pk_mov_b32 v[156:157], v[152:153], v[152:153] op_sel:[0,1]
    v_pk_mov_b32 v[158:159], v[154:155], v[154:155] op_sel:[0,1]
    v_pk_mov_b32 v[160:161], v[152:153], v[152:153] op_sel:[0,1]
    v_pk_mov_b32 v[162:163], v[154:155], v[154:155] op_sel:[0,1]
    v_pk_mov_b32 v[164:165], v[152:153], v[152:153] op_sel:[0,1]
    v_pk_mov_b32 v[166:167], v[154:155], v[154:155] op_sel:[0,1]
    s_barrier
    ds_read_b128 v[168:171], v240 offset:0
    ds_read_b64_tr_b16 v[200:201], v242 offset:0
    ds_read_b64_tr_b16 v[202:203], v242 offset:14336
    ds_read_b128 v[172:175], v240 offset:1024
    ds_read_b128 v[176:179], v240 offset:7168
    ds_read_b128 v[180:183], v240 offset:8192
    ds_read_b64_tr_b16 v[204:205], v243 offset:0
    ds_read_b64_tr_b16 v[206:207], v243 offset:14336
    ds_read_b64_tr_b16 v[208:209], v244 offset:0
    ds_read_b64_tr_b16 v[210:211], v244 offset:14336
    ds_read_b64_tr_b16 v[212:213], v245 offset:0
    ds_read_b64_tr_b16 v[214:215], v245 offset:14336
    ds_read_b64_tr_b16 v[216:217], v242 offset:1024
    ds_read_b64_tr_b16 v[218:219], v242 offset:15360
    s_mov_b32 s44, 8
G5_loop:
    s_waitcnt lgkmcnt(0)
    v_mfma_f32_16x16x32_bf16 v[8:11], v[200:203], v[168:171], v[8:11]
    ds_read_b64_tr_b16 v[220:221], v243 offset:1024
    v_mfma_f32_16x16x32_bf16 v[12:15], v[200:203], v[172:175], v[12:15]
    ds_read_b64_tr_b16 v[222:223], v243 offset:15360
    v_mfma_f32_16x16x32_bf16 v[16:19], v[200:203], v[176:179], v[16:19]
    ds_read_b64_tr_b16 v[224:225], v244 offset:1024
    v_mfma_f32_16x16x32_bf16 v[20:23], v[200:203], v[180:183], v[20:23]
    ds_read_b64_tr_b16 v[226:227], v244 offset:15360
    v_mfma_f32_16x16x32_bf16 v[36:39], v[204:207], v[180:183], v[36:39]
    ds_read_b64_tr_b16 v[228:229], v245 offset:1024
    v_mfma_f32_16x16x32_bf16 v[32:35], v[204:207], v[176:179], v[32:35]
    v_mfma_f32_16x16x32_bf16 v[28:31], v[204:207], v[172:175], v[28:31]
    ds_read_b64_tr_b16 v[230:231], v245 offset:15360
    v_mfma_f32_16x16x32_bf16 v[24:27], v[204:207], v[168:171], v[24:27]
    ds_read_b64_tr_b16 v[232:233], v242 offset:2048
    v_mfma_f32_16x16x32_bf16 v[40:43], v[208:211], v[168:171], v[40:43]
    ds_read_b64_tr_b16 v[234:235], v242 offset:16384
    v_mfma_f32_16x16x32_bf16 v[44:47], v[208:211], v[172:175], v[44:47]
    ds_read_b64_tr_b16 v[236:237], v243 offset:2048
    v_mfma_f32_16x16x32_bf16 v[48:51], v[208:211], v[176:179], v[48:51]
    ds_read_b64_tr_b16 v[238:239], v243 offset:16384
    v_mfma_f32_16x16x32_bf16 v[52:55], v[208:211], v[180:183], v[52:55]
    v_mfma_f32_16x16x32_bf16 v[68:71], v[212:215], v[180:183], v[68:71]
    v_mfma_f32_16x16x32_bf16 v[64:67], v[212:215], v[176:179], v[64:67]
    v_mfma_f32_16x16x32_bf16 v[60:63], v[212:215], v[172:175], v[60:63]
    v_mfma_f32_16x16x32_bf16 v[56:59], v[212:215], v[168:171], v[56:59]
    v_mfma_f32_16x16x32_bf16 v[72:75], v[216:219], v[168:171], v[72:75]
    v_mfma_f32_16x16x32_bf16 v[76:79], v[216:219], v[172:175], v[76:79]
    v_mfma_f32_16x16x32_bf16 v[80:83], v[216:219], v[176:179], v[80:83]
    v_mfma_f32_16x16x32_bf16 v[84:87], v[216:219], v[180:183], v[84:87]
    s_waitcnt lgkmcnt(0)
    v_mfma_f32_16x16x32_bf16 v[88:91], v[220:223], v[168:171], v[88:91]
    s_barrier
    v_mfma_f32_16x16x32_bf16 v[92:95], v[220:223], v[172:175], v[92:95]
    ds_read_b128 v[184:187], v240 offset:28672
    ds_read_b64_tr_b16 v[200:201], v242 offset:28672
    v_mfma_f32_16x16x32_bf16 v[96:99], v[220:223], v[176:179], v[96:99]
    ds_read_b64_tr_b16 v[202:203], v242 offset:43008
    v_mfma_f32_16x16x32_bf16 v[100:103], v[220:223], v[180:183], v[100:103]
    ds_read_b128 v[188:191], v240 offset:29696
    v_mfma_f32_16x16x32_bf16 v[116:119], v[224:227], v[180:183], v[116:119]
    ds_read_b128 v[192:195], v240 offset:35840
    ds_read_b128 v[196:199], v240 offset:36864
    v_mfma_f32_16x16x32_bf16 v[112:115], v[224:227], v[176:179], v[112:115]
    ds_read_b64_tr_b16 v[204:205], v243 offset:28672
    v_mfma_f32_16x16x32_bf16 v[108:111], v[224:227], v[172:175], v[108:111]
    ds_read_b64_tr_b16 v[206:207], v243 offset:43008
    v_mfma_f32_16x16x32_bf16 v[104:107], v[224:227], v[168:171], v[104:107]
    ds_read_b64_tr_b16 v[208:209], v244 offset:28672
    v_mfma_f32_16x16x32_bf16 v[120:123], v[228:231], v[168:171], v[120:123]
    ds_read_b64_tr_b16 v[210:211], v244 offset:43008
    ds_read_b64_tr_b16 v[212:213], v245 offset:28672
    v_mfma_f32_16x16x32_bf16 v[124:127], v[228:231], v[172:175], v[124:127]
    ds_read_b64_tr_b16 v[214:215], v245 offset:43008
    v_mfma_f32_16x16x32_bf16 v[128:131], v[228:231], v[176:179], v[128:131]
    ds_read_b64_tr_b16 v[216:217], v242 offset:29696
    v_mfma_f32_16x16x32_bf16 v[132:135], v[228:231], v[180:183], v[132:135]
    ds_read_b64_tr_b16 v[218:219], v242 offset:44032
    v_mfma_f32_16x16x32_bf16 v[148:151], v[232:235], v[180:183], v[148:151]
    v_mfma_f32_16x16x32_bf16 v[144:147], v[232:235], v[176:179], v[144:147]
    v_mfma_f32_16x16x32_bf16 v[140:143], v[232:235], v[172:175], v[140:143]
    v_mfma_f32_16x16x32_bf16 v[136:139], v[232:235], v[168:171], v[136:139]
    v_mfma_f32_16x16x32_bf16 v[152:155], v[236:239], v[168:171], v[152:155]
    v_mfma_f32_16x16x32_bf16 v[156:159], v[236:239], v[172:175], v[156:159]
    v_mfma_f32_16x16x32_bf16 v[160:163], v[236:239], v[176:179], v[160:163]
    v_mfma_f32_16x16x32_bf16 v[164:167], v[236:239], v[180:183], v[164:167]
    s_waitcnt lgkmcnt(0)
    v_mfma_f32_16x16x32_bf16 v[8:11], v[200:203], v[184:187], v[8:11]
    ds_read_b64_tr_b16 v[220:221], v243 offset:29696
    v_mfma_f32_16x16x32_bf16 v[12:15], v[200:203], v[188:191], v[12:15]
    ds_read_b64_tr_b16 v[222:223], v243 offset:44032
    v_mfma_f32_16x16x32_bf16 v[16:19], v[200:203], v[192:195], v[16:19]
    ds_read_b64_tr_b16 v[224:225], v244 offset:29696
    v_mfma_f32_16x16x32_bf16 v[20:23], v[200:203], v[196:199], v[20:23]
    ds_read_b64_tr_b16 v[226:227], v244 offset:44032
    v_mfma_f32_16x16x32_bf16 v[36:39], v[204:207], v[196:199], v[36:39]
    ds_read_b64_tr_b16 v[228:229], v245 offset:29696
    v_mfma_f32_16x16x32_bf16 v[32:35], v[204:207], v[192:195], v[32:35]
    v_mfma_f32_16x16x32_bf16 v[28:31], v[204:207], v[188:191], v[28:31]
    ds_read_b64_tr_b16 v[230:231], v245 offset:44032
    v_mfma_f32_16x16x32_bf16 v[24:27], v[204:207], v[184:187], v[24:27]
    ds_read_b64_tr_b16 v[232:233], v242 offset:30720
    v_mfma_f32_16x16x32_bf16 v[40:43], v[208:211], v[184:187], v[40:43]
    ds_read_b64_tr_b16 v[234:235], v242 offset:45056
    v_mfma_f32_16x16x32_bf16 v[44:47], v[208:211], v[188:191], v[44:47]
    ds_read_b64_tr_b16 v[236:237], v243 offset:30720
    v_mfma_f32_16x16x32_bf16 v[48:51], v[208:211], v[192:195], v[48:51]
    ds_read_b64_tr_b16 v[238:239], v243 offset:45056
    v_mfma_f32_16x16x32_bf16 v[52:55], v[208:211], v[196:199], v[52:55]
    v_mfma_f32_16x16x32_bf16 v[68:71], v[212:215], v[196:199], v[68:71]
    v_mfma_f32_16x16x32_bf16 v[64:67], v[212:215], v[192:195], v[64:67]
    v_mfma_f32_16x16x32_bf16 v[60:63], v[212:215], v[188:191], v[60:63]
    v_mfma_f32_16x16x32_bf16 v[56:59], v[212:215], v[184:187], v[56:59]
    v_mfma_f32_16x16x32_bf16 v[72:75], v[216:219], v[184:187], v[72:75]
    v_mfma_f32_16x16x32_bf16 v[76:79], v[216:219], v[188:191], v[76:79]
    v_mfma_f32_16x16x32_bf16 v[80:83], v[216:219], v[192:195], v[80:83]
    v_mfma_f32_16x16x32_bf16 v[84:87], v[216:219], v[196:199], v[84:87]
    s_waitcnt lgkmcnt(0)
    v_mfma_f32_16x16x32_bf16 v[88:91], v[220:223], v[184:187], v[88:91]
    s_barrier
    v_mfma_f32_16x16x32_bf16 v[92:95], v[220:223], v[188:191], v[92:95]
    ds_read_b128 v[168:171], v241 offset:0
    ds_read_b64_tr_b16 v[200:201], v246 offset:0
    v_mfma_f32_16x16x32_bf16 v[96:99], v[220:223], v[192:195], v[96:99]
    ds_read_b64_tr_b16 v[202:203], v246 offset:14336
    v_mfma_f32_16x16x32_bf16 v[100:103], v[220:223], v[196:199], v[100:103]
    ds_read_b128 v[172:175], v241 offset:1024
    v_mfma_f32_16x16x32_bf16 v[116:119], v[224:227], v[196:199], v[116:119]
    ds_read_b128 v[176:179], v241 offset:7168
    ds_read_b128 v[180:183], v241 offset:8192
    v_mfma_f32_16x16x32_bf16 v[112:115], v[224:227], v[192:195], v[112:115]
    ds_read_b64_tr_b16 v[204:205], v247 offset:0
    v_mfma_f32_16x16x32_bf16 v[108:111], v[224:227], v[188:191], v[108:111]
    ds_read_b64_tr_b16 v[206:207], v247 offset:14336
    v_mfma_f32_16x16x32_bf16 v[104:107], v[224:227], v[184:187], v[104:107]
    ds_read_b64_tr_b16 v[208:209], v248 offset:0
    v_mfma_f32_16x16x32_bf16 v[120:123], v[228:231], v[184:187], v[120:123]
    ds_read_b64_tr_b16 v[210:211], v248 offset:14336
    ds_read_b64_tr_b16 v[212:213], v249 offset:0
    v_mfma_f32_16x16x32_bf16 v[124:127], v[228:231], v[188:191], v[124:127]
    ds_read_b64_tr_b16 v[214:215], v249 offset:14336
    v_mfma_f32_16x16x32_bf16 v[128:131], v[228:231], v[192:195], v[128:131]
    ds_read_b64_tr_b16 v[216:217], v246 offset:1024
    v_mfma_f32_16x16x32_bf16 v[132:135], v[228:231], v[196:199], v[132:135]
    ds_read_b64_tr_b16 v[218:219], v246 offset:15360
    v_mfma_f32_16x16x32_bf16 v[148:151], v[232:235], v[196:199], v[148:151]
    v_mfma_f32_16x16x32_bf16 v[144:147], v[232:235], v[192:195], v[144:147]
    v_mfma_f32_16x16x32_bf16 v[140:143], v[232:235], v[188:191], v[140:143]
    v_mfma_f32_16x16x32_bf16 v[136:139], v[232:235], v[184:187], v[136:139]
    v_mfma_f32_16x16x32_bf16 v[152:155], v[236:239], v[184:187], v[152:155]
    v_mfma_f32_16x16x32_bf16 v[156:159], v[236:239], v[188:191], v[156:159]
    v_mfma_f32_16x16x32_bf16 v[160:163], v[236:239], v[192:195], v[160:163]
    v_mfma_f32_16x16x32_bf16 v[164:167], v[236:239], v[196:199], v[164:167]
    s_waitcnt lgkmcnt(0)
    v_mfma_f32_16x16x32_bf16 v[8:11], v[200:203], v[168:171], v[8:11]
    ds_read_b64_tr_b16 v[220:221], v247 offset:1024
    v_mfma_f32_16x16x32_bf16 v[12:15], v[200:203], v[172:175], v[12:15]
    ds_read_b64_tr_b16 v[222:223], v247 offset:15360
    v_mfma_f32_16x16x32_bf16 v[16:19], v[200:203], v[176:179], v[16:19]
    ds_read_b64_tr_b16 v[224:225], v248 offset:1024
    v_mfma_f32_16x16x32_bf16 v[20:23], v[200:203], v[180:183], v[20:23]
    ds_read_b64_tr_b16 v[226:227], v248 offset:15360
    v_mfma_f32_16x16x32_bf16 v[36:39], v[204:207], v[180:183], v[36:39]
    ds_read_b64_tr_b16 v[228:229], v249 offset:1024
    v_mfma_f32_16x16x32_bf16 v[32:35], v[204:207], v[176:179], v[32:35]
    v_mfma_f32_16x16x32_bf16 v[28:31], v[204:207], v[172:175], v[28:31]
    ds_read_b64_tr_b16 v[230:231], v249 offset:15360
    v_mfma_f32_16x16x32_bf16 v[24:27], v[204:207], v[168:171], v[24:27]
    ds_read_b64_tr_b16 v[232:233], v246 offset:2048
    v_mfma_f32_16x16x32_bf16 v[40:43], v[208:211], v[168:171], v[40:43]
    ds_read_b64_tr_b16 v[234:235], v246 offset:16384
    v_mfma_f32_16x16x32_bf16 v[44:47], v[208:211], v[172:175], v[44:47]
    ds_read_b64_tr_b16 v[236:237], v247 offset:2048
    v_mfma_f32_16x16x32_bf16 v[48:51], v[208:211], v[176:179], v[48:51]
    ds_read_b64_tr_b16 v[238:239], v247 offset:16384
    v_mfma_f32_16x16x32_bf16 v[52:55], v[208:211], v[180:183], v[52:55]
    v_mfma_f32_16x16x32_bf16 v[68:71], v[212:215], v[180:183], v[68:71]
    v_mfma_f32_16x16x32_bf16 v[64:67], v[212:215], v[176:179], v[64:67]
    v_mfma_f32_16x16x32_bf16 v[60:63], v[212:215], v[172:175], v[60:63]
    v_mfma_f32_16x16x32_bf16 v[56:59], v[212:215], v[168:171], v[56:59]
    v_mfma_f32_16x16x32_bf16 v[72:75], v[216:219], v[168:171], v[72:75]
    v_mfma_f32_16x16x32_bf16 v[76:79], v[216:219], v[172:175], v[76:79]
    v_mfma_f32_16x16x32_bf16 v[80:83], v[216:219], v[176:179], v[80:83]
    v_mfma_f32_16x16x32_bf16 v[84:87], v[216:219], v[180:183], v[84:87]
    s_waitcnt lgkmcnt(0)
    v_mfma_f32_16x16x32_bf16 v[88:91], v[220:223], v[168:171], v[88:91]
    s_barrier
    v_mfma_f32_16x16x32_bf16 v[92:95], v[220:223], v[172:175], v[92:95]
    ds_read_b128 v[184:187], v241 offset:28672
    ds_read_b64_tr_b16 v[200:201], v246 offset:28672
    v_mfma_f32_16x16x32_bf16 v[96:99], v[220:223], v[176:179], v[96:99]
    ds_read_b64_tr_b16 v[202:203], v246 offset:43008
    v_mfma_f32_16x16x32_bf16 v[100:103], v[220:223], v[180:183], v[100:103]
    ds_read_b128 v[188:191], v241 offset:29696
    v_mfma_f32_16x16x32_bf16 v[116:119], v[224:227], v[180:183], v[116:119]
    ds_read_b128 v[192:195], v241 offset:35840
    ds_read_b128 v[196:199], v241 offset:36864
    v_mfma_f32_16x16x32_bf16 v[112:115], v[224:227], v[176:179], v[112:115]
    ds_read_b64_tr_b16 v[204:205], v247 offset:28672
    v_mfma_f32_16x16x32_bf16 v[108:111], v[224:227], v[172:175], v[108:111]
    ds_read_b64_tr_b16 v[206:207], v247 offset:43008
    v_mfma_f32_16x16x32_bf16 v[104:107], v[224:227], v[168:171], v[104:107]
    ds_read_b64_tr_b16 v[208:209], v248 offset:28672
    v_mfma_f32_16x16x32_bf16 v[120:123], v[228:231], v[168:171], v[120:123]
    ds_read_b64_tr_b16 v[210:211], v248 offset:43008
    ds_read_b64_tr_b16 v[212:213], v249 offset:28672
    v_mfma_f32_16x16x32_bf16 v[124:127], v[228:231], v[172:175], v[124:127]
    ds_read_b64_tr_b16 v[214:215], v249 offset:43008
    v_mfma_f32_16x16x32_bf16 v[128:131], v[228:231], v[176:179], v[128:131]
    ds_read_b64_tr_b16 v[216:217], v246 offset:29696
    v_mfma_f32_16x16x32_bf16 v[132:135], v[228:231], v[180:183], v[132:135]
    ds_read_b64_tr_b16 v[218:219], v246 offset:44032
    v_mfma_f32_16x16x32_bf16 v[148:151], v[232:235], v[180:183], v[148:151]
    v_mfma_f32_16x16x32_bf16 v[144:147], v[232:235], v[176:179], v[144:147]
    v_mfma_f32_16x16x32_bf16 v[140:143], v[232:235], v[172:175], v[140:143]
    v_mfma_f32_16x16x32_bf16 v[136:139], v[232:235], v[168:171], v[136:139]
    v_mfma_f32_16x16x32_bf16 v[152:155], v[236:239], v[168:171], v[152:155]
    v_mfma_f32_16x16x32_bf16 v[156:159], v[236:239], v[172:175], v[156:159]
    v_mfma_f32_16x16x32_bf16 v[160:163], v[236:239], v[176:179], v[160:163]
    v_mfma_f32_16x16x32_bf16 v[164:167], v[236:239], v[180:183], v[164:167]
    s_waitcnt lgkmcnt(0)
    v_mfma_f32_16x16x32_bf16 v[8:11], v[200:203], v[184:187], v[8:11]
    ds_read_b64_tr_b16 v[220:221], v247 offset:29696
    v_mfma_f32_16x16x32_bf16 v[12:15], v[200:203], v[188:191], v[12:15]
    ds_read_b64_tr_b16 v[222:223], v247 offset:44032
    v_mfma_f32_16x16x32_bf16 v[16:19], v[200:203], v[192:195], v[16:19]
    ds_read_b64_tr_b16 v[224:225], v248 offset:29696
    v_mfma_f32_16x16x32_bf16 v[20:23], v[200:203], v[196:199], v[20:23]
    ds_read_b64_tr_b16 v[226:227], v248 offset:44032
    v_mfma_f32_16x16x32_bf16 v[36:39], v[204:207], v[196:199], v[36:39]
    ds_read_b64_tr_b16 v[228:229], v249 offset:29696
    v_mfma_f32_16x16x32_bf16 v[32:35], v[204:207], v[192:195], v[32:35]
    v_mfma_f32_16x16x32_bf16 v[28:31], v[204:207], v[188:191], v[28:31]
    ds_read_b64_tr_b16 v[230:231], v249 offset:44032
    v_mfma_f32_16x16x32_bf16 v[24:27], v[204:207], v[184:187], v[24:27]
    ds_read_b64_tr_b16 v[232:233], v246 offset:30720
    v_mfma_f32_16x16x32_bf16 v[40:43], v[208:211], v[184:187], v[40:43]
    ds_read_b64_tr_b16 v[234:235], v246 offset:45056
    v_mfma_f32_16x16x32_bf16 v[44:47], v[208:211], v[188:191], v[44:47]
    ds_read_b64_tr_b16 v[236:237], v247 offset:30720
    v_mfma_f32_16x16x32_bf16 v[48:51], v[208:211], v[192:195], v[48:51]
    ds_read_b64_tr_b16 v[238:239], v247 offset:45056
    v_mfma_f32_16x16x32_bf16 v[52:55], v[208:211], v[196:199], v[52:55]
    v_mfma_f32_16x16x32_bf16 v[68:71], v[212:215], v[196:199], v[68:71]
    v_mfma_f32_16x16x32_bf16 v[64:67], v[212:215], v[192:195], v[64:67]
    v_mfma_f32_16x16x32_bf16 v[60:63], v[212:215], v[188:191], v[60:63]
    v_mfma_f32_16x16x32_bf16 v[56:59], v[212:215], v[184:187], v[56:59]
    v_mfma_f32_16x16x32_bf16 v[72:75], v[216:219], v[184:187], v[72:75]
    v_mfma_f32_16x16x32_bf16 v[76:79], v[216:219], v[188:191], v[76:79]
    v_mfma_f32_16x16x32_bf16 v[80:83], v[216:219], v[192:195], v[80:83]
    v_mfma_f32_16x16x32_bf16 v[84:87], v[216:219], v[196:199], v[84:87]
    s_waitcnt lgkmcnt(0)
    v_mfma_f32_16x16x32_bf16 v[88:91], v[220:223], v[184:187], v[88:91]
    s_barrier
    v_mfma_f32_16x16x32_bf16 v[92:95], v[220:223], v[188:191], v[92:95]
    ds_read_b128 v[168:171], v240 offset:0
    ds_read_b64_tr_b16 v[200:201], v242 offset:0
    v_mfma_f32_16x16x32_bf16 v[96:99], v[220:223], v[192:195], v[96:99]
    ds_read_b64_tr_b16 v[202:203], v242 offset:14336
    v_mfma_f32_16x16x32_bf16 v[100:103], v[220:223], v[196:199], v[100:103]
    ds_read_b128 v[172:175], v240 offset:1024
    v_mfma_f32_16x16x32_bf16 v[116:119], v[224:227], v[196:199], v[116:119]
    ds_read_b128 v[176:179], v240 offset:7168
    ds_read_b128 v[180:183], v240 offset:8192
    v_mfma_f32_16x16x32_bf16 v[112:115], v[224:227], v[192:195], v[112:115]
    ds_read_b64_tr_b16 v[204:205], v243 offset:0
    v_mfma_f32_16x16x32_bf16 v[108:111], v[224:227], v[188:191], v[108:111]
    ds_read_b64_tr_b16 v[206:207], v243 offset:14336
    v_mfma_f32_16x16x32_bf16 v[104:107], v[224:227], v[184:187], v[104:107]
    ds_read_b64_tr_b16 v[208:209], v244 offset:0
    v_mfma_f32_16x16x32_bf16 v[120:123], v[228:231], v[184:187], v[120:123]
    ds_read_b64_tr_b16 v[210:211], v244 offset:14336
    ds_read_b64_tr_b16 v[212:213], v245 offset:0
    v_mfma_f32_16x16x32_bf16 v[124:127], v[228:231], v[188:191], v[124:127]
    ds_read_b64_tr_b16 v[214:215], v245 offset:14336
    v_mfma_f32_16x16x32_bf16 v[128:131], v[228:231], v[192:195], v[128:131]
    ds_read_b64_tr_b16 v[216:217], v242 offset:1024
    v_mfma_f32_16x16x32_bf16 v[132:135], v[228:231], v[196:199], v[132:135]
    ds_read_b64_tr_b16 v[218:219], v242 offset:15360
    v_mfma_f32_16x16x32_bf16 v[148:151], v[232:235], v[196:199], v[148:151]
    v_mfma_f32_16x16x32_bf16 v[144:147], v[232:235], v[192:195], v[144:147]
    v_mfma_f32_16x16x32_bf16 v[140:143], v[232:235], v[188:191], v[140:143]
    v_mfma_f32_16x16x32_bf16 v[136:139], v[232:235], v[184:187], v[136:139]
    v_mfma_f32_16x16x32_bf16 v[152:155], v[236:239], v[184:187], v[152:155]
    v_mfma_f32_16x16x32_bf16 v[156:159], v[236:239], v[188:191], v[156:159]
    v_mfma_f32_16x16x32_bf16 v[160:163], v[236:239], v[192:195], v[160:163]
    v_mfma_f32_16x16x32_bf16 v[164:167], v[236:239], v[196:199], v[164:167]
    s_sub_u32 s44, s44, 1
    s_cmp_lg_u32 s44, 0
    s_cbranch_scc1 G5_loop
    s_waitcnt lgkmcnt(0)
    s_waitcnt vmcnt(0)
    v_and_b32 v1, 63, v0
    v_lshlrev_b32 v2, 4, v1
    s_lshl_b32 s71, s70, 1
    s_mul_i32 s73, s47, 5
    s_add_u32 s71, s71, s73
    s_lshl_b32 s72, s68, 3
    s_lshl_b32 s73, s46, 2
    s_add_u32 s72, s72, s73
    s_mul_i32 s78, s72, 114688
    s_sub_u32 s73, s71, 34
    s_lshl_b32 s73, s73, 10
    s_add_u32 s78, s78, s73
    s_add_u32 s78, s78, 16777216
    v_mul_f32_e64 v8, v8, |v8|
    v_mul_f32_e64 v9, v9, |v9|
    v_mul_f32_e64 v10, v10, |v10|
    v_mul_f32_e64 v11, v11, |v11|
    v_mul_f32_e64 v24, v24, |v24|
    v_mul_f32_e64 v25, v25, |v25|
    v_mul_f32_e64 v26, v26, |v26|
    v_mul_f32_e64 v27, v27, |v27|
    v_cvt_pk_bf16_f32 v176, v8, v9
    v_cvt_pk_bf16_f32 v177, v10, v11
    v_cvt_pk_bf16_f32 v178, v24, v25
    v_cvt_pk_bf16_f32 v179, v26, v27
    v_pk_max_i16 v176, v176, 0
    v_pk_max_i16 v177, v177, 0
    v_pk_max_i16 v178, v178, 0
    v_pk_max_i16 v179, v179, 0
    v_mul_f32_e64 v12, v12, |v12|
    v_mul_f32_e64 v13, v13, |v13|
    v_mul_f32_e64 v14, v14, |v14|
    v_mul_f32_e64 v15, v15, |v15|
    v_mul_f32_e64 v28, v28, |v28|
    v_mul_f32_e64 v29, v29, |v29|
    v_mul_f32_e64 v30, v30, |v30|
    v_mul_f32_e64 v31, v31, |v31|
    v_cvt_pk_bf16_f32 v180, v12, v13
    v_cvt_pk_bf16_f32 v181, v14, v15
    v_cvt_pk_bf16_f32 v182, v28, v29
    v_cvt_pk_bf16_f32 v183, v30, v31
    v_pk_max_i16 v180, v180, 0
    v_pk_max_i16 v181, v181, 0
    v_pk_max_i16 v182, v182, 0
    v_pk_max_i16 v183, v183, 0
    v_mul_f32_e64 v16, v16, |v16|
    v_mul_f32_e64 v17, v17, |v17|
    v_mul_f32_e64 v18, v18, |v18|
    v_mul_f32_e64 v19, v19, |v19|
    v_mul_f32_e64 v32, v32, |v32|
    v_mul_f32_e64 v33, v33, |v33|
    v_mul_f32_e64 v34, v34, |v34|
    v_mul_f32_e64 v35, v35, |v35|
    v_cvt_pk_bf16_f32 v184, v16, v17
    v_cvt_pk_bf16_f32 v185, v18, v19
    v_cvt_pk_bf16_f32 v186, v32, v33
    v_cvt_pk_bf16_f32 v187, v34, v35
    v_pk_max_i16 v184, v184, 0
    v_pk_max_i16 v185, v185, 0
    v_pk_max_i16 v186, v186, 0
    v_pk_max_i16 v187, v187, 0
    v_mul_f32_e64 v20, v20, |v20|
    v_mul_f32_e64 v21, v21, |v21|
    v_mul_f32_e64 v22, v22, |v22|
    v_mul_f32_e64 v23, v23, |v23|
    v_mul_f32_e64 v36, v36, |v36|
    v_mul_f32_e64 v37, v37, |v37|
    v_mul_f32_e64 v38, v38, |v38|
    v_mul_f32_e64 v39, v39, |v39|
    v_cvt_pk_bf16_f32 v188, v20, v21
    v_cvt_pk_bf16_f32 v189, v22, v23
    v_cvt_pk_bf16_f32 v190, v36, v37
    v_cvt_pk_bf16_f32 v191, v38, v39
    v_pk_max_i16 v188, v188, 0
    v_pk_max_i16 v189, v189, 0
    v_pk_max_i16 v190, v190, 0
    v_pk_max_i16 v191, v191, 0
    v_mul_f32_e64 v40, v40, |v40|
    v_mul_f32_e64 v41, v41, |v41|
    v_mul_f32_e64 v42, v42, |v42|
    v_mul_f32_e64 v43, v43, |v43|
    v_mul_f32_e64 v56, v56, |v56|
    v_mul_f32_e64 v57, v57, |v57|
    v_mul_f32_e64 v58, v58, |v58|
    v_mul_f32_e64 v59, v59, |v59|
    v_cvt_pk_bf16_f32 v192, v40, v41
    v_cvt_pk_bf16_f32 v193, v42, v43
    v_cvt_pk_bf16_f32 v194, v56, v57
    v_cvt_pk_bf16_f32 v195, v58, v59
    v_pk_max_i16 v192, v192, 0
    v_pk_max_i16 v193, v193, 0
    v_pk_max_i16 v194, v194, 0
    v_pk_max_i16 v195, v195, 0
    v_mul_f32_e64 v44, v44, |v44|
    v_mul_f32_e64 v45, v45, |v45|
    v_mul_f32_e64 v46, v46, |v46|
    v_mul_f32_e64 v47, v47, |v47|
    v_mul_f32_e64 v60, v60, |v60|
    v_mul_f32_e64 v61, v61, |v61|
    v_mul_f32_e64 v62, v62, |v62|
    v_mul_f32_e64 v63, v63, |v63|
    v_cvt_pk_bf16_f32 v196, v44, v45
    v_cvt_pk_bf16_f32 v197, v46, v47
    v_cvt_pk_bf16_f32 v198, v60, v61
    v_cvt_pk_bf16_f32 v199, v62, v63
    v_pk_max_i16 v196, v196, 0
    v_pk_max_i16 v197, v197, 0
    v_pk_max_i16 v198, v198, 0
    v_pk_max_i16 v199, v199, 0
    v_mul_f32_e64 v48, v48, |v48|
    v_mul_f32_e64 v49, v49, |v49|
    v_mul_f32_e64 v50, v50, |v50|
    v_mul_f32_e64 v51, v51, |v51|
    v_mul_f32_e64 v64, v64, |v64|
    v_mul_f32_e64 v65, v65, |v65|
    v_mul_f32_e64 v66, v66, |v66|
    v_mul_f32_e64 v67, v67, |v67|
    v_cvt_pk_bf16_f32 v200, v48, v49
    v_cvt_pk_bf16_f32 v201, v50, v51
    v_cvt_pk_bf16_f32 v202, v64, v65
    v_cvt_pk_bf16_f32 v203, v66, v67
    v_pk_max_i16 v200, v200, 0
    v_pk_max_i16 v201, v201, 0
    v_pk_max_i16 v202, v202, 0
    v_pk_max_i16 v203, v203, 0
    v_mul_f32_e64 v52, v52, |v52|
    v_mul_f32_e64 v53, v53, |v53|
    v_mul_f32_e64 v54, v54, |v54|
    v_mul_f32_e64 v55, v55, |v55|
    v_mul_f32_e64 v68, v68, |v68|
    v_mul_f32_e64 v69, v69, |v69|
    v_mul_f32_e64 v70, v70, |v70|
    v_mul_f32_e64 v71, v71, |v71|
    v_cvt_pk_bf16_f32 v204, v52, v53
    v_cvt_pk_bf16_f32 v205, v54, v55
    v_cvt_pk_bf16_f32 v206, v68, v69
    v_cvt_pk_bf16_f32 v207, v70, v71
    v_pk_max_i16 v204, v204, 0
    v_pk_max_i16 v205, v205, 0
    v_pk_max_i16 v206, v206, 0
    v_pk_max_i16 v207, v207, 0
    v_mul_f32_e64 v72, v72, |v72|
    v_mul_f32_e64 v73, v73, |v73|
    v_mul_f32_e64 v74, v74, |v74|
    v_mul_f32_e64 v75, v75, |v75|
    v_mul_f32_e64 v88, v88, |v88|
    v_mul_f32_e64 v89, v89, |v89|
    v_mul_f32_e64 v90, v90, |v90|
    v_mul_f32_e64 v91, v91, |v91|
    v_cvt_pk_bf16_f32 v208, v72, v73
    v_cvt_pk_bf16_f32 v209, v74, v75
    v_cvt_pk_bf16_f32 v210, v88, v89
    v_cvt_pk_bf16_f32 v211, v90, v91
    v_pk_max_i16 v208, v208, 0
    v_pk_max_i16 v209, v209, 0
    v_pk_max_i16 v210, v210, 0
    v_pk_max_i16 v211, v211, 0
    v_mul_f32_e64 v76, v76, |v76|
    v_mul_f32_e64 v77, v77, |v77|
    v_mul_f32_e64 v78, v78, |v78|
    v_mul_f32_e64 v79, v79, |v79|
    v_mul_f32_e64 v92, v92, |v92|
    v_mul_f32_e64 v93, v93, |v93|
    v_mul_f32_e64 v94, v94, |v94|
    v_mul_f32_e64 v95, v95, |v95|
    v_cvt_pk_bf16_f32 v212, v76, v77
    v_cvt_pk_bf16_f32 v213, v78, v79
    v_cvt_pk_bf16_f32 v214, v92, v93
    v_cvt_pk_bf16_f32 v215, v94, v95
    v_pk_max_i16 v212, v212, 0
    v_pk_max_i16 v213, v213, 0
    v_pk_max_i16 v214, v214, 0
    v_pk_max_i16 v215, v215, 0
    v_mul_f32_e64 v80, v80, |v80|
    v_mul_f32_e64 v81, v81, |v81|
    v_mul_f32_e64 v82, v82, |v82|
    v_mul_f32_e64 v83, v83, |v83|
    v_mul_f32_e64 v96, v96, |v96|
    v_mul_f32_e64 v97, v97, |v97|
    v_mul_f32_e64 v98, v98, |v98|
    v_mul_f32_e64 v99, v99, |v99|
    v_cvt_pk_bf16_f32 v216, v80, v81
    v_cvt_pk_bf16_f32 v217, v82, v83
    v_cvt_pk_bf16_f32 v218, v96, v97
    v_cvt_pk_bf16_f32 v219, v98, v99
    v_pk_max_i16 v216, v216, 0
    v_pk_max_i16 v217, v217, 0
    v_pk_max_i16 v218, v218, 0
    v_pk_max_i16 v219, v219, 0
    v_mul_f32_e64 v84, v84, |v84|
    v_mul_f32_e64 v85, v85, |v85|
    v_mul_f32_e64 v86, v86, |v86|
    v_mul_f32_e64 v87, v87, |v87|
    v_mul_f32_e64 v100, v100, |v100|
    v_mul_f32_e64 v101, v101, |v101|
    v_mul_f32_e64 v102, v102, |v102|
    v_mul_f32_e64 v103, v103, |v103|
    v_cvt_pk_bf16_f32 v220, v84, v85
    v_cvt_pk_bf16_f32 v221, v86, v87
    v_cvt_pk_bf16_f32 v222, v100, v101
    v_cvt_pk_bf16_f32 v223, v102, v103
    v_pk_max_i16 v220, v220, 0
    v_pk_max_i16 v221, v221, 0
    v_pk_max_i16 v222, v222, 0
    v_pk_max_i16 v223, v223, 0
    v_mul_f32_e64 v104, v104, |v104|
    v_mul_f32_e64 v105, v105, |v105|
    v_mul_f32_e64 v106, v106, |v106|
    v_mul_f32_e64 v107, v107, |v107|
    v_mul_f32_e64 v120, v120, |v120|
    v_mul_f32_e64 v121, v121, |v121|
    v_mul_f32_e64 v122, v122, |v122|
    v_mul_f32_e64 v123, v123, |v123|
    v_cvt_pk_bf16_f32 v224, v104, v105
    v_cvt_pk_bf16_f32 v225, v106, v107
    v_cvt_pk_bf16_f32 v226, v120, v121
    v_cvt_pk_bf16_f32 v227, v122, v123
    v_pk_max_i16 v224, v224, 0
    v_pk_max_i16 v225, v225, 0
    v_pk_max_i16 v226, v226, 0
    v_pk_max_i16 v227, v227, 0
    v_mul_f32_e64 v108, v108, |v108|
    v_mul_f32_e64 v109, v109, |v109|
    v_mul_f32_e64 v110, v110, |v110|
    v_mul_f32_e64 v111, v111, |v111|
    v_mul_f32_e64 v124, v124, |v124|
    v_mul_f32_e64 v125, v125, |v125|
    v_mul_f32_e64 v126, v126, |v126|
    v_mul_f32_e64 v127, v127, |v127|
    v_cvt_pk_bf16_f32 v228, v108, v109
    v_cvt_pk_bf16_f32 v229, v110, v111
    v_cvt_pk_bf16_f32 v230, v124, v125
    v_cvt_pk_bf16_f32 v231, v126, v127
    v_pk_max_i16 v228, v228, 0
    v_pk_max_i16 v229, v229, 0
    v_pk_max_i16 v230, v230, 0
    v_pk_max_i16 v231, v231, 0
    v_mul_f32_e64 v112, v112, |v112|
    v_mul_f32_e64 v113, v113, |v113|
    v_mul_f32_e64 v114, v114, |v114|
    v_mul_f32_e64 v115, v115, |v115|
    v_mul_f32_e64 v128, v128, |v128|
    v_mul_f32_e64 v129, v129, |v129|
    v_mul_f32_e64 v130, v130, |v130|
    v_mul_f32_e64 v131, v131, |v131|
    v_cvt_pk_bf16_f32 v232, v112, v113
    v_cvt_pk_bf16_f32 v233, v114, v115
    v_cvt_pk_bf16_f32 v234, v128, v129
    v_cvt_pk_bf16_f32 v235, v130, v131
    v_pk_max_i16 v232, v232, 0
    v_pk_max_i16 v233, v233, 0
    v_pk_max_i16 v234, v234, 0
    v_pk_max_i16 v235, v235, 0
    v_mul_f32_e64 v116, v116, |v116|
    v_mul_f32_e64 v117, v117, |v117|
    v_mul_f32_e64 v118, v118, |v118|
    v_mul_f32_e64 v119, v119, |v119|
    v_mul_f32_e64 v132, v132, |v132|
    v_mul_f32_e64 v133, v133, |v133|
    v_mul_f32_e64 v134, v134, |v134|
    v_mul_f32_e64 v135, v135, |v135|
    v_cvt_pk_bf16_f32 v236, v116, v117
    v_cvt_pk_bf16_f32 v237, v118, v119
    v_cvt_pk_bf16_f32 v238, v132, v133
    v_cvt_pk_bf16_f32 v239, v134, v135
    v_pk_max_i16 v236, v236, 0
    v_pk_max_i16 v237, v237, 0
    v_pk_max_i16 v238, v238, 0
    v_pk_max_i16 v239, v239, 0
    v_mul_f32_e64 v136, v136, |v136|
    v_mul_f32_e64 v137, v137, |v137|
    v_mul_f32_e64 v138, v138, |v138|
    v_mul_f32_e64 v139, v139, |v139|
    v_mul_f32_e64 v152, v152, |v152|
    v_mul_f32_e64 v153, v153, |v153|
    v_mul_f32_e64 v154, v154, |v154|
    v_mul_f32_e64 v155, v155, |v155|
    v_cvt_pk_bf16_f32 v240, v136, v137
    v_cvt_pk_bf16_f32 v241, v138, v139
    v_cvt_pk_bf16_f32 v242, v152, v153
    v_cvt_pk_bf16_f32 v243, v154, v155
    v_pk_max_i16 v240, v240, 0
    v_pk_max_i16 v241, v241, 0
    v_pk_max_i16 v242, v242, 0
    v_pk_max_i16 v243, v243, 0
    v_mul_f32_e64 v140, v140, |v140|
    v_mul_f32_e64 v141, v141, |v141|
    v_mul_f32_e64 v142, v142, |v142|
    v_mul_f32_e64 v143, v143, |v143|
    v_mul_f32_e64 v156, v156, |v156|
    v_mul_f32_e64 v157, v157, |v157|
    v_mul_f32_e64 v158, v158, |v158|
    v_mul_f32_e64 v159, v159, |v159|
    v_cvt_pk_bf16_f32 v244, v140, v141
    v_cvt_pk_bf16_f32 v245, v142, v143
    v_cvt_pk_bf16_f32 v246, v156, v157
    v_cvt_pk_bf16_f32 v247, v158, v159
    v_pk_max_i16 v244, v244, 0
    v_pk_max_i16 v245, v245, 0
    v_pk_max_i16 v246, v246, 0
    v_pk_max_i16 v247, v247, 0
    v_mul_f32_e64 v144, v144, |v144|
    v_mul_f32_e64 v145, v145, |v145|
    v_mul_f32_e64 v146, v146, |v146|
    v_mul_f32_e64 v147, v147, |v147|
    v_mul_f32_e64 v160, v160, |v160|
    v_mul_f32_e64 v161, v161, |v161|
    v_mul_f32_e64 v162, v162, |v162|
    v_mul_f32_e64 v163, v163, |v163|
    v_cvt_pk_bf16_f32 v248, v144, v145
    v_cvt_pk_bf16_f32 v249, v146, v147
    v_cvt_pk_bf16_f32 v250, v160, v161
    v_cvt_pk_bf16_f32 v251, v162, v163
    v_pk_max_i16 v248, v248, 0
    v_pk_max_i16 v249, v249, 0
    v_pk_max_i16 v250, v250, 0
    v_pk_max_i16 v251, v251, 0
    v_mul_f32_e64 v148, v148, |v148|
    v_mul_f32_e64 v149, v149, |v149|
    v_mul_f32_e64 v150, v150, |v150|
    v_mul_f32_e64 v151, v151, |v151|
    v_mul_f32_e64 v164, v164, |v164|
    v_mul_f32_e64 v165, v165, |v165|
    v_mul_f32_e64 v166, v166, |v166|
    v_mul_f32_e64 v167, v167, |v167|
    v_cvt_pk_bf16_f32 v252, v148, v149
    v_cvt_pk_bf16_f32 v253, v150, v151
    v_cvt_pk_bf16_f32 v254, v164, v165
    v_cvt_pk_bf16_f32 v255, v166, v167
    v_pk_max_i16 v252, v252, 0
    v_pk_max_i16 v253, v253, 0
    v_pk_max_i16 v254, v254, 0
    v_pk_max_i16 v255, v255, 0
G5_join:
    s_add_u32 s59, s68, 32
    s_lshl_b32 s59, s59, 7
    s_cmp_eq_u32 s48, 0
    s_cselect_b32 s66, s66, 0
    s_cselect_b32 s68, s78, 0
    s_mov_b32 s47, -1
    s_branch G1_end
G4_entry:
    s_cmp_eq_u32 s48, 0
    s_cbranch_scc1 G4_compute
    s_lshl_b32 s71, s68, 3
    s_lshl_b32 s72, s45, 1
    s_add_u32 s71, s71, s72
    s_lshl_b32 s71, s71, 15
    s_add_u32 s71, s71, 0
    s_add_u32 s8, s58, s71
    s_addc_u32 s72, s59, 0
    s_and_b32 s9, s72, 0xffff
    s_mov_b32 s10, 65536
    s_mov_b32 s11, 0x00020000
    s_add_u32 s71, s70, 0
    s_sub_u32 s72, s71, 17
    s_cmp_lt_u32 s71, 16
    s_cselect_b32 s72, s71, s72
    s_cselect_b32 s12, s56, s52
    s_cselect_b32 s73, s57, s53
    s_cselect_b32 s32, 2, 7
    s_lshl_b32 s74, s32, 20
    s_lshl_b32 s32, s32, 10
    s_lshl_b32 s72, s72, 7
    s_sub_u32 s74, s74, s72
    s_cmp_eq_u32 s71, 16
    s_cselect_b32 s12, s58, s12
    s_cselect_b32 s73, s59, s73
    s_cselect_b32 s72, 9437184, s72
    s_cselect_b32 s74, 131072, s74
    s_cselect_b32 s32, 128, s32
    s_add_u32 s12, s12, s72
    s_addc_u32 s73, s73, 0
    s_and_b32 s13, s73, 0xffff
    s_mov_b32 s14, s74
    s_mov_b32 s15, 0x00020000
    s_add_u32 s71, s70, 1
    s_sub_u32 s72, s71, 17
    s_cmp_lt_u32 s71, 16
    s_cselect_b32 s72, s71, s72
    s_cselect_b32 s16, s56, s52
    s_cselect_b32 s73, s57, s53
    s_cselect_b32 s33, 2, 7
    s_lshl_b32 s74, s33, 20
    s_lshl_b32 s33, s33, 10
    s_lshl_b32 s72, s72, 7
    s_sub_u32 s74, s74, s72
    s_add_u32 s16, s16, s72
    s_addc_u32 s73, s73, 0
    s_and_b32 s17, s73, 0xffff
    s_mov_b32 s18, s74
    s_mov_b32 s19, 0x00020000
    s_add_u32 s71, s70, 2
    s_sub_u32 s72, s71, 17
    s_cmp_lt_u32 s71, 16
    s_cselect_b32 s72, s71, s72
    s_cselect_b32 s20, s56, s52
    s_cselect_b32 s73, s57, s53
    s_cselect_b32 s34, 2, 7
    s_lshl_b32 s74, s34, 20
    s_lshl_b32 s34, s34, 10
    s_lshl_b32 s72, s72, 7
    s_sub_u32 s74, s74, s72
    s_add_u32 s20, s20, s72
    s_addc_u32 s73, s73, 0
    s_and_b32 s21, s73, 0xffff
    s_mov_b32 s22, s74
    s_mov_b32 s23, 0x00020000
    s_add_u32 s71, s70, 3
    s_sub_u32 s72, s71, 17
    s_cmp_lt_u32 s71, 16
    s_cselect_b32 s72, s71, s72
    s_cselect_b32 s24, s56, s52
    s_cselect_b32 s73, s57, s53
    s_cselect_b32 s35, 2, 7
    s_lshl_b32 s74, s35, 20
    s_lshl_b32 s35, s35, 10
    s_lshl_b32 s72, s72, 7
    s_sub_u32 s74, s74, s72
    s_add_u32 s24, s24, s72
    s_addc_u32 s73, s73, 0
    s_and_b32 s25, s73, 0xffff
    s_mov_b32 s26, s74
    s_mov_b32 s27, 0x00020000
    v_and_b32 v1, 63, v0
    v_lshrrev_b32 v2, 3, v1
    v_and_b32 v3, 7, v1
    v_bfe_u32 v4, v1, 4, 2
    v_lshlrev_b32 v4, 1, v4
    v_xor_b32 v3, v3, v4
    v_lshlrev_b32 v3, 4, v3
    s_lshl_b32 s49, s45, 3
    v_add_u32 v2, s49, v2
    v_lshlrev_b32 v8, 4, v1
    v_add_u32 v9, 32768, v8
    v_mul_lo_u32 v10, v2, s32
    v_add_u32 v10, v10, v3
    v_mul_lo_u32 v11, v2, s33
    v_add_u32 v11, v11, v3
    v_mul_lo_u32 v12, v2, s34
    v_add_u32 v12, v12, v3
    v_mul_lo_u32 v13, v2, s35
    v_add_u32 v13, v13, v3
    s_lshl_b32 s32, s32, 5
    s_mov_b32 s28, 0
    s_lshl_b32 s33, s33, 5
    s_mov_b32 s29, 0
    s_lshl_b32 s34, s34, 5
    s_mov_b32 s30, 0
    s_lshl_b32 s35, s35, 5
    s_mov_b32 s31, 0
    s_mov_b32 s36, 0
    s_mul_i32 s37, s45, 6144
    s_add_u32 s37, s37, 16384
    s_add_u32 m0, s37, 0
    s_nop 0
    buffer_load_dwordx4 v8, s[8:11], s36 offen lds
    s_add_u32 m0, s37, 1024
    s_nop 0
    buffer_load_dwordx4 v9, s[8:11], s36 offen lds
    s_add_u32 s36, s36, 1024
    s_add_u32 m0, s37, 2048
    s_nop 0
    buffer_load_dwordx4 v10, s[12:15], s28 offen lds
    s_add_u32 s28, s28, s32
    s_add_u32 m0, s37, 3072
    s_nop 0
    buffer_load_dwordx4 v11, s[16:19], s29 offen lds
    s_add_u32 s29, s29, s33
    s_add_u32 m0, s37, 4096
    s_nop 0
    buffer_load_dwordx4 v12, s[20:23], s30 offen lds
    s_add_u32 s30, s30, s34
    s_add_u32 m0, s37, 5120
    s_nop 0
    buffer_load_dwordx4 v13, s[24:27], s31 offen lds
    s_add_u32 s31, s31, s35
    s_add_u32 m0, s37, 24576
    s_nop 0
    buffer_load_dwordx4 v8, s[8:11], s36 offen lds
    s_add_u32 m0, s37, 25600
    s_nop 0
    buffer_load_dwordx4 v9, s[8:11], s36 offen lds
    s_add_u32 s36, s36, 1024
    s_add_u32 m0, s37, 26624
    s_nop 0
    buffer_load_dwordx4 v10, s[12:15], s28 offen lds
    s_add_u32 s28, s28, s32
    s_add_u32 m0, s37, 27648
    s_nop 0
    buffer_load_dwordx4 v11, s[16:19], s29 offen lds
    s_add_u32 s29, s29, s33
    s_add_u32 m0, s37, 28672
    s_nop 0
    buffer_load_dwordx4 v12, s[20:23], s30 offen lds
    s_add_u32 s30, s30, s34
    s_add_u32 m0, s37, 29696
    s_nop 0
    buffer_load_dwordx4 v13, s[24:27], s31 offen lds
    s_add_u32 s31, s31, s35
    s_add_u32 m0, s37, 49152
    s_nop 0
    buffer_load_dwordx4 v8, s[8:11], s36 offen lds
    s_add_u32 m0, s37, 50176
    s_nop 0
    buffer_load_dwordx4 v9, s[8:11], s36 offen lds
    s_add_u32 s36, s36, 1024
    s_add_u32 m0, s37, 51200
    s_nop 0
    buffer_load_dwordx4 v10, s[12:15], s28 offen lds
    s_add_u32 s28, s28, s32
    s_add_u32 m0, s37, 52224
    s_nop 0
    buffer_load_dwordx4 v11, s[16:19], s29 offen lds
    s_add_u32 s29, s29, s33
    s_add_u32 m0, s37, 53248
    s_nop 0
    buffer_load_dwordx4 v12, s[20:23], s30 offen lds
    s_add_u32 s30, s30, s34
    s_add_u32 m0, s37, 54272
    s_nop 0
    buffer_load_dwordx4 v13, s[24:27], s31 offen lds
    s_add_u32 s31, s31, s35
    s_add_u32 m0, s37, 73728
    s_nop 0
    buffer_load_dwordx4 v8, s[8:11], s36 offen lds
    s_add_u32 m0, s37, 74752
    s_nop 0
    buffer_load_dwordx4 v9, s[8:11], s36 offen lds
    s_add_u32 s36, s36, 1024
    s_add_u32 m0, s37, 75776
    s_nop 0
    buffer_load_dwordx4 v10, s[12:15], s28 offen lds
    s_add_u32 s28, s28, s32
    s_add_u32 m0, s37, 76800
    s_nop 0
    buffer_load_dwordx4 v11, s[16:19], s29 offen lds
    s_add_u32 s29, s29, s33
    s_add_u32 m0, s37, 77824
    s_nop 0
    buffer_load_dwordx4 v12, s[20:23], s30 offen lds
    s_add_u32 s30, s30, s34
    s_add_u32 m0, s37, 78848
    s_nop 0
    buffer_load_dwordx4 v13, s[24:27], s31 offen lds
    s_add_u32 s31, s31, s35
    s_waitcnt vmcnt(18)
    s_barrier
    s_mov_b32 s38, 8
G4_lloop:
    s_waitcnt vmcnt(12)
    s_barrier
    s_add_u32 m0, s37, 0
    s_nop 0
    buffer_load_dwordx4 v8, s[8:11], s36 offen lds
    s_add_u32 m0, s37, 1024
    s_nop 0
    buffer_load_dwordx4 v9, s[8:11], s36 offen lds
    s_add_u32 s36, s36, 1024
    s_add_u32 m0, s37, 2048
    s_nop 0
    buffer_load_dwordx4 v10, s[12:15], s28 offen lds
    s_add_u32 s28, s28, s32
    s_add_u32 m0, s37, 3072
    s_nop 0
    buffer_load_dwordx4 v11, s[16:19], s29 offen lds
    s_add_u32 s29, s29, s33
    s_add_u32 m0, s37, 4096
    s_nop 0
    buffer_load_dwordx4 v12, s[20:23], s30 offen lds
    s_add_u32 s30, s30, s34
    s_add_u32 m0, s37, 5120
    s_nop 0
    buffer_load_dwordx4 v13, s[24:27], s31 offen lds
    s_add_u32 s31, s31, s35
    s_waitcnt vmcnt(12)
    s_barrier
    s_add_u32 m0, s37, 24576
    s_nop 0
    buffer_load_dwordx4 v8, s[8:11], s36 offen lds
    s_add_u32 m0, s37, 25600
    s_nop 0
    buffer_load_dwordx4 v9, s[8:11], s36 offen lds
    s_add_u32 s36, s36, 1024
    s_add_u32 m0, s37, 26624
    s_nop 0
    buffer_load_dwordx4 v10, s[12:15], s28 offen lds
    s_add_u32 s28, s28, s32
    s_add_u32 m0, s37, 27648
    s_nop 0
    buffer_load_dwordx4 v11, s[16:19], s29 offen lds
    s_add_u32 s29, s29, s33
    s_add_u32 m0, s37, 28672
    s_nop 0
    buffer_load_dwordx4 v12, s[20:23], s30 offen lds
    s_add_u32 s30, s30, s34
    s_add_u32 m0, s37, 29696
    s_nop 0
    buffer_load_dwordx4 v13, s[24:27], s31 offen lds
    s_add_u32 s31, s31, s35
    s_waitcnt vmcnt(12)
    s_barrier
    s_add_u32 m0, s37, 49152
    s_nop 0
    buffer_load_dwordx4 v8, s[8:11], s36 offen lds
    s_add_u32 m0, s37, 50176
    s_nop 0
    buffer_load_dwordx4 v9, s[8:11], s36 offen lds
    s_add_u32 s36, s36, 1024
    s_add_u32 m0, s37, 51200
    s_nop 0
    buffer_load_dwordx4 v10, s[12:15], s28 offen lds
    s_add_u32 s28, s28, s32
    s_add_u32 m0, s37, 52224
    s_nop 0
    buffer_load_dwordx4 v11, s[16:19], s29 offen lds
    s_add_u32 s29, s29, s33
    s_add_u32 m0, s37, 53248
    s_nop 0
    buffer_load_dwordx4 v12, s[20:23], s30 offen lds
    s_add_u32 s30, s30, s34
    s_add_u32 m0, s37, 54272
    s_nop 0
    buffer_load_dwordx4 v13, s[24:27], s31 offen lds
    s_add_u32 s31, s31, s35
    s_waitcnt vmcnt(12)
    s_barrier
    s_add_u32 m0, s37, 73728
    s_nop 0
    buffer_load_dwordx4 v8, s[8:11], s36 offen lds
    s_add_u32 m0, s37, 74752
    s_nop 0
    buffer_load_dwordx4 v9, s[8:11], s36 offen lds
    s_add_u32 s36, s36, 1024
    s_add_u32 m0, s37, 75776
    s_nop 0
    buffer_load_dwordx4 v10, s[12:15], s28 offen lds
    s_add_u32 s28, s28, s32
    s_add_u32 m0, s37, 76800
    s_nop 0
    buffer_load_dwordx4 v11, s[16:19], s29 offen lds
    s_add_u32 s29, s29, s33
    s_add_u32 m0, s37, 77824
    s_nop 0
    buffer_load_dwordx4 v12, s[20:23], s30 offen lds
    s_add_u32 s30, s30, s34
    s_add_u32 m0, s37, 78848
    s_nop 0
    buffer_load_dwordx4 v13, s[24:27], s31 offen lds
    s_add_u32 s31, s31, s35
    s_sub_u32 s38, s38, 1
    s_cmp_lg_u32 s38, 0
    s_cbranch_scc1 G4_lloop
    s_waitcnt vmcnt(0)
    s_branch G4_join
G4_compute:
    v_bfe_u32 v1, v0, 4, 2
    v_lshlrev_b32 v1, 3, v1
    s_lshl_b32 s71, s70, 1
    s_mul_i32 s72, s47, 4
    s_add_u32 s71, s71, s72
    s_sub_u32 s71, s71, 34
    s_mov_b32 s60, s54
    s_and_b32 s61, s55, 0xffff
    s_mov_b32 s62, 7168
    s_mov_b32 s63, 0x00020000
    s_add_u32 s73, s71, 0
    s_lshl_b32 s72, s73, 6
    s_cmp_lt_u32 s73, 112
    s_cselect_b32 s72, s72, 0x100000
    buffer_load_dwordx2 v[136:137], v1, s[60:63], s72 offen
    buffer_load_dwordx2 v[138:139], v1, s[60:63], s72 offen offset:32
    s_add_u32 s73, s71, 1
    s_lshl_b32 s72, s73, 6
    s_cmp_lt_u32 s73, 112
    s_cselect_b32 s72, s72, 0x100000
    buffer_load_dwordx2 v[140:141], v1, s[60:63], s72 offen
    buffer_load_dwordx2 v[142:143], v1, s[60:63], s72 offen offset:32
    s_add_u32 s73, s71, 2
    s_lshl_b32 s72, s73, 6
    s_cmp_lt_u32 s73, 112
    s_cselect_b32 s72, s72, 0x100000
    buffer_load_dwordx2 v[144:145], v1, s[60:63], s72 offen
    buffer_load_dwordx2 v[146:147], v1, s[60:63], s72 offen offset:32
    s_add_u32 s73, s71, 3
    s_lshl_b32 s72, s73, 6
    s_cmp_lt_u32 s73, 112
    s_cselect_b32 s72, s72, 0x100000
    buffer_load_dwordx2 v[148:149], v1, s[60:63], s72 offen
    buffer_load_dwordx2 v[150:151], v1, s[60:63], s72 offen offset:32
    v_and_b32 v1, 63, v0
    v_lshrrev_b32 v2, 5, v1
    v_mul_u32_u24 v4, 6144, v2
    v_bfe_u32 v3, v1, 2, 3
    v_lshl_add_u32 v4, v3, 7, v4
    v_and_b32 v6, 3, v1
    v_lshl_add_u32 v4, v6, 3, v4
    v_lshrrev_b32 v5, 1, v3
    s_mul_i32 s49, s47, 8
    s_add_u32 s49, s49, 0
    s_lshr_b32 s50, s49, 2
    s_lshl_b32 s50, s50, 10
    s_add_u32 s50, s50, 18432
    s_and_b32 s49, s49, 3
    v_xor_b32 v6, s49, v5
    v_lshl_add_u32 v6, v6, 5, v4
    v_add_u32 v202, s50, v6
    v_add_u32 v206, s50, v6
    v_add_u32 v206, 49152, v206
    s_mul_i32 s49, s47, 8
    s_add_u32 s49, s49, 1
    s_lshr_b32 s50, s49, 2
    s_lshl_b32 s50, s50, 10
    s_add_u32 s50, s50, 18432
    s_and_b32 s49, s49, 3
    v_xor_b32 v6, s49, v5
    v_lshl_add_u32 v6, v6, 5, v4
    v_add_u32 v203, s50, v6
    v_add_u32 v207, s50, v6
    v_add_u32 v207, 49152, v207
    s_mul_i32 s49, s47, 8
    s_add_u32 s49, s49, 2
    s_lshr_b32 s50, s49, 2
    s_lshl_b32 s50, s50, 10
    s_add_u32 s50, s50, 18432
    s_and_b32 s49, s49, 3
    v_xor_b32 v6, s49, v5
    v_lshl_add_u32 v6, v6, 5, v4
    v_add_u32 v204, s50, v6
    v_add_u32 v208, s50, v6
    v_add_u32 v208, 49152, v208
    s_mul_i32 s49, s47, 8
    s_add_u32 s49, s49, 3
    s_lshr_b32 s50, s49, 2
    s_lshl_b32 s50, s50, 10
    s_add_u32 s50, s50, 18432
    s_and_b32 s49, s49, 3
    v_xor_b32 v6, s49, v5
    v_lshl_add_u32 v6, v6, 5, v4
    v_add_u32 v205, s50, v6
    v_add_u32 v209, s50, v6
    v_add_u32 v209, 49152, v209
    s_mul_i32 s49, s46, 12288
    s_add_u32 s49, s49, 16384
    v_lshlrev_b32 v6, 4, v1
    v_add_u32 v200, s49, v6
    v_add_u32 v201, s49, v6
    v_add_u32 v201, 49152, v201
    s_waitcnt vmcnt(0)
    v_lshlrev_b32 v8, 16, v136
    v_and_b32 v9, 0xffff0000, v136
    v_lshlrev_b32 v10, 16, v137
    v_and_b32 v11, 0xffff0000, v137
    v_pk_mov_b32 v[12:13], v[8:9], v[8:9] op_sel:[0,1]
    v_pk_mov_b32 v[14:15], v[10:11], v[10:11] op_sel:[0,1]
    v_pk_mov_b32 v[16:17], v[8:9], v[8:9] op_sel:[0,1]
    v_pk_mov_b32 v[18:19], v[10:11], v[10:11] op_sel:[0,1]
    v_pk_mov_b32 v[20:21], v[8:9], v[8:9] op_sel:[0,1]
    v_pk_mov_b32 v[22:23], v[10:11], v[10:11] op_sel:[0,1]
    v_lshlrev_b32 v24, 16, v138
    v_and_b32 v25, 0xffff0000, v138
    v_lshlrev_b32 v26, 16, v139
    v_and_b32 v27, 0xffff0000, v139
    v_pk_mov_b32 v[28:29], v[24:25], v[24:25] op_sel:[0,1]
    v_pk_mov_b32 v[30:31], v[26:27], v[26:27] op_sel:[0,1]
    v_pk_mov_b32 v[32:33], v[24:25], v[24:25] op_sel:[0,1]
    v_pk_mov_b32 v[34:35], v[26:27], v[26:27] op_sel:[0,1]
    v_pk_mov_b32 v[36:37], v[24:25], v[24:25] op_sel:[0,1]
    v_pk_mov_b32 v[38:39], v[26:27], v[26:27] op_sel:[0,1]
    v_lshlrev_b32 v40, 16, v140
    v_and_b32 v41, 0xffff0000, v140
    v_lshlrev_b32 v42, 16, v141
    v_and_b32 v43, 0xffff0000, v141
    v_pk_mov_b32 v[44:45], v[40:41], v[40:41] op_sel:[0,1]
    v_pk_mov_b32 v[46:47], v[42:43], v[42:43] op_sel:[0,1]
    v_pk_mov_b32 v[48:49], v[40:41], v[40:41] op_sel:[0,1]
    v_pk_mov_b32 v[50:51], v[42:43], v[42:43] op_sel:[0,1]
    v_pk_mov_b32 v[52:53], v[40:41], v[40:41] op_sel:[0,1]
    v_pk_mov_b32 v[54:55], v[42:43], v[42:43] op_sel:[0,1]
    v_lshlrev_b32 v56, 16, v142
    v_and_b32 v57, 0xffff0000, v142
    v_lshlrev_b32 v58, 16, v143
    v_and_b32 v59, 0xffff0000, v143
    v_pk_mov_b32 v[60:61], v[56:57], v[56:57] op_sel:[0,1]
    v_pk_mov_b32 v[62:63], v[58:59], v[58:59] op_sel:[0,1]
    v_pk_mov_b32 v[64:65], v[56:57], v[56:57] op_sel:[0,1]
    v_pk_mov_b32 v[66:67], v[58:59], v[58:59] op_sel:[0,1]
    v_pk_mov_b32 v[68:69], v[56:57], v[56:57] op_sel:[0,1]
    v_pk_mov_b32 v[70:71], v[58:59], v[58:59] op_sel:[0,1]
    v_lshlrev_b32 v72, 16, v144
    v_and_b32 v73, 0xffff0000, v144
    v_lshlrev_b32 v74, 16, v145
    v_and_b32 v75, 0xffff0000, v145
    v_pk_mov_b32 v[76:77], v[72:73], v[72:73] op_sel:[0,1]
    v_pk_mov_b32 v[78:79], v[74:75], v[74:75] op_sel:[0,1]
    v_pk_mov_b32 v[80:81], v[72:73], v[72:73] op_sel:[0,1]
    v_pk_mov_b32 v[82:83], v[74:75], v[74:75] op_sel:[0,1]
    v_pk_mov_b32 v[84:85], v[72:73], v[72:73] op_sel:[0,1]
    v_pk_mov_b32 v[86:87], v[74:75], v[74:75] op_sel:[0,1]
    v_lshlrev_b32 v88, 16, v146
    v_and_b32 v89, 0xffff0000, v146
    v_lshlrev_b32 v90, 16, v147
    v_and_b32 v91, 0xffff0000, v147
    v_pk_mov_b32 v[92:93], v[88:89], v[88:89] op_sel:[0,1]
    v_pk_mov_b32 v[94:95], v[90:91], v[90:91] op_sel:[0,1]
    v_pk_mov_b32 v[96:97], v[88:89], v[88:89] op_sel:[0,1]
    v_pk_mov_b32 v[98:99], v[90:91], v[90:91] op_sel:[0,1]
    v_pk_mov_b32 v[100:101], v[88:89], v[88:89] op_sel:[0,1]
    v_pk_mov_b32 v[102:103], v[90:91], v[90:91] op_sel:[0,1]
    v_lshlrev_b32 v104, 16, v148
    v_and_b32 v105, 0xffff0000, v148
    v_lshlrev_b32 v106, 16, v149
    v_and_b32 v107, 0xffff0000, v149
    v_pk_mov_b32 v[108:109], v[104:105], v[104:105] op_sel:[0,1]
    v_pk_mov_b32 v[110:111], v[106:107], v[106:107] op_sel:[0,1]
    v_pk_mov_b32 v[112:113], v[104:105], v[104:105] op_sel:[0,1]
    v_pk_mov_b32 v[114:115], v[106:107], v[106:107] op_sel:[0,1]
    v_pk_mov_b32 v[116:117], v[104:105], v[104:105] op_sel:[0,1]
    v_pk_mov_b32 v[118:119], v[106:107], v[106:107] op_sel:[0,1]
    v_lshlrev_b32 v120, 16, v150
    v_and_b32 v121, 0xffff0000, v150
    v_lshlrev_b32 v122, 16, v151
    v_and_b32 v123, 0xffff0000, v151
    v_pk_mov_b32 v[124:125], v[120:121], v[120:121] op_sel:[0,1]
    v_pk_mov_b32 v[126:127], v[122:123], v[122:123] op_sel:[0,1]
    v_pk_mov_b32 v[128:129], v[120:121], v[120:121] op_sel:[0,1]
    v_pk_mov_b32 v[130:131], v[122:123], v[122:123] op_sel:[0,1]
    v_pk_mov_b32 v[132:133], v[120:121], v[120:121] op_sel:[0,1]
    v_pk_mov_b32 v[134:135], v[122:123], v[122:123] op_sel:[0,1]
    s_barrier
    ds_read_b128 v[136:139], v200 offset:0
    ds_read_b64_tr_b16 v[168:169], v202 offset:0
    ds_read_b64_tr_b16 v[170:171], v202 offset:12288
    ds_read_b128 v[140:143], v200 offset:1024
    ds_read_b128 v[144:147], v200 offset:6144
    ds_read_b128 v[148:151], v200 offset:7168
    ds_read_b64_tr_b16 v[172:173], v203 offset:0
    ds_read_b64_tr_b16 v[174:175], v203 offset:12288
    ds_read_b64_tr_b16 v[176:177], v204 offset:0
    ds_read_b64_tr_b16 v[178:179], v204 offset:12288
    ds_read_b64_tr_b16 v[180:181], v205 offset:0
    ds_read_b64_tr_b16 v[182:183], v205 offset:12288
    s_mov_b32 s38, 8
G4_loop:
    s_waitcnt lgkmcnt(0)
    v_mfma_f32_16x16x32_bf16 v[8:11], v[168:171], v[136:139], v[8:11]
    ds_read_b64_tr_b16 v[184:185], v202 offset:1024
    v_mfma_f32_16x16x32_bf16 v[12:15], v[168:171], v[140:143], v[12:15]
    ds_read_b64_tr_b16 v[186:187], v202 offset:13312
    v_mfma_f32_16x16x32_bf16 v[16:19], v[168:171], v[144:147], v[16:19]
    ds_read_b64_tr_b16 v[188:189], v203 offset:1024
    v_mfma_f32_16x16x32_bf16 v[20:23], v[168:171], v[148:151], v[20:23]
    ds_read_b64_tr_b16 v[190:191], v203 offset:13312
    v_mfma_f32_16x16x32_bf16 v[36:39], v[172:175], v[148:151], v[36:39]
    ds_read_b64_tr_b16 v[192:193], v204 offset:1024
    v_mfma_f32_16x16x32_bf16 v[32:35], v[172:175], v[144:147], v[32:35]
    ds_read_b64_tr_b16 v[194:195], v204 offset:13312
    v_mfma_f32_16x16x32_bf16 v[28:31], v[172:175], v[140:143], v[28:31]
    ds_read_b64_tr_b16 v[196:197], v205 offset:1024
    v_mfma_f32_16x16x32_bf16 v[24:27], v[172:175], v[136:139], v[24:27]
    ds_read_b64_tr_b16 v[198:199], v205 offset:13312
    v_mfma_f32_16x16x32_bf16 v[40:43], v[176:179], v[136:139], v[40:43]
    v_mfma_f32_16x16x32_bf16 v[44:47], v[176:179], v[140:143], v[44:47]
    v_mfma_f32_16x16x32_bf16 v[48:51], v[176:179], v[144:147], v[48:51]
    v_mfma_f32_16x16x32_bf16 v[52:55], v[176:179], v[148:151], v[52:55]
    v_mfma_f32_16x16x32_bf16 v[68:71], v[180:183], v[148:151], v[68:71]
    v_mfma_f32_16x16x32_bf16 v[64:67], v[180:183], v[144:147], v[64:67]
    v_mfma_f32_16x16x32_bf16 v[60:63], v[180:183], v[140:143], v[60:63]
    v_mfma_f32_16x16x32_bf16 v[56:59], v[180:183], v[136:139], v[56:59]
    s_waitcnt lgkmcnt(0)
    v_mfma_f32_16x16x32_bf16 v[72:75], v[184:187], v[136:139], v[72:75]
    s_barrier
    v_mfma_f32_16x16x32_bf16 v[76:79], v[184:187], v[140:143], v[76:79]
    ds_read_b128 v[152:155], v200 offset:24576
    ds_read_b64_tr_b16 v[168:169], v202 offset:24576
    v_mfma_f32_16x16x32_bf16 v[80:83], v[184:187], v[144:147], v[80:83]
    ds_read_b64_tr_b16 v[170:171], v202 offset:36864
    v_mfma_f32_16x16x32_bf16 v[84:87], v[184:187], v[148:151], v[84:87]
    ds_read_b128 v[156:159], v200 offset:25600
    ds_read_b128 v[160:163], v200 offset:30720
    v_mfma_f32_16x16x32_bf16 v[100:103], v[188:191], v[148:151], v[100:103]
    ds_read_b128 v[164:167], v200 offset:31744
    v_mfma_f32_16x16x32_bf16 v[96:99], v[188:191], v[144:147], v[96:99]
    ds_read_b64_tr_b16 v[172:173], v203 offset:24576
    ds_read_b64_tr_b16 v[174:175], v203 offset:36864
    v_mfma_f32_16x16x32_bf16 v[92:95], v[188:191], v[140:143], v[92:95]
    ds_read_b64_tr_b16 v[176:177], v204 offset:24576
    v_mfma_f32_16x16x32_bf16 v[88:91], v[188:191], v[136:139], v[88:91]
    ds_read_b64_tr_b16 v[178:179], v204 offset:36864
    ds_read_b64_tr_b16 v[180:181], v205 offset:24576
    v_mfma_f32_16x16x32_bf16 v[104:107], v[192:195], v[136:139], v[104:107]
    ds_read_b64_tr_b16 v[182:183], v205 offset:36864
    v_mfma_f32_16x16x32_bf16 v[108:111], v[192:195], v[140:143], v[108:111]
    v_mfma_f32_16x16x32_bf16 v[112:115], v[192:195], v[144:147], v[112:115]
    v_mfma_f32_16x16x32_bf16 v[116:119], v[192:195], v[148:151], v[116:119]
    v_mfma_f32_16x16x32_bf16 v[132:135], v[196:199], v[148:151], v[132:135]
    v_mfma_f32_16x16x32_bf16 v[128:131], v[196:199], v[144:147], v[128:131]
    v_mfma_f32_16x16x32_bf16 v[124:127], v[196:199], v[140:143], v[124:127]
    v_mfma_f32_16x16x32_bf16 v[120:123], v[196:199], v[136:139], v[120:123]
    s_waitcnt lgkmcnt(0)
    v_mfma_f32_16x16x32_bf16 v[8:11], v[168:171], v[152:155], v[8:11]
    ds_read_b64_tr_b16 v[184:185], v202 offset:25600
    v_mfma_f32_16x16x32_bf16 v[12:15], v[168:171], v[156:159], v[12:15]
    ds_read_b64_tr_b16 v[186:187], v202 offset:37888
    v_mfma_f32_16x16x32_bf16 v[16:19], v[168:171], v[160:163], v[16:19]
    ds_read_b64_tr_b16 v[188:189], v203 offset:25600
    v_mfma_f32_16x16x32_bf16 v[20:23], v[168:171], v[164:167], v[20:23]
    ds_read_b64_tr_b16 v[190:191], v203 offset:37888
    v_mfma_f32_16x16x32_bf16 v[36:39], v[172:175], v[164:167], v[36:39]
    ds_read_b64_tr_b16 v[192:193], v204 offset:25600
    v_mfma_f32_16x16x32_bf16 v[32:35], v[172:175], v[160:163], v[32:35]
    ds_read_b64_tr_b16 v[194:195], v204 offset:37888
    v_mfma_f32_16x16x32_bf16 v[28:31], v[172:175], v[156:159], v[28:31]
    ds_read_b64_tr_b16 v[196:197], v205 offset:25600
    v_mfma_f32_16x16x32_bf16 v[24:27], v[172:175], v[152:155], v[24:27]
    ds_read_b64_tr_b16 v[198:199], v205 offset:37888
    v_mfma_f32_16x16x32_bf16 v[40:43], v[176:179], v[152:155], v[40:43]
    v_mfma_f32_16x16x32_bf16 v[44:47], v[176:179], v[156:159], v[44:47]
    v_mfma_f32_16x16x32_bf16 v[48:51], v[176:179], v[160:163], v[48:51]
    v_mfma_f32_16x16x32_bf16 v[52:55], v[176:179], v[164:167], v[52:55]
    v_mfma_f32_16x16x32_bf16 v[68:71], v[180:183], v[164:167], v[68:71]
    v_mfma_f32_16x16x32_bf16 v[64:67], v[180:183], v[160:163], v[64:67]
    v_mfma_f32_16x16x32_bf16 v[60:63], v[180:183], v[156:159], v[60:63]
    v_mfma_f32_16x16x32_bf16 v[56:59], v[180:183], v[152:155], v[56:59]
    s_waitcnt lgkmcnt(0)
    v_mfma_f32_16x16x32_bf16 v[72:75], v[184:187], v[152:155], v[72:75]
    s_barrier
    v_mfma_f32_16x16x32_bf16 v[76:79], v[184:187], v[156:159], v[76:79]
    ds_read_b128 v[136:139], v201 offset:0
    ds_read_b64_tr_b16 v[168:169], v206 offset:0
    v_mfma_f32_16x16x32_bf16 v[80:83], v[184:187], v[160:163], v[80:83]
    ds_read_b64_tr_b16 v[170:171], v206 offset:12288
    v_mfma_f32_16x16x32_bf16 v[84:87], v[184:187], v[164:167], v[84:87]
    ds_read_b128 v[140:143], v201 offset:1024
    ds_read_b128 v[144:147], v201 offset:6144
    v_mfma_f32_16x16x32_bf16 v[100:103], v[188:191], v[164:167], v[100:103]
    ds_read_b128 v[148:151], v201 offset:7168
    v_mfma_f32_16x16x32_bf16 v[96:99], v[188:191], v[160:163], v[96:99]
    ds_read_b64_tr_b16 v[172:173], v207 offset:0
    ds_read_b64_tr_b16 v[174:175], v207 offset:12288
    v_mfma_f32_16x16x32_bf16 v[92:95], v[188:191], v[156:159], v[92:95]
    ds_read_b64_tr_b16 v[176:177], v208 offset:0
    v_mfma_f32_16x16x32_bf16 v[88:91], v[188:191], v[152:155], v[88:91]
    ds_read_b64_tr_b16 v[178:179], v208 offset:12288
    ds_read_b64_tr_b16 v[180:181], v209 offset:0
    v_mfma_f32_16x16x32_bf16 v[104:107], v[192:195], v[152:155], v[104:107]
    ds_read_b64_tr_b16 v[182:183], v209 offset:12288
    v_mfma_f32_16x16x32_bf16 v[108:111], v[192:195], v[156:159], v[108:111]
    v_mfma_f32_16x16x32_bf16 v[112:115], v[192:195], v[160:163], v[112:115]
    v_mfma_f32_16x16x32_bf16 v[116:119], v[192:195], v[164:167], v[116:119]
    v_mfma_f32_16x16x32_bf16 v[132:135], v[196:199], v[164:167], v[132:135]
    v_mfma_f32_16x16x32_bf16 v[128:131], v[196:199], v[160:163], v[128:131]
    v_mfma_f32_16x16x32_bf16 v[124:127], v[196:199], v[156:159], v[124:127]
    v_mfma_f32_16x16x32_bf16 v[120:123], v[196:199], v[152:155], v[120:123]
    s_waitcnt lgkmcnt(0)
    v_mfma_f32_16x16x32_bf16 v[8:11], v[168:171], v[136:139], v[8:11]
    ds_read_b64_tr_b16 v[184:185], v206 offset:1024
    v_mfma_f32_16x16x32_bf16 v[12:15], v[168:171], v[140:143], v[12:15]
    ds_read_b64_tr_b16 v[186:187], v206 offset:13312
    v_mfma_f32_16x16x32_bf16 v[16:19], v[168:171], v[144:147], v[16:19]
    ds_read_b64_tr_b16 v[188:189], v207 offset:1024
    v_mfma_f32_16x16x32_bf16 v[20:23], v[168:171], v[148:151], v[20:23]
    ds_read_b64_tr_b16 v[190:191], v207 offset:13312
    v_mfma_f32_16x16x32_bf16 v[36:39], v[172:175], v[148:151], v[36:39]
    ds_read_b64_tr_b16 v[192:193], v208 offset:1024
    v_mfma_f32_16x16x32_bf16 v[32:35], v[172:175], v[144:147], v[32:35]
    ds_read_b64_tr_b16 v[194:195], v208 offset:13312
    v_mfma_f32_16x16x32_bf16 v[28:31], v[172:175], v[140:143], v[28:31]
    ds_read_b64_tr_b16 v[196:197], v209 offset:1024
    v_mfma_f32_16x16x32_bf16 v[24:27], v[172:175], v[136:139], v[24:27]
    ds_read_b64_tr_b16 v[198:199], v209 offset:13312
    v_mfma_f32_16x16x32_bf16 v[40:43], v[176:179], v[136:139], v[40:43]
    v_mfma_f32_16x16x32_bf16 v[44:47], v[176:179], v[140:143], v[44:47]
    v_mfma_f32_16x16x32_bf16 v[48:51], v[176:179], v[144:147], v[48:51]
    v_mfma_f32_16x16x32_bf16 v[52:55], v[176:179], v[148:151], v[52:55]
    v_mfma_f32_16x16x32_bf16 v[68:71], v[180:183], v[148:151], v[68:71]
    v_mfma_f32_16x16x32_bf16 v[64:67], v[180:183], v[144:147], v[64:67]
    v_mfma_f32_16x16x32_bf16 v[60:63], v[180:183], v[140:143], v[60:63]
    v_mfma_f32_16x16x32_bf16 v[56:59], v[180:183], v[136:139], v[56:59]
    s_waitcnt lgkmcnt(0)
    v_mfma_f32_16x16x32_bf16 v[72:75], v[184:187], v[136:139], v[72:75]
    s_barrier
    v_mfma_f32_16x16x32_bf16 v[76:79], v[184:187], v[140:143], v[76:79]
    ds_read_b128 v[152:155], v201 offset:24576
    ds_read_b64_tr_b16 v[168:169], v206 offset:24576
    v_mfma_f32_16x16x32_bf16 v[80:83], v[184:187], v[144:147], v[80:83]
    ds_read_b64_tr_b16 v[170:171], v206 offset:36864
    v_mfma_f32_16x16x32_bf16 v[84:87], v[184:187], v[148:151], v[84:87]
    ds_read_b128 v[156:159], v201 offset:25600
    ds_read_b128 v[160:163], v201 offset:30720
    v_mfma_f32_16x16x32_bf16 v[100:103], v[188:191], v[148:151], v[100:103]
    ds_read_b128 v[164:167], v201 offset:31744
    v_mfma_f32_16x16x32_bf16 v[96:99], v[188:191], v[144:147], v[96:99]
    ds_read_b64_tr_b16 v[172:173], v207 offset:24576
    ds_read_b64_tr_b16 v[174:175], v207 offset:36864
    v_mfma_f32_16x16x32_bf16 v[92:95], v[188:191], v[140:143], v[92:95]
    ds_read_b64_tr_b16 v[176:177], v208 offset:24576
    v_mfma_f32_16x16x32_bf16 v[88:91], v[188:191], v[136:139], v[88:91]
    ds_read_b64_tr_b16 v[178:179], v208 offset:36864
    ds_read_b64_tr_b16 v[180:181], v209 offset:24576
    v_mfma_f32_16x16x32_bf16 v[104:107], v[192:195], v[136:139], v[104:107]
    ds_read_b64_tr_b16 v[182:183], v209 offset:36864
    v_mfma_f32_16x16x32_bf16 v[108:111], v[192:195], v[140:143], v[108:111]
    v_mfma_f32_16x16x32_bf16 v[112:115], v[192:195], v[144:147], v[112:115]
    v_mfma_f32_16x16x32_bf16 v[116:119], v[192:195], v[148:151], v[116:119]
    v_mfma_f32_16x16x32_bf16 v[132:135], v[196:199], v[148:151], v[132:135]
    v_mfma_f32_16x16x32_bf16 v[128:131], v[196:199], v[144:147], v[128:131]
    v_mfma_f32_16x16x32_bf16 v[124:127], v[196:199], v[140:143], v[124:127]
    v_mfma_f32_16x16x32_bf16 v[120:123], v[196:199], v[136:139], v[120:123]
    s_waitcnt lgkmcnt(0)
    v_mfma_f32_16x16x32_bf16 v[8:11], v[168:171], v[152:155], v[8:11]
    ds_read_b64_tr_b16 v[184:185], v206 offset:25600
    v_mfma_f32_16x16x32_bf16 v[12:15], v[168:171], v[156:159], v[12:15]
    ds_read_b64_tr_b16 v[186:187], v206 offset:37888
    v_mfma_f32_16x16x32_bf16 v[16:19], v[168:171], v[160:163], v[16:19]
    ds_read_b64_tr_b16 v[188:189], v207 offset:25600
    v_mfma_f32_16x16x32_bf16 v[20:23], v[168:171], v[164:167], v[20:23]
    ds_read_b64_tr_b16 v[190:191], v207 offset:37888
    v_mfma_f32_16x16x32_bf16 v[36:39], v[172:175], v[164:167], v[36:39]
    ds_read_b64_tr_b16 v[192:193], v208 offset:25600
    v_mfma_f32_16x16x32_bf16 v[32:35], v[172:175], v[160:163], v[32:35]
    ds_read_b64_tr_b16 v[194:195], v208 offset:37888
    v_mfma_f32_16x16x32_bf16 v[28:31], v[172:175], v[156:159], v[28:31]
    ds_read_b64_tr_b16 v[196:197], v209 offset:25600
    v_mfma_f32_16x16x32_bf16 v[24:27], v[172:175], v[152:155], v[24:27]
    ds_read_b64_tr_b16 v[198:199], v209 offset:37888
    v_mfma_f32_16x16x32_bf16 v[40:43], v[176:179], v[152:155], v[40:43]
    v_mfma_f32_16x16x32_bf16 v[44:47], v[176:179], v[156:159], v[44:47]
    v_mfma_f32_16x16x32_bf16 v[48:51], v[176:179], v[160:163], v[48:51]
    v_mfma_f32_16x16x32_bf16 v[52:55], v[176:179], v[164:167], v[52:55]
    v_mfma_f32_16x16x32_bf16 v[68:71], v[180:183], v[164:167], v[68:71]
    v_mfma_f32_16x16x32_bf16 v[64:67], v[180:183], v[160:163], v[64:67]
    v_mfma_f32_16x16x32_bf16 v[60:63], v[180:183], v[156:159], v[60:63]
    v_mfma_f32_16x16x32_bf16 v[56:59], v[180:183], v[152:155], v[56:59]
    s_waitcnt lgkmcnt(0)
    v_mfma_f32_16x16x32_bf16 v[72:75], v[184:187], v[152:155], v[72:75]
    s_barrier
    v_mfma_f32_16x16x32_bf16 v[76:79], v[184:187], v[156:159], v[76:79]
    ds_read_b128 v[136:139], v200 offset:0
    ds_read_b64_tr_b16 v[168:169], v202 offset:0
    v_mfma_f32_16x16x32_bf16 v[80:83], v[184:187], v[160:163], v[80:83]
    ds_read_b64_tr_b16 v[170:171], v202 offset:12288
    v_mfma_f32_16x16x32_bf16 v[84:87], v[184:187], v[164:167], v[84:87]
    ds_read_b128 v[140:143], v200 offset:1024
    ds_read_b128 v[144:147], v200 offset:6144
    v_mfma_f32_16x16x32_bf16 v[100:103], v[188:191], v[164:167], v[100:103]
    ds_read_b128 v[148:151], v200 offset:7168
    v_mfma_f32_16x16x32_bf16 v[96:99], v[188:191], v[160:163], v[96:99]
    ds_read_b64_tr_b16 v[172:173], v203 offset:0
    ds_read_b64_tr_b16 v[174:175], v203 offset:12288
    v_mfma_f32_16x16x32_bf16 v[92:95], v[188:191], v[156:159], v[92:95]
    ds_read_b64_tr_b16 v[176:177], v204 offset:0
    v_mfma_f32_16x16x32_bf16 v[88:91], v[188:191], v[152:155], v[88:91]
    ds_read_b64_tr_b16 v[178:179], v204 offset:12288
    ds_read_b64_tr_b16 v[180:181], v205 offset:0
    v_mfma_f32_16x16x32_bf16 v[104:107], v[192:195], v[152:155], v[104:107]
    ds_read_b64_tr_b16 v[182:183], v205 offset:12288
    v_mfma_f32_16x16x32_bf16 v[108:111], v[192:195], v[156:159], v[108:111]
    v_mfma_f32_16x16x32_bf16 v[112:115], v[192:195], v[160:163], v[112:115]
    v_mfma_f32_16x16x32_bf16 v[116:119], v[192:195], v[164:167], v[116:119]
    v_mfma_f32_16x16x32_bf16 v[132:135], v[196:199], v[164:167], v[132:135]
    v_mfma_f32_16x16x32_bf16 v[128:131], v[196:199], v[160:163], v[128:131]
    v_mfma_f32_16x16x32_bf16 v[124:127], v[196:199], v[156:159], v[124:127]
    v_mfma_f32_16x16x32_bf16 v[120:123], v[196:199], v[152:155], v[120:123]
    s_sub_u32 s38, s38, 1
    s_cmp_lg_u32 s38, 0
    s_cbranch_scc1 G4_loop
    s_waitcnt lgkmcnt(0)
    s_waitcnt vmcnt(0)
    v_and_b32 v1, 63, v0
    v_lshlrev_b32 v2, 4, v1
    s_lshl_b32 s71, s70, 1
    s_mul_i32 s73, s47, 4
    s_add_u32 s71, s71, s73
    s_lshl_b32 s72, s68, 3
    s_lshl_b32 s73, s46, 2
    s_add_u32 s72, s72, s73
    v_lshrrev_b32 v5, 4, v1
    v_and_b32 v4, 15, v1
    v_lshlrev_b32 v4, 4, v4
    v_lshl_add_u32 v4, v5, 9, v4
    v_lshlrev_b32 v3, 6, v5
    v_bfe_u32 v5, v1, 2, 1
    v_lshl_add_u32 v3, v5, 9, v3
    v_bfe_u32 v5, v1, 3, 1
    v_lshl_add_u32 v3, v5, 3, v3
    v_and_b32 v5, 3, v1
    v_lshl_add_u32 v3, v5, 1, v3
    s_cmp_lt_u32 s71, 34
    s_cbranch_scc1 G4_eq0
    s_mul_i32 s78, s72, 114688
    s_sub_u32 s73, s71, 34
    s_lshl_b32 s73, s73, 10
    s_add_u32 s78, s78, s73
    s_add_u32 s78, s78, 16777216
    v_mul_f32_e64 v8, v8, |v8|
    v_mul_f32_e64 v9, v9, |v9|
    v_mul_f32_e64 v10, v10, |v10|
    v_mul_f32_e64 v11, v11, |v11|
    v_mul_f32_e64 v24, v24, |v24|
    v_mul_f32_e64 v25, v25, |v25|
    v_mul_f32_e64 v26, v26, |v26|
    v_mul_f32_e64 v27, v27, |v27|
    v_cvt_pk_bf16_f32 v136, v8, v9
    v_cvt_pk_bf16_f32 v137, v10, v11
    v_cvt_pk_bf16_f32 v138, v24, v25
    v_cvt_pk_bf16_f32 v139, v26, v27
    v_pk_max_i16 v136, v136, 0
    v_pk_max_i16 v137, v137, 0
    v_pk_max_i16 v138, v138, 0
    v_pk_max_i16 v139, v139, 0
    buffer_store_dwordx4 v[136:139], v2, s[64:67], s78 offen sc1
    s_add_u32 s78, s78, 114688
    v_mul_f32_e64 v12, v12, |v12|
    v_mul_f32_e64 v13, v13, |v13|
    v_mul_f32_e64 v14, v14, |v14|
    v_mul_f32_e64 v15, v15, |v15|
    v_mul_f32_e64 v28, v28, |v28|
    v_mul_f32_e64 v29, v29, |v29|
    v_mul_f32_e64 v30, v30, |v30|
    v_mul_f32_e64 v31, v31, |v31|
    v_cvt_pk_bf16_f32 v140, v12, v13
    v_cvt_pk_bf16_f32 v141, v14, v15
    v_cvt_pk_bf16_f32 v142, v28, v29
    v_cvt_pk_bf16_f32 v143, v30, v31
    v_pk_max_i16 v140, v140, 0
    v_pk_max_i16 v141, v141, 0
    v_pk_max_i16 v142, v142, 0
    v_pk_max_i16 v143, v143, 0
    buffer_store_dwordx4 v[140:143], v2, s[64:67], s78 offen sc1
    s_add_u32 s78, s78, 114688
    v_mul_f32_e64 v16, v16, |v16|
    v_mul_f32_e64 v17, v17, |v17|
    v_mul_f32_e64 v18, v18, |v18|
    v_mul_f32_e64 v19, v19, |v19|
    v_mul_f32_e64 v32, v32, |v32|
    v_mul_f32_e64 v33, v33, |v33|
    v_mul_f32_e64 v34, v34, |v34|
    v_mul_f32_e64 v35, v35, |v35|
    v_cvt_pk_bf16_f32 v144, v16, v17
    v_cvt_pk_bf16_f32 v145, v18, v19
    v_cvt_pk_bf16_f32 v146, v32, v33
    v_cvt_pk_bf16_f32 v147, v34, v35
    v_pk_max_i16 v144, v144, 0
    v_pk_max_i16 v145, v145, 0
    v_pk_max_i16 v146, v146, 0
    v_pk_max_i16 v147, v147, 0
    buffer_store_dwordx4 v[144:147], v2, s[64:67], s78 offen sc1
    s_add_u32 s78, s78, 114688
    v_mul_f32_e64 v20, v20, |v20|
    v_mul_f32_e64 v21, v21, |v21|
    v_mul_f32_e64 v22, v22, |v22|
    v_mul_f32_e64 v23, v23, |v23|
    v_mul_f32_e64 v36, v36, |v36|
    v_mul_f32_e64 v37, v37, |v37|
    v_mul_f32_e64 v38, v38, |v38|
    v_mul_f32_e64 v39, v39, |v39|
    v_cvt_pk_bf16_f32 v148, v20, v21
    v_cvt_pk_bf16_f32 v149, v22, v23
    v_cvt_pk_bf16_f32 v150, v36, v37
    v_cvt_pk_bf16_f32 v151, v38, v39
    v_pk_max_i16 v148, v148, 0
    v_pk_max_i16 v149, v149, 0
    v_pk_max_i16 v150, v150, 0
    v_pk_max_i16 v151, v151, 0
    buffer_store_dwordx4 v[148:151], v2, s[64:67], s78 offen sc1
    s_branch G4_en0
G4_eq0:
    s_lshl_b32 s78, s72, 15
    s_lshl_b32 s73, s71, 11
    s_add_u32 s78, s78, s73
    s_add_u32 s78, s78, 4194304
    s_add_u32 s79, s78, 65536
    s_mov_b32 s76, 1048744942
    s_lshl_b32 s73, s72, 10
    s_add_u32 s73, s73, 8388608
    s_add_u32 s74, s73, 2048
    s_cmp_eq_u32 s71, 32
    s_cselect_b32 s78, s73, s78
    s_cselect_b32 s79, s74, s79
    s_cselect_b32 s76, 1.0, s76
    s_mov_b32 s77, s76
    v_pk_mul_f32 v[8:9], v[8:9], s[76:77]
    v_pk_mul_f32 v[10:11], v[10:11], s[76:77]
    v_pk_mul_f32 v[24:25], v[24:25], s[76:77]
    v_pk_mul_f32 v[26:27], v[26:27], s[76:77]
    v_cvt_pk_bf16_f32 v136, v8, v9
    v_cvt_pk_bf16_f32 v137, v10, v11
    v_cvt_pk_bf16_f32 v138, v24, v25
    v_cvt_pk_bf16_f32 v139, v26, v27
    buffer_store_dwordx4 v[136:139], v4, s[64:67], s78 offen offset:0 sc1
    v_pk_mul_f32 v[12:13], v[12:13], s[76:77]
    v_pk_mul_f32 v[14:15], v[14:15], s[76:77]
    v_pk_mul_f32 v[28:29], v[28:29], s[76:77]
    v_pk_mul_f32 v[30:31], v[30:31], s[76:77]
    v_cvt_pk_bf16_f32 v140, v12, v13
    v_cvt_pk_bf16_f32 v141, v14, v15
    v_cvt_pk_bf16_f32 v142, v28, v29
    v_cvt_pk_bf16_f32 v143, v30, v31
    buffer_store_dwordx4 v[140:143], v4, s[64:67], s78 offen offset:256 sc1
    v_pk_mul_f32 v[16:17], v[16:17], s[76:77]
    v_pk_mul_f32 v[18:19], v[18:19], s[76:77]
    v_pk_mul_f32 v[32:33], v[32:33], s[76:77]
    v_pk_mul_f32 v[34:35], v[34:35], s[76:77]
    v_cvt_pk_bf16_f32 v144, v16, v17
    v_cvt_pk_bf16_f32 v145, v18, v19
    v_cvt_pk_bf16_f32 v146, v32, v33
    v_cvt_pk_bf16_f32 v147, v34, v35
    buffer_store_dwordx4 v[144:147], v4, s[64:67], s79 offen offset:0 sc1
    v_pk_mul_f32 v[20:21], v[20:21], s[76:77]
    v_pk_mul_f32 v[22:23], v[22:23], s[76:77]
    v_pk_mul_f32 v[36:37], v[36:37], s[76:77]
    v_pk_mul_f32 v[38:39], v[38:39], s[76:77]
    v_cvt_pk_bf16_f32 v148, v20, v21
    v_cvt_pk_bf16_f32 v149, v22, v23
    v_cvt_pk_bf16_f32 v150, v36, v37
    v_cvt_pk_bf16_f32 v151, v38, v39
    buffer_store_dwordx4 v[148:151], v4, s[64:67], s79 offen offset:256 sc1
G4_en0:
    s_add_u32 s71, s71, 1
    s_nop 0
    s_cmp_lt_u32 s71, 34
    s_cbranch_scc1 G4_eq1
    s_mul_i32 s78, s72, 114688
    s_sub_u32 s73, s71, 34
    s_lshl_b32 s73, s73, 10
    s_add_u32 s78, s78, s73
    s_add_u32 s78, s78, 16777216
    v_mul_f32_e64 v40, v40, |v40|
    v_mul_f32_e64 v41, v41, |v41|
    v_mul_f32_e64 v42, v42, |v42|
    v_mul_f32_e64 v43, v43, |v43|
    v_mul_f32_e64 v56, v56, |v56|
    v_mul_f32_e64 v57, v57, |v57|
    v_mul_f32_e64 v58, v58, |v58|
    v_mul_f32_e64 v59, v59, |v59|
    v_cvt_pk_bf16_f32 v152, v40, v41
    v_cvt_pk_bf16_f32 v153, v42, v43
    v_cvt_pk_bf16_f32 v154, v56, v57
    v_cvt_pk_bf16_f32 v155, v58, v59
    v_pk_max_i16 v152, v152, 0
    v_pk_max_i16 v153, v153, 0
    v_pk_max_i16 v154, v154, 0
    v_pk_max_i16 v155, v155, 0
    buffer_store_dwordx4 v[152:155], v2, s[64:67], s78 offen sc1
    s_add_u32 s78, s78, 114688
    v_mul_f32_e64 v44, v44, |v44|
    v_mul_f32_e64 v45, v45, |v45|
    v_mul_f32_e64 v46, v46, |v46|
    v_mul_f32_e64 v47, v47, |v47|
    v_mul_f32_e64 v60, v60, |v60|
    v_mul_f32_e64 v61, v61, |v61|
    v_mul_f32_e64 v62, v62, |v62|
    v_mul_f32_e64 v63, v63, |v63|
    v_cvt_pk_bf16_f32 v156, v44, v45
    v_cvt_pk_bf16_f32 v157, v46, v47
    v_cvt_pk_bf16_f32 v158, v60, v61
    v_cvt_pk_bf16_f32 v159, v62, v63
    v_pk_max_i16 v156, v156, 0
    v_pk_max_i16 v157, v157, 0
    v_pk_max_i16 v158, v158, 0
    v_pk_max_i16 v159, v159, 0
    buffer_store_dwordx4 v[156:159], v2, s[64:67], s78 offen sc1
    s_add_u32 s78, s78, 114688
    v_mul_f32_e64 v48, v48, |v48|
    v_mul_f32_e64 v49, v49, |v49|
    v_mul_f32_e64 v50, v50, |v50|
    v_mul_f32_e64 v51, v51, |v51|
    v_mul_f32_e64 v64, v64, |v64|
    v_mul_f32_e64 v65, v65, |v65|
    v_mul_f32_e64 v66, v66, |v66|
    v_mul_f32_e64 v67, v67, |v67|
    v_cvt_pk_bf16_f32 v160, v48, v49
    v_cvt_pk_bf16_f32 v161, v50, v51
    v_cvt_pk_bf16_f32 v162, v64, v65
    v_cvt_pk_bf16_f32 v163, v66, v67
    v_pk_max_i16 v160, v160, 0
    v_pk_max_i16 v161, v161, 0
    v_pk_max_i16 v162, v162, 0
    v_pk_max_i16 v163, v163, 0
    buffer_store_dwordx4 v[160:163], v2, s[64:67], s78 offen sc1
    s_add_u32 s78, s78, 114688
    v_mul_f32_e64 v52, v52, |v52|
    v_mul_f32_e64 v53, v53, |v53|
    v_mul_f32_e64 v54, v54, |v54|
    v_mul_f32_e64 v55, v55, |v55|
    v_mul_f32_e64 v68, v68, |v68|
    v_mul_f32_e64 v69, v69, |v69|
    v_mul_f32_e64 v70, v70, |v70|
    v_mul_f32_e64 v71, v71, |v71|
    v_cvt_pk_bf16_f32 v164, v52, v53
    v_cvt_pk_bf16_f32 v165, v54, v55
    v_cvt_pk_bf16_f32 v166, v68, v69
    v_cvt_pk_bf16_f32 v167, v70, v71
    v_pk_max_i16 v164, v164, 0
    v_pk_max_i16 v165, v165, 0
    v_pk_max_i16 v166, v166, 0
    v_pk_max_i16 v167, v167, 0
    buffer_store_dwordx4 v[164:167], v2, s[64:67], s78 offen sc1
    s_branch G4_en1
G4_eq1:
    s_cmp_eq_u32 s71, 33
    s_cbranch_scc1 G4_ev
    s_lshl_b32 s78, s72, 15
    s_lshl_b32 s73, s71, 11
    s_add_u32 s78, s78, s73
    s_add_u32 s78, s78, 4194304
    s_add_u32 s79, s78, 65536
    s_mov_b32 s76, 1048744942
    s_mov_b32 s77, s76
    v_pk_mul_f32 v[40:41], v[40:41], s[76:77]
    v_pk_mul_f32 v[42:43], v[42:43], s[76:77]
    v_pk_mul_f32 v[56:57], v[56:57], s[76:77]
    v_pk_mul_f32 v[58:59], v[58:59], s[76:77]
    v_cvt_pk_bf16_f32 v152, v40, v41
    v_cvt_pk_bf16_f32 v153, v42, v43
    v_cvt_pk_bf16_f32 v154, v56, v57
    v_cvt_pk_bf16_f32 v155, v58, v59
    buffer_store_dwordx4 v[152:155], v4, s[64:67], s78 offen offset:0 sc1
    v_pk_mul_f32 v[44:45], v[44:45], s[76:77]
    v_pk_mul_f32 v[46:47], v[46:47], s[76:77]
    v_pk_mul_f32 v[60:61], v[60:61], s[76:77]
    v_pk_mul_f32 v[62:63], v[62:63], s[76:77]
    v_cvt_pk_bf16_f32 v156, v44, v45
    v_cvt_pk_bf16_f32 v157, v46, v47
    v_cvt_pk_bf16_f32 v158, v60, v61
    v_cvt_pk_bf16_f32 v159, v62, v63
    buffer_store_dwordx4 v[156:159], v4, s[64:67], s78 offen offset:256 sc1
    v_pk_mul_f32 v[48:49], v[48:49], s[76:77]
    v_pk_mul_f32 v[50:51], v[50:51], s[76:77]
    v_pk_mul_f32 v[64:65], v[64:65], s[76:77]
    v_pk_mul_f32 v[66:67], v[66:67], s[76:77]
    v_cvt_pk_bf16_f32 v160, v48, v49
    v_cvt_pk_bf16_f32 v161, v50, v51
    v_cvt_pk_bf16_f32 v162, v64, v65
    v_cvt_pk_bf16_f32 v163, v66, v67
    buffer_store_dwordx4 v[160:163], v4, s[64:67], s79 offen offset:0 sc1
    v_pk_mul_f32 v[52:53], v[52:53], s[76:77]
    v_pk_mul_f32 v[54:55], v[54:55], s[76:77]
    v_pk_mul_f32 v[68:69], v[68:69], s[76:77]
    v_pk_mul_f32 v[70:71], v[70:71], s[76:77]
    v_cvt_pk_bf16_f32 v164, v52, v53
    v_cvt_pk_bf16_f32 v165, v54, v55
    v_cvt_pk_bf16_f32 v166, v68, v69
    v_cvt_pk_bf16_f32 v167, v70, v71
    buffer_store_dwordx4 v[164:167], v4, s[64:67], s79 offen offset:256 sc1
    s_branch G4_en1
G4_ev:
    s_lshl_b32 s78, s72, 10
    s_add_u32 s78, s78, 8519680
    s_lshl_b32 s73, s46, 12
    s_add_u32 s73, s73, 131072
    v_add_u32 v5, s73, v3
    v_add_u32 v6, s73, v2
    v_cvt_pk_bf16_f32 v152, v40, v41
    v_cvt_pk_bf16_f32 v153, v42, v43
    v_cvt_pk_bf16_f32 v154, v56, v57
    v_cvt_pk_bf16_f32 v155, v58, v59
    ds_write_b16 v5, v152 offset:0
    ds_write_b16_d16_hi v5, v152 offset:16
    ds_write_b16 v5, v153 offset:32
    ds_write_b16_d16_hi v5, v153 offset:48
    ds_write_b16 v5, v154 offset:256
    ds_write_b16_d16_hi v5, v154 offset:272
    ds_write_b16 v5, v155 offset:288
    ds_write_b16_d16_hi v5, v155 offset:304
    v_cvt_pk_bf16_f32 v156, v44, v45
    v_cvt_pk_bf16_f32 v157, v46, v47
    v_cvt_pk_bf16_f32 v158, v60, v61
    v_cvt_pk_bf16_f32 v159, v62, v63
    ds_write_b16 v5, v156 offset:1024
    ds_write_b16_d16_hi v5, v156 offset:1040
    ds_write_b16 v5, v157 offset:1056
    ds_write_b16_d16_hi v5, v157 offset:1072
    ds_write_b16 v5, v158 offset:1280
    ds_write_b16_d16_hi v5, v158 offset:1296
    ds_write_b16 v5, v159 offset:1312
    ds_write_b16_d16_hi v5, v159 offset:1328
    v_cvt_pk_bf16_f32 v160, v48, v49
    v_cvt_pk_bf16_f32 v161, v50, v51
    v_cvt_pk_bf16_f32 v162, v64, v65
    v_cvt_pk_bf16_f32 v163, v66, v67
    ds_write_b16 v5, v160 offset:2048
    ds_write_b16_d16_hi v5, v160 offset:2064
    ds_write_b16 v5, v161 offset:2080
    ds_write_b16_d16_hi v5, v161 offset:2096
    ds_write_b16 v5, v162 offset:2304
    ds_write_b16_d16_hi v5, v162 offset:2320
    ds_write_b16 v5, v163 offset:2336
    ds_write_b16_d16_hi v5, v163 offset:2352
    v_cvt_pk_bf16_f32 v164, v52, v53
    v_cvt_pk_bf16_f32 v165, v54, v55
    v_cvt_pk_bf16_f32 v166, v68, v69
    v_cvt_pk_bf16_f32 v167, v70, v71
    ds_write_b16 v5, v164 offset:3072
    ds_write_b16_d16_hi v5, v164 offset:3088
    ds_write_b16 v5, v165 offset:3104
    ds_write_b16_d16_hi v5, v165 offset:3120
    ds_write_b16 v5, v166 offset:3328
    ds_write_b16_d16_hi v5, v166 offset:3344
    ds_write_b16 v5, v167 offset:3360
    ds_write_b16_d16_hi v5, v167 offset:3376
    s_waitcnt lgkmcnt(0)
    ds_read_b128 v[152:155], v6 offset:0
    ds_read_b128 v[156:159], v6 offset:1024
    ds_read_b128 v[160:163], v6 offset:2048
    ds_read_b128 v[164:167], v6 offset:3072
    s_waitcnt lgkmcnt(3)
    buffer_store_dwordx4 v[152:155], v2, s[64:67], s78 offen offset:0 sc1
    s_waitcnt lgkmcnt(2)
    buffer_store_dwordx4 v[156:159], v2, s[64:67], s78 offen offset:1024 sc1
    s_waitcnt lgkmcnt(1)
    buffer_store_dwordx4 v[160:163], v2, s[64:67], s78 offen offset:2048 sc1
    s_waitcnt lgkmcnt(0)
    buffer_store_dwordx4 v[164:167], v2, s[64:67], s78 offen offset:3072 sc1
    v_lshlrev_b32 v5, 7, v1
    v_mov_b32 v6, 1
    s_mov_b32 s73, 10493952
    s_waitcnt vmcnt(0)
    buffer_atomic_add v6, v5, s[64:67], s73 offen
    s_mov_b64 exec, -1
G4_en1:
    s_add_u32 s71, s71, 1
    s_nop 0
    s_cmp_lt_u32 s71, 34
    s_cbranch_scc1 G4_eq2
    s_mul_i32 s78, s72, 114688
    s_sub_u32 s73, s71, 34
    s_lshl_b32 s73, s73, 10
    s_add_u32 s78, s78, s73
    s_add_u32 s78, s78, 16777216
    v_mul_f32_e64 v72, v72, |v72|
    v_mul_f32_e64 v73, v73, |v73|
    v_mul_f32_e64 v74, v74, |v74|
    v_mul_f32_e64 v75, v75, |v75|
    v_mul_f32_e64 v88, v88, |v88|
    v_mul_f32_e64 v89, v89, |v89|
    v_mul_f32_e64 v90, v90, |v90|
    v_mul_f32_e64 v91, v91, |v91|
    v_cvt_pk_bf16_f32 v136, v72, v73
    v_cvt_pk_bf16_f32 v137, v74, v75
    v_cvt_pk_bf16_f32 v138, v88, v89
    v_cvt_pk_bf16_f32 v139, v90, v91
    v_pk_max_i16 v136, v136, 0
    v_pk_max_i16 v137, v137, 0
    v_pk_max_i16 v138, v138, 0
    v_pk_max_i16 v139, v139, 0
    buffer_store_dwordx4 v[136:139], v2, s[64:67], s78 offen sc1
    s_add_u32 s78, s78, 114688
    v_mul_f32_e64 v76, v76, |v76|
    v_mul_f32_e64 v77, v77, |v77|
    v_mul_f32_e64 v78, v78, |v78|
    v_mul_f32_e64 v79, v79, |v79|
    v_mul_f32_e64 v92, v92, |v92|
    v_mul_f32_e64 v93, v93, |v93|
    v_mul_f32_e64 v94, v94, |v94|
    v_mul_f32_e64 v95, v95, |v95|
    v_cvt_pk_bf16_f32 v140, v76, v77
    v_cvt_pk_bf16_f32 v141, v78, v79
    v_cvt_pk_bf16_f32 v142, v92, v93
    v_cvt_pk_bf16_f32 v143, v94, v95
    v_pk_max_i16 v140, v140, 0
    v_pk_max_i16 v141, v141, 0
    v_pk_max_i16 v142, v142, 0
    v_pk_max_i16 v143, v143, 0
    buffer_store_dwordx4 v[140:143], v2, s[64:67], s78 offen sc1
    s_add_u32 s78, s78, 114688
    v_mul_f32_e64 v80, v80, |v80|
    v_mul_f32_e64 v81, v81, |v81|
    v_mul_f32_e64 v82, v82, |v82|
    v_mul_f32_e64 v83, v83, |v83|
    v_mul_f32_e64 v96, v96, |v96|
    v_mul_f32_e64 v97, v97, |v97|
    v_mul_f32_e64 v98, v98, |v98|
    v_mul_f32_e64 v99, v99, |v99|
    v_cvt_pk_bf16_f32 v144, v80, v81
    v_cvt_pk_bf16_f32 v145, v82, v83
    v_cvt_pk_bf16_f32 v146, v96, v97
    v_cvt_pk_bf16_f32 v147, v98, v99
    v_pk_max_i16 v144, v144, 0
    v_pk_max_i16 v145, v145, 0
    v_pk_max_i16 v146, v146, 0
    v_pk_max_i16 v147, v147, 0
    buffer_store_dwordx4 v[144:147], v2, s[64:67], s78 offen sc1
    s_add_u32 s78, s78, 114688
    v_mul_f32_e64 v84, v84, |v84|
    v_mul_f32_e64 v85, v85, |v85|
    v_mul_f32_e64 v86, v86, |v86|
    v_mul_f32_e64 v87, v87, |v87|
    v_mul_f32_e64 v100, v100, |v100|
    v_mul_f32_e64 v101, v101, |v101|
    v_mul_f32_e64 v102, v102, |v102|
    v_mul_f32_e64 v103, v103, |v103|
    v_cvt_pk_bf16_f32 v148, v84, v85
    v_cvt_pk_bf16_f32 v149, v86, v87
    v_cvt_pk_bf16_f32 v150, v100, v101
    v_cvt_pk_bf16_f32 v151, v102, v103
    v_pk_max_i16 v148, v148, 0
    v_pk_max_i16 v149, v149, 0
    v_pk_max_i16 v150, v150, 0
    v_pk_max_i16 v151, v151, 0
    buffer_store_dwordx4 v[148:151], v2, s[64:67], s78 offen sc1
    s_branch G4_en2
G4_eq2:
    s_lshl_b32 s78, s72, 15
    s_lshl_b32 s73, s71, 11
    s_add_u32 s78, s78, s73
    s_add_u32 s78, s78, 4194304
    s_add_u32 s79, s78, 65536
    s_mov_b32 s76, 1048744942
    s_mov_b32 s77, s76
    v_pk_mul_f32 v[72:73], v[72:73], s[76:77]
    v_pk_mul_f32 v[74:75], v[74:75], s[76:77]
    v_pk_mul_f32 v[88:89], v[88:89], s[76:77]
    v_pk_mul_f32 v[90:91], v[90:91], s[76:77]
    v_cvt_pk_bf16_f32 v136, v72, v73
    v_cvt_pk_bf16_f32 v137, v74, v75
    v_cvt_pk_bf16_f32 v138, v88, v89
    v_cvt_pk_bf16_f32 v139, v90, v91
    buffer_store_dwordx4 v[136:139], v4, s[64:67], s78 offen offset:0 sc1
    v_pk_mul_f32 v[76:77], v[76:77], s[76:77]
    v_pk_mul_f32 v[78:79], v[78:79], s[76:77]
    v_pk_mul_f32 v[92:93], v[92:93], s[76:77]
    v_pk_mul_f32 v[94:95], v[94:95], s[76:77]
    v_cvt_pk_bf16_f32 v140, v76, v77
    v_cvt_pk_bf16_f32 v141, v78, v79
    v_cvt_pk_bf16_f32 v142, v92, v93
    v_cvt_pk_bf16_f32 v143, v94, v95
    buffer_store_dwordx4 v[140:143], v4, s[64:67], s78 offen offset:256 sc1
    v_pk_mul_f32 v[80:81], v[80:81], s[76:77]
    v_pk_mul_f32 v[82:83], v[82:83], s[76:77]
    v_pk_mul_f32 v[96:97], v[96:97], s[76:77]
    v_pk_mul_f32 v[98:99], v[98:99], s[76:77]
    v_cvt_pk_bf16_f32 v144, v80, v81
    v_cvt_pk_bf16_f32 v145, v82, v83
    v_cvt_pk_bf16_f32 v146, v96, v97
    v_cvt_pk_bf16_f32 v147, v98, v99
    buffer_store_dwordx4 v[144:147], v4, s[64:67], s79 offen offset:0 sc1
    v_pk_mul_f32 v[84:85], v[84:85], s[76:77]
    v_pk_mul_f32 v[86:87], v[86:87], s[76:77]
    v_pk_mul_f32 v[100:101], v[100:101], s[76:77]
    v_pk_mul_f32 v[102:103], v[102:103], s[76:77]
    v_cvt_pk_bf16_f32 v148, v84, v85
    v_cvt_pk_bf16_f32 v149, v86, v87
    v_cvt_pk_bf16_f32 v150, v100, v101
    v_cvt_pk_bf16_f32 v151, v102, v103
    buffer_store_dwordx4 v[148:151], v4, s[64:67], s79 offen offset:256 sc1
G4_en2:
    s_add_u32 s71, s71, 1
    s_nop 0
    s_cmp_lt_u32 s71, 34
    s_cbranch_scc1 G4_eq3
    s_mul_i32 s78, s72, 114688
    s_sub_u32 s73, s71, 34
    s_lshl_b32 s73, s73, 10
    s_add_u32 s78, s78, s73
    s_add_u32 s78, s78, 16777216
    v_mul_f32_e64 v104, v104, |v104|
    v_mul_f32_e64 v105, v105, |v105|
    v_mul_f32_e64 v106, v106, |v106|
    v_mul_f32_e64 v107, v107, |v107|
    v_mul_f32_e64 v120, v120, |v120|
    v_mul_f32_e64 v121, v121, |v121|
    v_mul_f32_e64 v122, v122, |v122|
    v_mul_f32_e64 v123, v123, |v123|
    v_cvt_pk_bf16_f32 v152, v104, v105
    v_cvt_pk_bf16_f32 v153, v106, v107
    v_cvt_pk_bf16_f32 v154, v120, v121
    v_cvt_pk_bf16_f32 v155, v122, v123
    v_pk_max_i16 v152, v152, 0
    v_pk_max_i16 v153, v153, 0
    v_pk_max_i16 v154, v154, 0
    v_pk_max_i16 v155, v155, 0
    buffer_store_dwordx4 v[152:155], v2, s[64:67], s78 offen sc1
    s_add_u32 s78, s78, 114688
    v_mul_f32_e64 v108, v108, |v108|
    v_mul_f32_e64 v109, v109, |v109|
    v_mul_f32_e64 v110, v110, |v110|
    v_mul_f32_e64 v111, v111, |v111|
    v_mul_f32_e64 v124, v124, |v124|
    v_mul_f32_e64 v125, v125, |v125|
    v_mul_f32_e64 v126, v126, |v126|
    v_mul_f32_e64 v127, v127, |v127|
    v_cvt_pk_bf16_f32 v156, v108, v109
    v_cvt_pk_bf16_f32 v157, v110, v111
    v_cvt_pk_bf16_f32 v158, v124, v125
    v_cvt_pk_bf16_f32 v159, v126, v127
    v_pk_max_i16 v156, v156, 0
    v_pk_max_i16 v157, v157, 0
    v_pk_max_i16 v158, v158, 0
    v_pk_max_i16 v159, v159, 0
    buffer_store_dwordx4 v[156:159], v2, s[64:67], s78 offen sc1
    s_add_u32 s78, s78, 114688
    v_mul_f32_e64 v112, v112, |v112|
    v_mul_f32_e64 v113, v113, |v113|
    v_mul_f32_e64 v114, v114, |v114|
    v_mul_f32_e64 v115, v115, |v115|
    v_mul_f32_e64 v128, v128, |v128|
    v_mul_f32_e64 v129, v129, |v129|
    v_mul_f32_e64 v130, v130, |v130|
    v_mul_f32_e64 v131, v131, |v131|
    v_cvt_pk_bf16_f32 v160, v112, v113
    v_cvt_pk_bf16_f32 v161, v114, v115
    v_cvt_pk_bf16_f32 v162, v128, v129
    v_cvt_pk_bf16_f32 v163, v130, v131
    v_pk_max_i16 v160, v160, 0
    v_pk_max_i16 v161, v161, 0
    v_pk_max_i16 v162, v162, 0
    v_pk_max_i16 v163, v163, 0
    buffer_store_dwordx4 v[160:163], v2, s[64:67], s78 offen sc1
    s_add_u32 s78, s78, 114688
    v_mul_f32_e64 v116, v116, |v116|
    v_mul_f32_e64 v117, v117, |v117|
    v_mul_f32_e64 v118, v118, |v118|
    v_mul_f32_e64 v119, v119, |v119|
    v_mul_f32_e64 v132, v132, |v132|
    v_mul_f32_e64 v133, v133, |v133|
    v_mul_f32_e64 v134, v134, |v134|
    v_mul_f32_e64 v135, v135, |v135|
    v_cvt_pk_bf16_f32 v164, v116, v117
    v_cvt_pk_bf16_f32 v165, v118, v119
    v_cvt_pk_bf16_f32 v166, v132, v133
    v_cvt_pk_bf16_f32 v167, v134, v135
    v_pk_max_i16 v164, v164, 0
    v_pk_max_i16 v165, v165, 0
    v_pk_max_i16 v166, v166, 0
    v_pk_max_i16 v167, v167, 0
    buffer_store_dwordx4 v[164:167], v2, s[64:67], s78 offen sc1
    s_branch G4_en3
G4_eq3:
    s_lshl_b32 s78, s72, 15
    s_lshl_b32 s73, s71, 11
    s_add_u32 s78, s78, s73
    s_add_u32 s78, s78, 4194304
    s_add_u32 s79, s78, 65536
    s_mov_b32 s76, 1048744942
    s_mov_b32 s77, s76
    v_pk_mul_f32 v[104:105], v[104:105], s[76:77]
    v_pk_mul_f32 v[106:107], v[106:107], s[76:77]
    v_pk_mul_f32 v[120:121], v[120:121], s[76:77]
    v_pk_mul_f32 v[122:123], v[122:123], s[76:77]
    v_cvt_pk_bf16_f32 v152, v104, v105
    v_cvt_pk_bf16_f32 v153, v106, v107
    v_cvt_pk_bf16_f32 v154, v120, v121
    v_cvt_pk_bf16_f32 v155, v122, v123
    buffer_store_dwordx4 v[152:155], v4, s[64:67], s78 offen offset:0 sc1
    v_pk_mul_f32 v[108:109], v[108:109], s[76:77]
    v_pk_mul_f32 v[110:111], v[110:111], s[76:77]
    v_pk_mul_f32 v[124:125], v[124:125], s[76:77]
    v_pk_mul_f32 v[126:127], v[126:127], s[76:77]
    v_cvt_pk_bf16_f32 v156, v108, v109
    v_cvt_pk_bf16_f32 v157, v110, v111
    v_cvt_pk_bf16_f32 v158, v124, v125
    v_cvt_pk_bf16_f32 v159, v126, v127
    buffer_store_dwordx4 v[156:159], v4, s[64:67], s78 offen offset:256 sc1
    v_pk_mul_f32 v[112:113], v[112:113], s[76:77]
    v_pk_mul_f32 v[114:115], v[114:115], s[76:77]
    v_pk_mul_f32 v[128:129], v[128:129], s[76:77]
    v_pk_mul_f32 v[130:131], v[130:131], s[76:77]
    v_cvt_pk_bf16_f32 v160, v112, v113
    v_cvt_pk_bf16_f32 v161, v114, v115
    v_cvt_pk_bf16_f32 v162, v128, v129
    v_cvt_pk_bf16_f32 v163, v130, v131
    buffer_store_dwordx4 v[160:163], v4, s[64:67], s79 offen offset:0 sc1
    v_pk_mul_f32 v[116:117], v[116:117], s[76:77]
    v_pk_mul_f32 v[118:119], v[118:119], s[76:77]
    v_pk_mul_f32 v[132:133], v[132:133], s[76:77]
    v_pk_mul_f32 v[134:135], v[134:135], s[76:77]
    v_cvt_pk_bf16_f32 v164, v116, v117
    v_cvt_pk_bf16_f32 v165, v118, v119
    v_cvt_pk_bf16_f32 v166, v132, v133
    v_cvt_pk_bf16_f32 v167, v134, v135
    buffer_store_dwordx4 v[164:167], v4, s[64:67], s79 offen offset:256 sc1
G4_en3:
    s_add_u32 s71, s71, 1
    s_nop 0
    s_waitcnt vmcnt(0)
G4_join:
    s_barrier
    s_mov_b32 s59, 0
    s_lshl_b32 s71, s48, 2
    s_or_b32 s71, s71, s45
    s_cmp_lg_u32 s71, 0
    s_cbranch_scc1 G4_nosig
    s_lshl_b32 s72, s68, 2
    s_add_u32 s72, s72, 128
    s_add_u32 s73, s68, 32
    s_cmp_le_u32 s69, 3
    s_cselect_b32 s72, s72, s73
    s_cselect_b32 s73, 15, 1
    s_lshl_b32 s72, s72, 7
    s_add_u32 s72, s72, 10485760
    v_lshlrev_b32 v2, 7, v0
    s_cmp_le_u32 s69, 3
    s_cselect_b32 s74, 1, 4
    v_mov_b32 v3, s74
    s_mov_b32 exec_lo, s73
    s_mov_b32 exec_hi, 0
    buffer_atomic_add v3, v2, s[64:67], s72 offen
    s_mov_b64 exec, -1
G4_nosig:
    s_sub_u32 s71, s69, 9
    s_cmp_le_u32 s69, 4
    s_cselect_b32 s71, s69, s71
    s_mul_i32 s47, s68, 7
    s_add_u32 s47, s47, s71
    s_mov_b32 s66, 0
    s_mov_b32 s68, 0
G1_end:
    s_load_dwordx2 s[4:5], s[0:1], 96
    s_load_dwordx2 s[6:7], s[0:1], 64
    s_load_dwordx2 s[30:31], s[0:1], 32
    v_lshrrev_b32 v1, 6, v0
    s_nop 0
    v_readfirstlane_b32 s16, v1
    v_and_b32 v1, 63, v0
    v_lshlrev_b32 v165, 4, v1
    v_mov_b32 v175, 0
    s_mov_b32 s20, 0
    s_lshr_b32 s26, s16, 2
    s_lshr_b32 s23, s2, 2
    s_and_b32 s24, s2, 3
    s_lshl_b32 s24, s24, 2
    s_and_b32 s21, s16, 3
    s_add_u32 s24, s24, s21
    s_lshl_b32 s24, s24, 1
    s_add_u32 s24, s24, s26
    s_lshl_b32 s23, s23, 16
    s_lshl_b32 s21, s24, 11
    s_add_u32 s21, s21, s23
    s_add_u32 s21, s21, 4194304
    s_lshl_b32 s25, s24, 10
    s_add_u32 s25, s25, s23
    s_add_u32 s25, s25, 33554432
    s_lshl_b32 s17, s16, 11
    s_lshl_b32 s27, s26, 16
    s_and_b32 s78, s2, 1
    s_bfe_u32 s76, s2, 0x10001
    s_lshl_b32 s76, s76, 3
    s_bfe_u32 s23, s2, 0x30003
    s_add_u32 s76, s76, s23
    s_bfe_u32 s77, s2, 0x10002
    s_lshl_b32 s77, s77, 2
    s_bfe_u32 s23, s2, 0x20006
    s_add_u32 s77, s77, s23
    s_waitcnt lgkmcnt(0)
    s_mov_b32 s8, s4
    s_and_b32 s9, s5, 0xffff
    s_mov_b32 s10, 268435456
    s_mov_b32 s11, 0x00020000
    s_add_u32 s12, s4, 8388608
    s_addc_u32 s23, s5, 0
    s_and_b32 s13, s23, 0xffff
    s_mov_b32 s14, 262144
    s_mov_b32 s15, 0x00020000
    s_add_u32 s60, s4, 10485760
    s_addc_u32 s23, s5, 0
    s_and_b32 s61, s23, 0xffff
    s_mov_b32 s62, 65536
    s_mov_b32 s63, 0x00020000
    s_cmp_eq_u32 s26, 0
    s_cbranch_scc1 P3_qkv_ok
    s_lshr_b32 s23, s2, 4
    s_lshl_b32 s23, s23, 2
    s_and_b32 s24, s16, 3
    s_add_u32 s23, s23, s24
    s_add_u32 s23, s23, 128
    s_lshl_b32 s23, s23, 7
    s_and_b32 s79, s2, 15
    s_lshl_b32 s79, s79, 2
    s_add_u32 s24, s24, s79
    s_add_u32 s24, s24, 64
    s_lshl_b32 s24, s24, 7
P3_qkv_poll:
    buffer_load_dword v2, v175, s[60:63], s23 offen sc1
    buffer_load_dword v3, v175, s[60:63], s24 offen sc1
    s_waitcnt vmcnt(0)
    v_readfirstlane_b32 s79, v2
    v_readfirstlane_b32 s3, v3
    s_cmp_ge_u32 s79, 4
    s_cselect_b32 s3, s3, 0
    s_cmp_ge_u32 s3, 32
    s_cbranch_scc1 P3_qkv_ok
    s_sleep 6
    s_branch P3_qkv_poll
P3_qkv_ok:
    s_mul_i32 s23, s26, 126976
    s_cmp_eq_u32 s26, 0
    s_cselect_b32 s23, 0x40000000, s23
    v_add_u32 v173, s23, v165
    s_xor_b32 s83, s26, 1
    s_cmp_eq_u32 s26, 0
    s_cbranch_scc1 P3_noq
    s_and_b32 s23, s16, 3
    s_lshl_b32 s24, s23, 12
    s_add_u32 m0, s24, 131072
    s_sub_u32 s24, s21, 2048
    buffer_load_dwordx4 v165, s[8:11], s24 offen offset:0 sc1 lds
    buffer_load_dwordx4 v165, s[8:11], s24 offen offset:1024 sc1 lds
    buffer_load_dwordx4 v165, s[8:11], s24 offen offset:2048 sc1 lds
    buffer_load_dwordx4 v165, s[8:11], s24 offen offset:3072 sc1 lds
    s_lshl_b32 s24, s23, 10
    s_add_u32 m0, s24, 147456
    s_lshr_b32 s24, s23, 1
    s_lshl_b32 s24, s24, 16
    s_and_b32 s23, s23, 1
    s_lshl_b32 s23, s23, 10
    s_add_u32 s24, s24, s23
    buffer_load_dwordx4 v165, s[12:15], s24 offen sc1 lds
P3_noq:
    s_bfe_u32 s18, s16, 0x10001
    s_lshl_b32 s18, s18, 11
    s_add_u32 s18, s18, s27
    s_and_b32 s23, s16, 1
    s_cmp_eq_u32 s23, 0
    s_mov_b32 s23, 131072
    s_cselect_b32 s23, 2048, s23
    s_add_u32 s18, s18, s23
    s_mov_b32 s22, 0
    s_and_b32 s23, s16, 3
    s_lshl_b32 s81, s23, 12
    s_lshr_b32 s82, s23, 1
    s_lshl_b32 s82, s82, 16
    s_and_b32 s23, s23, 1
    s_lshl_b32 s23, s23, 11
    s_add_u32 s82, s82, s23
    s_add_u32 s82, s82, 2048
    s_add_u32 s23, s81, 131072
    s_cmp_eq_u32 s26, 0
    s_cselect_b32 s81, s23, s81
    s_cselect_b32 s82, 0x10000000, s82
    s_mov_b32 s84, 4096
    s_cselect_b32 s84, 4194304, s84
    s_mov_b32 s72, s12
    s_mov_b32 s73, s13
    s_mov_b32 s74, s14
    s_mov_b32 s75, 0x00020000
    s_cbranch_scc1 P3_nb1
    s_add_u32 m0, s81, s22
    s_xor_b32 s22, s22, 16384
    buffer_load_dwordx4 v165, s[72:75], s82 offen sc1 lds
    buffer_load_dwordx4 v165, s[72:75], s82 offen offset:1024 sc1 lds
    buffer_load_dwordx4 v173, s[72:75], s82 offen offset:2048 sc1 lds
    buffer_load_dwordx4 v173, s[72:75], s82 offen offset:3072 sc1 lds
    s_add_u32 s82, s82, s84
    s_add_u32 s18, s18, 4096
    s_branch P3_nc1
P3_nb1:
    s_xor_b32 s22, s22, 16384
    s_add_u32 s18, s18, 4096
P3_nc1:
    s_xor_b32 s24, s78, 0
    s_lshl_b32 s24, s24, 7
    s_lshl_b32 s23, s77, 8
    s_add_u32 s23, s23, s24
    s_sub_u32 s79, 3670016, s23
    s_mul_i32 s24, s78, 3670016
    s_add_u32 s23, s23, s24
    s_add_u32 s36, s6, s23
    s_addc_u32 s24, s7, 0
    s_and_b32 s37, s24, 0xffff
    s_mov_b32 s38, s79
    s_mov_b32 s39, 0x00020000
    s_xor_b32 s24, s78, 1
    s_lshl_b32 s24, s24, 7
    s_lshl_b32 s23, s77, 8
    s_add_u32 s23, s23, s24
    s_sub_u32 s79, 3670016, s23
    s_mul_i32 s24, s78, 3670016
    s_add_u32 s23, s23, s24
    s_add_u32 s40, s6, s23
    s_addc_u32 s24, s7, 0
    s_and_b32 s41, s24, 0xffff
    s_mov_b32 s42, s79
    s_mov_b32 s43, 0x00020000
    s_lshl_b32 s23, s76, 3
    s_add_u32 s79, s23, s16
    s_mul_i32 s23, s79, 114688
    s_mul_i32 s24, s78, 57344
    s_add_u32 s23, s23, s24
    s_add_u32 s23, s23, 16777216
    s_add_u32 s32, s4, s23
    s_addc_u32 s24, s5, 0
    s_and_b32 s33, s24, 0xffff
    s_mov_b32 s34, 57344
    s_mov_b32 s35, 0x00020000
    v_and_b32 v2, 63, v0
    v_lshrrev_b32 v3, 3, v2
    v_and_b32 v4, 7, v2
    v_bfe_u32 v5, v2, 4, 2
    v_lshlrev_b32 v5, 1, v5
    v_xor_b32 v4, v4, v5
    v_lshlrev_b32 v4, 4, v4
    s_lshl_b32 s23, s16, 3
    v_add_u32 v3, s23, v3
    v_mul_u32_u24 v3, 2048, v3
    v_add_u32 v7, v3, v4
    s_lshl_b32 s23, s79, 15
    s_add_u32 s23, s23, 33554432
    s_add_u32 s48, s4, s23
    s_addc_u32 s24, s5, 0
    s_and_b32 s49, s24, 0xffff
    s_mov_b32 s50, 32768
    s_mov_b32 s51, 0x00020000
    s_lshl_b32 s23, s77, 8
    s_lshl_b32 s24, s78, 7
    s_add_u32 s23, s23, s24
    s_sub_u32 s79, 2097152, s23
    s_add_u32 s52, s30, s23
    s_addc_u32 s24, s31, 0
    s_and_b32 s53, s24, 0xffff
    s_mov_b32 s54, s79
    s_mov_b32 s55, 0x00020000
    v_and_b32 v166, 3, v1
    v_bfe_u32 v167, v1, 4, 1
    v_mov_b32 v168, 0x3f803f80
    v_cmp_eq_u32 vcc, v166, v167
    s_nop 1
    v_cndmask_b32 v152, 0, v168, vcc
    v_cndmask_b32 v153, 0, v168, vcc
    v_cndmask_b32 v154, 0, v168, vcc
    v_cndmask_b32 v155, 0, v168, vcc
    v_add_u32 v167, 2, v167
    v_cmp_eq_u32 vcc, v166, v167
    s_nop 1
    v_cndmask_b32 v156, 0, v168, vcc
    v_cndmask_b32 v157, 0, v168, vcc
    v_cndmask_b32 v158, 0, v168, vcc
    v_cndmask_b32 v159, 0, v168, vcc
    v_mov_b32 v88, 0
    v_mov_b32 v89, 0
    v_mov_b32 v90, 0
    v_mov_b32 v91, 0
    v_mov_b32 v92, 0
    v_mov_b32 v93, 0
    v_mov_b32 v94, 0
    v_mov_b32 v95, 0
    v_mov_b32 v96, 0
    v_mov_b32 v97, 0
    v_mov_b32 v98, 0
    v_mov_b32 v99, 0
    v_mov_b32 v100, 0
    v_mov_b32 v101, 0
    v_mov_b32 v102, 0
    v_mov_b32 v103, 0
    v_mov_b32 v104, 0
    v_mov_b32 v105, 0
    v_mov_b32 v106, 0
    v_mov_b32 v107, 0
    v_mov_b32 v108, 0
    v_mov_b32 v109, 0
    v_mov_b32 v110, 0
    v_mov_b32 v111, 0
    v_mov_b32 v112, 0
    v_mov_b32 v113, 0
    v_mov_b32 v114, 0
    v_mov_b32 v115, 0
    v_mov_b32 v116, 0
    v_mov_b32 v117, 0
    v_mov_b32 v118, 0
    v_mov_b32 v119, 0
    v_mov_b32 v160, 0
    v_mov_b32 v161, 0
    v_mov_b32 v162, 0
    v_mov_b32 v163, 0
    v_mov_b32 v128, 0
    v_mov_b32 v129, 0
    v_mov_b32 v130, 0
    v_mov_b32 v131, 0
    v_mov_b32 v132, 0
    v_mov_b32 v133, 0
    v_mov_b32 v134, 0
    v_mov_b32 v135, 0
    s_and_b32 s23, s16, 3
    s_lshl_b32 s23, s23, 12
    s_lshl_b32 s24, s26, 11
    s_add_u32 s23, s23, s24
    s_add_u32 s23, s23, 131072
    v_add_u32 v2, s23, v165
    v_xor_b32 v3, 2048, v2
    s_add_u32 s24, s24, 147456
    v_add_u32 v4, s24, v165
    v_add_u32 v5, 147456, v165
    s_nop 0
    s_mov_b32 s23, s83
    s_cmp_lg_u32 s23, 0
    s_cbranch_scc1 P3_now
    s_waitcnt vmcnt(0)
P3_now:
    s_barrier
    s_cmp_lg_u32 s26, 1
    s_cbranch_scc1 P3_r1
    s_add_u32 m0, s81, 16384
    s_nop 0
    buffer_load_dwordx4 v165, s[12:15], s82 offen sc1 lds
    buffer_load_dwordx4 v165, s[12:15], s82 offen offset:1024 sc1 lds
    buffer_load_dwordx4 v173, s[12:15], s82 offen offset:2048 sc1 lds
    buffer_load_dwordx4 v173, s[12:15], s82 offen offset:3072 sc1 lds
    s_add_u32 s82, s82, 4096
P3_r1:
    s_cmp_lg_u32 s26, 1
    s_cbranch_scc1 P3_r2
    s_add_u32 m0, s81, 98304
    s_nop 0
    buffer_load_dwordx4 v165, s[12:15], s82 offen sc1 lds
    buffer_load_dwordx4 v165, s[12:15], s82 offen offset:1024 sc1 lds
    buffer_load_dwordx4 v173, s[12:15], s82 offen offset:2048 sc1 lds
    buffer_load_dwordx4 v173, s[12:15], s82 offen offset:3072 sc1 lds
    s_add_u32 s82, s82, 4096
P3_r2:
    s_cmp_lg_u32 s26, 1
    s_cbranch_scc1 P3_r3
    s_add_u32 m0, s81, 114688
    s_nop 0
    buffer_load_dwordx4 v165, s[12:15], s82 offen sc1 lds
    buffer_load_dwordx4 v165, s[12:15], s82 offen offset:1024 sc1 lds
    buffer_load_dwordx4 v173, s[12:15], s82 offen offset:2048 sc1 lds
    buffer_load_dwordx4 v173, s[12:15], s82 offen offset:3072 sc1 lds
    s_add_u32 s82, s82, 4096
P3_r3:
    ds_read_b128 v[144:147], v5
    ds_read_b128 v[148:151], v5 offset:1024
    ds_read_b128 v[8:11], v2
    ds_read_b128 v[12:15], v2 offset:1024
    ds_read_b128 v[16:19], v3
    ds_read_b128 v[20:23], v3 offset:1024
    ds_read_b128 v[136:139], v4
    ds_read_b128 v[140:143], v4 offset:1024
    s_waitcnt lgkmcnt(0)
    v_mfma_f32_32x32x16_bf16 v[56:71], v[144:147], v[8:11], 0
    v_mfma_f32_32x32x16_bf16 v[56:71], v[148:151], v[12:15], v[56:71]
    v_mfma_f32_32x32x16_bf16 v[72:87], v[144:147], v[16:19], 0
    v_mfma_f32_32x32x16_bf16 v[72:87], v[148:151], v[20:23], v[72:87]
    s_nop 9
    v_max_f32 v166, v56, v57
    v_max3_f32 v166, v58, v59, v166
    v_max3_f32 v166, v60, v61, v166
    v_max3_f32 v166, v62, v63, v166
    v_max3_f32 v166, v64, v65, v166
    v_max3_f32 v166, v66, v67, v166
    v_max3_f32 v166, v68, v69, v166
    v_max3_f32 v166, v70, v71, v166
    v_max_f32 v167, v72, v73
    v_max3_f32 v167, v74, v75, v167
    v_max3_f32 v167, v76, v77, v167
    v_max3_f32 v167, v78, v79, v167
    v_max3_f32 v167, v80, v81, v167
    v_max3_f32 v167, v82, v83, v167
    v_max3_f32 v167, v84, v85, v167
    v_max3_f32 v167, v86, v87, v167
    v_mov_b32 v170, v166
    s_nop 1
    v_permlane32_swap_b32 v170, v166
    v_max_f32 v166, v166, v170
    v_sub_f32 v24, 0, v166
    v_mov_b32 v25, v24
    v_mov_b32 v26, v24
    v_mov_b32 v27, v24
    v_mov_b32 v28, v24
    v_mov_b32 v29, v24
    v_mov_b32 v30, v24
    v_mov_b32 v31, v24
    v_mov_b32 v32, v24
    v_mov_b32 v33, v24
    v_mov_b32 v34, v24
    v_mov_b32 v35, v24
    v_mov_b32 v36, v24
    v_mov_b32 v37, v24
    v_mov_b32 v38, v24
    v_mov_b32 v39, v24
    v_mov_b32 v170, v167
    s_nop 1
    v_permlane32_swap_b32 v170, v167
    v_max_f32 v167, v167, v170
    v_sub_f32 v40, 0, v167
    v_mov_b32 v41, v40
    v_mov_b32 v42, v40
    v_mov_b32 v43, v40
    v_mov_b32 v44, v40
    v_mov_b32 v45, v40
    v_mov_b32 v46, v40
    v_mov_b32 v47, v40
    v_mov_b32 v48, v40
    v_mov_b32 v49, v40
    v_mov_b32 v50, v40
    v_mov_b32 v51, v40
    v_mov_b32 v52, v40
    v_mov_b32 v53, v40
    v_mov_b32 v54, v40
    v_mov_b32 v55, v40
    s_mov_b32 s80, 4
    s_branch AT_go
AT_restart:
    s_bfe_u32 s18, s16, 0x10001
    s_lshl_b32 s18, s18, 11
    s_add_u32 s18, s18, s27
    s_and_b32 s23, s16, 1
    s_cmp_eq_u32 s23, 0
    s_mov_b32 s23, 131072
    s_cselect_b32 s23, 2048, s23
    s_add_u32 s18, s18, s23
    s_mov_b32 s22, 0
    s_and_b32 s23, s16, 3
    s_lshl_b32 s81, s23, 12
    s_lshr_b32 s82, s23, 1
    s_lshl_b32 s82, s82, 16
    s_and_b32 s23, s23, 1
    s_lshl_b32 s23, s23, 11
    s_add_u32 s82, s82, s23
    s_add_u32 s82, s82, 2048
    s_add_u32 s23, s81, 131072
    s_cmp_eq_u32 s26, 0
    s_cselect_b32 s81, s23, s81
    s_cselect_b32 s82, 0x10000000, s82
    s_mov_b32 s84, 4096
    s_cselect_b32 s84, 4194304, s84
    s_mov_b32 s72, s12
    s_mov_b32 s73, s13
    s_mov_b32 s74, s14
    s_mov_b32 s75, 0x00020000
    s_cbranch_scc1 P3_nb2
    s_add_u32 m0, s81, s22
    s_xor_b32 s22, s22, 16384
    buffer_load_dwordx4 v165, s[72:75], s82 offen sc1 lds
    buffer_load_dwordx4 v165, s[72:75], s82 offen offset:1024 sc1 lds
    buffer_load_dwordx4 v173, s[72:75], s82 offen offset:2048 sc1 lds
    buffer_load_dwordx4 v173, s[72:75], s82 offen offset:3072 sc1 lds
    s_add_u32 s82, s82, s84
    s_add_u32 s18, s18, 4096
    s_branch P3_nc2
P3_nb2:
    s_xor_b32 s22, s22, 16384
    s_add_u32 s18, s18, 4096
P3_nc2:
    buffer_load_dwordx4 v[136:139], v165, s[12:15], s27 offen offset:0 sc1
    buffer_load_dwordx4 v[140:143], v165, s[12:15], s27 offen offset:1024 sc1
    v_mov_b32 v88, 0
    v_mov_b32 v89, 0
    v_mov_b32 v90, 0
    v_mov_b32 v91, 0
    v_mov_b32 v92, 0
    v_mov_b32 v93, 0
    v_mov_b32 v94, 0
    v_mov_b32 v95, 0
    v_mov_b32 v96, 0
    v_mov_b32 v97, 0
    v_mov_b32 v98, 0
    v_mov_b32 v99, 0
    v_mov_b32 v100, 0
    v_mov_b32 v101, 0
    v_mov_b32 v102, 0
    v_mov_b32 v103, 0
    v_mov_b32 v104, 0
    v_mov_b32 v105, 0
    v_mov_b32 v106, 0
    v_mov_b32 v107, 0
    v_mov_b32 v108, 0
    v_mov_b32 v109, 0
    v_mov_b32 v110, 0
    v_mov_b32 v111, 0
    v_mov_b32 v112, 0
    v_mov_b32 v113, 0
    v_mov_b32 v114, 0
    v_mov_b32 v115, 0
    v_mov_b32 v116, 0
    v_mov_b32 v117, 0
    v_mov_b32 v118, 0
    v_mov_b32 v119, 0
    v_mov_b32 v160, 0
    v_mov_b32 v161, 0
    v_mov_b32 v162, 0
    v_mov_b32 v163, 0
    v_mov_b32 v128, 0
    v_mov_b32 v129, 0
    v_mov_b32 v130, 0
    v_mov_b32 v131, 0
    v_mov_b32 v132, 0
    v_mov_b32 v133, 0
    v_mov_b32 v134, 0
    v_mov_b32 v135, 0
    s_mov_b32 s80, 0
    s_waitcnt vmcnt(0)
AT_go:
    s_lshl_b32 s23, s26, 13
    v_add_u32 v164, s23, v165
    v_mfma_f32_32x32x16_bf16 v[56:71], v[136:139], v[8:11], v[24:39]
    v_mfma_f32_32x32x16_bf16 v[56:71], v[140:143], v[12:15], v[56:71]
    s_mov_b32 s19, 8
    s_nop 7
    s_cmp_lg_u32 s20, 0
    s_cbranch_scc1 AT_loopB
    s_setprio 3
    v_mfma_f32_32x32x16_bf16 v[72:87], v[136:139], v[16:19], v[40:55]
    buffer_store_dwordx4 v[176:179], v165, s[64:67], s68 offen offset:0 sc1
    v_exp_f32 v56, v56
    v_exp_f32 v57, v57
    v_exp_f32 v58, v58
    v_exp_f32 v59, v59
    v_cvt_pk_bf16_f32 v120, v56, v57
    v_mfma_f32_32x32x16_bf16 v[72:87], v[140:143], v[20:23], v[72:87]
    ds_read_b128 v[136:139], v164 offset:0
    ds_read_b128 v[140:143], v164 offset:1024
    buffer_store_dwordx4 v[192:195], v165, s[64:67], s68 offen offset:1024 sc1
    v_exp_f32 v60, v60
    v_exp_f32 v61, v61
    v_cvt_pk_bf16_f32 v121, v58, v59
    v_exp_f32 v62, v62
    v_exp_f32 v63, v63
    v_mfma_f32_32x32x16_bf16 v[104:119], v[144:147], v[128:131], v[104:119]
    v_cvt_pk_bf16_f32 v122, v60, v61
    v_exp_f32 v64, v64
    v_exp_f32 v65, v65
    v_cvt_pk_bf16_f32 v123, v62, v63
    v_exp_f32 v66, v66
    v_mfma_f32_16x16x32_bf16 v[160:163], v[156:159], v[128:131], v[160:163]
    v_exp_f32 v67, v67
    v_cvt_pk_bf16_f32 v124, v64, v65
    v_mfma_f32_32x32x16_bf16 v[104:119], v[148:151], v[132:135], v[104:119]
    ds_read_b128 v[144:147], v164 offset:2048
    ds_read_b128 v[148:151], v164 offset:3072
    v_exp_f32 v68, v68
    v_exp_f32 v69, v69
    v_cvt_pk_bf16_f32 v125, v66, v67
    v_exp_f32 v70, v70
    v_exp_f32 v71, v71
    v_mfma_f32_16x16x32_bf16 v[160:163], v[156:159], v[132:135], v[160:163]
    v_cvt_pk_bf16_f32 v126, v68, v69
    v_cvt_pk_bf16_f32 v127, v70, v71
    s_waitcnt lgkmcnt(2)
    v_mfma_f32_32x32x16_bf16 v[56:71], v[136:139], v[8:11], v[24:39]
    buffer_store_dwordx4 v[208:211], v165, s[64:67], s68 offen offset:2048 sc1
    v_exp_f32 v72, v72
    v_exp_f32 v73, v73
    v_exp_f32 v74, v74
    v_exp_f32 v75, v75
    v_cvt_pk_bf16_f32 v128, v72, v73
    v_mfma_f32_32x32x16_bf16 v[56:71], v[140:143], v[12:15], v[56:71]
    v_exp_f32 v76, v76
    v_exp_f32 v77, v77
    v_cvt_pk_bf16_f32 v129, v74, v75
    v_exp_f32 v78, v78
    v_exp_f32 v79, v79
    s_waitcnt lgkmcnt(0)
    v_mfma_f32_32x32x16_bf16 v[88:103], v[144:147], v[120:123], v[88:103]
    v_cvt_pk_bf16_f32 v130, v76, v77
    v_exp_f32 v80, v80
    v_exp_f32 v81, v81
    v_cvt_pk_bf16_f32 v131, v78, v79
    v_exp_f32 v82, v82
    v_mfma_f32_16x16x32_bf16 v[160:163], v[152:155], v[120:123], v[160:163]
    v_exp_f32 v83, v83
    v_cvt_pk_bf16_f32 v132, v80, v81
    v_mfma_f32_32x32x16_bf16 v[88:103], v[148:151], v[124:127], v[88:103]
    v_exp_f32 v84, v84
    v_exp_f32 v85, v85
    v_cvt_pk_bf16_f32 v133, v82, v83
    v_exp_f32 v86, v86
    v_exp_f32 v87, v87
    v_mfma_f32_16x16x32_bf16 v[160:163], v[152:155], v[124:127], v[160:163]
    v_cvt_pk_bf16_f32 v134, v84, v85
    v_cvt_pk_bf16_f32 v135, v86, v87
    s_setprio 2
    v_mfma_f32_32x32x16_bf16 v[72:87], v[136:139], v[16:19], v[40:55]
    buffer_store_dwordx4 v[224:227], v165, s[64:67], s68 offen offset:3072 sc1
    s_add_u32 s68, s68, 4096
    v_exp_f32 v56, v56
    v_exp_f32 v57, v57
    v_exp_f32 v58, v58
    v_exp_f32 v59, v59
    v_cvt_pk_bf16_f32 v120, v56, v57
    v_mfma_f32_32x32x16_bf16 v[72:87], v[140:143], v[20:23], v[72:87]
    ds_read_b128 v[136:139], v164 offset:4096
    ds_read_b128 v[140:143], v164 offset:5120
    v_exp_f32 v60, v60
    v_exp_f32 v61, v61
    v_cvt_pk_bf16_f32 v121, v58, v59
    v_exp_f32 v62, v62
    v_exp_f32 v63, v63
    v_mfma_f32_32x32x16_bf16 v[104:119], v[144:147], v[128:131], v[104:119]
    v_cvt_pk_bf16_f32 v122, v60, v61
    v_exp_f32 v64, v64
    v_exp_f32 v65, v65
    v_cvt_pk_bf16_f32 v123, v62, v63
    v_exp_f32 v66, v66
    v_mfma_f32_16x16x32_bf16 v[160:163], v[156:159], v[128:131], v[160:163]
    v_exp_f32 v67, v67
    v_cvt_pk_bf16_f32 v124, v64, v65
    v_mfma_f32_32x32x16_bf16 v[104:119], v[148:151], v[132:135], v[104:119]
    ds_read_b128 v[144:147], v164 offset:6144
    ds_read_b128 v[148:151], v164 offset:7168
    v_exp_f32 v68, v68
    v_exp_f32 v69, v69
    v_cvt_pk_bf16_f32 v125, v66, v67
    v_exp_f32 v70, v70
    v_exp_f32 v71, v71
    v_mfma_f32_16x16x32_bf16 v[160:163], v[156:159], v[132:135], v[160:163]
    v_cvt_pk_bf16_f32 v126, v68, v69
    v_cvt_pk_bf16_f32 v127, v70, v71
    s_waitcnt lgkmcnt(2)
    v_mfma_f32_32x32x16_bf16 v[56:71], v[136:139], v[8:11], v[24:39]
    buffer_store_dwordx4 v[240:243], v165, s[64:67], s68 offen offset:0 sc1
    s_add_u32 s68, s68, 110592
    v_exp_f32 v72, v72
    v_exp_f32 v73, v73
    v_exp_f32 v74, v74
    v_exp_f32 v75, v75
    v_cvt_pk_bf16_f32 v128, v72, v73
    v_mfma_f32_32x32x16_bf16 v[56:71], v[140:143], v[12:15], v[56:71]
    v_exp_f32 v76, v76
    v_exp_f32 v77, v77
    v_cvt_pk_bf16_f32 v129, v74, v75
    v_exp_f32 v78, v78
    v_exp_f32 v79, v79
    s_waitcnt lgkmcnt(0)
    v_mfma_f32_32x32x16_bf16 v[88:103], v[144:147], v[120:123], v[88:103]
    v_cvt_pk_bf16_f32 v130, v76, v77
    v_exp_f32 v80, v80
    v_exp_f32 v81, v81
    v_cvt_pk_bf16_f32 v131, v78, v79
    v_exp_f32 v82, v82
    v_mfma_f32_16x16x32_bf16 v[160:163], v[152:155], v[120:123], v[160:163]
    v_exp_f32 v83, v83
    v_cvt_pk_bf16_f32 v132, v80, v81
    v_mfma_f32_32x32x16_bf16 v[88:103], v[148:151], v[124:127], v[88:103]
    v_exp_f32 v84, v84
    v_exp_f32 v85, v85
    v_cvt_pk_bf16_f32 v133, v82, v83
    v_exp_f32 v86, v86
    v_exp_f32 v87, v87
    v_mfma_f32_16x16x32_bf16 v[160:163], v[152:155], v[124:127], v[160:163]
    v_cvt_pk_bf16_f32 v134, v84, v85
    v_cvt_pk_bf16_f32 v135, v86, v87
    s_cmp_lg_u32 s26, 1
    s_cbranch_scc1 P3_r18
    s_waitcnt vmcnt(0)
P3_r18:
    s_barrier
    s_setprio 1
    v_mfma_f32_32x32x16_bf16 v[72:87], v[136:139], v[16:19], v[40:55]
    buffer_store_dwordx4 v[180:183], v165, s[64:67], s68 offen offset:0 sc1
    v_exp_f32 v56, v56
    v_exp_f32 v57, v57
    v_exp_f32 v58, v58
    v_exp_f32 v59, v59
    v_cvt_pk_bf16_f32 v120, v56, v57
    v_mfma_f32_32x32x16_bf16 v[72:87], v[140:143], v[20:23], v[72:87]
    ds_read_b128 v[136:139], v164 offset:16384
    ds_read_b128 v[140:143], v164 offset:17408
    buffer_store_dwordx4 v[196:199], v165, s[64:67], s68 offen offset:1024 sc1
    v_exp_f32 v60, v60
    v_exp_f32 v61, v61
    v_cvt_pk_bf16_f32 v121, v58, v59
    v_exp_f32 v62, v62
    v_exp_f32 v63, v63
    v_mfma_f32_32x32x16_bf16 v[104:119], v[144:147], v[128:131], v[104:119]
    v_cvt_pk_bf16_f32 v122, v60, v61
    v_exp_f32 v64, v64
    v_exp_f32 v65, v65
    v_cvt_pk_bf16_f32 v123, v62, v63
    v_exp_f32 v66, v66
    v_mfma_f32_16x16x32_bf16 v[160:163], v[156:159], v[128:131], v[160:163]
    v_exp_f32 v67, v67
    v_cvt_pk_bf16_f32 v124, v64, v65
    v_mfma_f32_32x32x16_bf16 v[104:119], v[148:151], v[132:135], v[104:119]
    ds_read_b128 v[144:147], v164 offset:18432
    ds_read_b128 v[148:151], v164 offset:19456
    v_exp_f32 v68, v68
    v_exp_f32 v69, v69
    v_cvt_pk_bf16_f32 v125, v66, v67
    v_exp_f32 v70, v70
    v_exp_f32 v71, v71
    v_mfma_f32_16x16x32_bf16 v[160:163], v[156:159], v[132:135], v[160:163]
    v_cvt_pk_bf16_f32 v126, v68, v69
    v_cvt_pk_bf16_f32 v127, v70, v71
    s_waitcnt lgkmcnt(2)
    v_mfma_f32_32x32x16_bf16 v[56:71], v[136:139], v[8:11], v[24:39]
    buffer_store_dwordx4 v[212:215], v165, s[64:67], s68 offen offset:2048 sc1
    v_exp_f32 v72, v72
    v_exp_f32 v73, v73
    v_exp_f32 v74, v74
    v_exp_f32 v75, v75
    v_cvt_pk_bf16_f32 v128, v72, v73
    v_mfma_f32_32x32x16_bf16 v[56:71], v[140:143], v[12:15], v[56:71]
    s_cmp_lg_u32 s26, 1
    s_cbranch_scc1 P3_r8
    s_add_u32 m0, s81, 65536
    s_nop 0
    buffer_load_dwordx4 v165, s[12:15], s82 offen sc1 lds
    buffer_load_dwordx4 v165, s[12:15], s82 offen offset:1024 sc1 lds
    buffer_load_dwordx4 v173, s[12:15], s82 offen offset:2048 sc1 lds
    buffer_load_dwordx4 v173, s[12:15], s82 offen offset:3072 sc1 lds
    s_add_u32 s82, s82, 4096
P3_r8:
    v_exp_f32 v76, v76
    v_exp_f32 v77, v77
    v_cvt_pk_bf16_f32 v129, v74, v75
    v_exp_f32 v78, v78
    v_exp_f32 v79, v79
    s_waitcnt lgkmcnt(0)
    v_mfma_f32_32x32x16_bf16 v[88:103], v[144:147], v[120:123], v[88:103]
    v_cvt_pk_bf16_f32 v130, v76, v77
    v_exp_f32 v80, v80
    v_exp_f32 v81, v81
    v_cvt_pk_bf16_f32 v131, v78, v79
    v_exp_f32 v82, v82
    v_mfma_f32_16x16x32_bf16 v[160:163], v[152:155], v[120:123], v[160:163]
    v_exp_f32 v83, v83
    v_cvt_pk_bf16_f32 v132, v80, v81
    v_mfma_f32_32x32x16_bf16 v[88:103], v[148:151], v[124:127], v[88:103]
    v_exp_f32 v84, v84
    v_exp_f32 v85, v85
    v_cvt_pk_bf16_f32 v133, v82, v83
    v_exp_f32 v86, v86
    v_exp_f32 v87, v87
    v_mfma_f32_16x16x32_bf16 v[160:163], v[152:155], v[124:127], v[160:163]
    v_cvt_pk_bf16_f32 v134, v84, v85
    v_cvt_pk_bf16_f32 v135, v86, v87
    s_setprio 0
    v_mfma_f32_32x32x16_bf16 v[72:87], v[136:139], v[16:19], v[40:55]
    buffer_store_dwordx4 v[228:231], v165, s[64:67], s68 offen offset:3072 sc1
    s_add_u32 s68, s68, 4096
    v_exp_f32 v56, v56
    v_exp_f32 v57, v57
    v_exp_f32 v58, v58
    v_exp_f32 v59, v59
    v_cvt_pk_bf16_f32 v120, v56, v57
    v_mfma_f32_32x32x16_bf16 v[72:87], v[140:143], v[20:23], v[72:87]
    ds_read_b128 v[136:139], v164 offset:20480
    ds_read_b128 v[140:143], v164 offset:21504
    v_exp_f32 v60, v60
    v_exp_f32 v61, v61
    v_cvt_pk_bf16_f32 v121, v58, v59
    v_exp_f32 v62, v62
    v_exp_f32 v63, v63
    v_mfma_f32_32x32x16_bf16 v[104:119], v[144:147], v[128:131], v[104:119]
    v_cvt_pk_bf16_f32 v122, v60, v61
    v_exp_f32 v64, v64
    v_exp_f32 v65, v65
    v_cvt_pk_bf16_f32 v123, v62, v63
    v_exp_f32 v66, v66
    v_mfma_f32_16x16x32_bf16 v[160:163], v[156:159], v[128:131], v[160:163]
    v_exp_f32 v67, v67
    v_cvt_pk_bf16_f32 v124, v64, v65
    v_mfma_f32_32x32x16_bf16 v[104:119], v[148:151], v[132:135], v[104:119]
    ds_read_b128 v[144:147], v164 offset:22528
    ds_read_b128 v[148:151], v164 offset:23552
    v_exp_f32 v68, v68
    v_exp_f32 v69, v69
    v_cvt_pk_bf16_f32 v125, v66, v67
    v_exp_f32 v70, v70
    v_exp_f32 v71, v71
    v_mfma_f32_16x16x32_bf16 v[160:163], v[156:159], v[132:135], v[160:163]
    v_cvt_pk_bf16_f32 v126, v68, v69
    v_cvt_pk_bf16_f32 v127, v70, v71
    s_waitcnt lgkmcnt(2)
    v_mfma_f32_32x32x16_bf16 v[56:71], v[136:139], v[8:11], v[24:39]
    buffer_store_dwordx4 v[244:247], v165, s[64:67], s68 offen offset:0 sc1
    s_add_u32 s68, s68, 110592
    v_exp_f32 v72, v72
    v_exp_f32 v73, v73
    v_exp_f32 v74, v74
    v_exp_f32 v75, v75
    v_cvt_pk_bf16_f32 v128, v72, v73
    v_mfma_f32_32x32x16_bf16 v[56:71], v[140:143], v[12:15], v[56:71]
    s_cmp_lg_u32 s26, 1
    s_cbranch_scc1 P3_r9
    s_add_u32 m0, s81, 81920
    s_nop 0
    buffer_load_dwordx4 v165, s[12:15], s82 offen sc1 lds
    buffer_load_dwordx4 v165, s[12:15], s82 offen offset:1024 sc1 lds
    buffer_load_dwordx4 v173, s[12:15], s82 offen offset:2048 sc1 lds
    buffer_load_dwordx4 v173, s[12:15], s82 offen offset:3072 sc1 lds
    s_add_u32 s82, s82, 4096
P3_r9:
    v_exp_f32 v76, v76
    v_exp_f32 v77, v77
    v_cvt_pk_bf16_f32 v129, v74, v75
    v_exp_f32 v78, v78
    v_exp_f32 v79, v79
    s_waitcnt lgkmcnt(0)
    v_mfma_f32_32x32x16_bf16 v[88:103], v[144:147], v[120:123], v[88:103]
    v_add_u32 v164, 98304, v164
    v_cvt_pk_bf16_f32 v130, v76, v77
    v_exp_f32 v80, v80
    v_exp_f32 v81, v81
    v_cvt_pk_bf16_f32 v131, v78, v79
    v_exp_f32 v82, v82
    v_mfma_f32_16x16x32_bf16 v[160:163], v[152:155], v[120:123], v[160:163]
    v_exp_f32 v83, v83
    v_cvt_pk_bf16_f32 v132, v80, v81
    v_mfma_f32_32x32x16_bf16 v[88:103], v[148:151], v[124:127], v[88:103]
    v_exp_f32 v84, v84
    v_exp_f32 v85, v85
    v_cvt_pk_bf16_f32 v133, v82, v83
    v_exp_f32 v86, v86
    v_exp_f32 v87, v87
    v_mfma_f32_16x16x32_bf16 v[160:163], v[152:155], v[124:127], v[160:163]
    v_cvt_pk_bf16_f32 v134, v84, v85
    v_cvt_pk_bf16_f32 v135, v86, v87
    s_setprio 3
    v_mfma_f32_32x32x16_bf16 v[72:87], v[136:139], v[16:19], v[40:55]
    buffer_store_dwordx4 v[184:187], v165, s[64:67], s68 offen offset:0 sc1
    v_exp_f32 v56, v56
    v_exp_f32 v57, v57
    v_exp_f32 v58, v58
    v_exp_f32 v59, v59
    v_cvt_pk_bf16_f32 v120, v56, v57
    v_mfma_f32_32x32x16_bf16 v[72:87], v[140:143], v[20:23], v[72:87]
    ds_read_b128 v[136:139], v164 offset:0
    ds_read_b128 v[140:143], v164 offset:1024
    buffer_store_dwordx4 v[200:203], v165, s[64:67], s68 offen offset:1024 sc1
    v_exp_f32 v60, v60
    v_exp_f32 v61, v61
    v_cvt_pk_bf16_f32 v121, v58, v59
    v_exp_f32 v62, v62
    v_exp_f32 v63, v63
    v_mfma_f32_32x32x16_bf16 v[104:119], v[144:147], v[128:131], v[104:119]
    v_cvt_pk_bf16_f32 v122, v60, v61
    v_exp_f32 v64, v64
    v_exp_f32 v65, v65
    v_cvt_pk_bf16_f32 v123, v62, v63
    v_exp_f32 v66, v66
    v_mfma_f32_16x16x32_bf16 v[160:163], v[156:159], v[128:131], v[160:163]
    v_exp_f32 v67, v67
    v_cvt_pk_bf16_f32 v124, v64, v65
    v_mfma_f32_32x32x16_bf16 v[104:119], v[148:151], v[132:135], v[104:119]
    ds_read_b128 v[144:147], v164 offset:2048
    ds_read_b128 v[148:151], v164 offset:3072
    v_exp_f32 v68, v68
    v_exp_f32 v69, v69
    v_cvt_pk_bf16_f32 v125, v66, v67
    v_exp_f32 v70, v70
    v_exp_f32 v71, v71
    v_mfma_f32_16x16x32_bf16 v[160:163], v[156:159], v[132:135], v[160:163]
    v_cvt_pk_bf16_f32 v126, v68, v69
    v_cvt_pk_bf16_f32 v127, v70, v71
    s_waitcnt lgkmcnt(2)
    v_mfma_f32_32x32x16_bf16 v[56:71], v[136:139], v[8:11], v[24:39]
    buffer_store_dwordx4 v[216:219], v165, s[64:67], s68 offen offset:2048 sc1
    v_exp_f32 v72, v72
    v_exp_f32 v73, v73
    v_exp_f32 v74, v74
    v_exp_f32 v75, v75
    v_cvt_pk_bf16_f32 v128, v72, v73
    v_mfma_f32_32x32x16_bf16 v[56:71], v[140:143], v[12:15], v[56:71]
    v_exp_f32 v76, v76
    v_exp_f32 v77, v77
    v_cvt_pk_bf16_f32 v129, v74, v75
    v_exp_f32 v78, v78
    v_exp_f32 v79, v79
    s_waitcnt lgkmcnt(0)
    v_mfma_f32_32x32x16_bf16 v[88:103], v[144:147], v[120:123], v[88:103]
    v_cvt_pk_bf16_f32 v130, v76, v77
    v_exp_f32 v80, v80
    v_exp_f32 v81, v81
    v_cvt_pk_bf16_f32 v131, v78, v79
    v_exp_f32 v82, v82
    v_mfma_f32_16x16x32_bf16 v[160:163], v[152:155], v[120:123], v[160:163]
    v_exp_f32 v83, v83
    v_cvt_pk_bf16_f32 v132, v80, v81
    v_mfma_f32_32x32x16_bf16 v[88:103], v[148:151], v[124:127], v[88:103]
    v_exp_f32 v84, v84
    v_exp_f32 v85, v85
    v_cvt_pk_bf16_f32 v133, v82, v83
    v_exp_f32 v86, v86
    v_exp_f32 v87, v87
    v_mfma_f32_16x16x32_bf16 v[160:163], v[152:155], v[124:127], v[160:163]
    v_cvt_pk_bf16_f32 v134, v84, v85
    v_cvt_pk_bf16_f32 v135, v86, v87
    s_setprio 2
    v_mfma_f32_32x32x16_bf16 v[72:87], v[136:139], v[16:19], v[40:55]
    buffer_store_dwordx4 v[232:235], v165, s[64:67], s68 offen offset:3072 sc1
    s_add_u32 s68, s68, 4096
    v_exp_f32 v56, v56
    v_exp_f32 v57, v57
    v_exp_f32 v58, v58
    v_exp_f32 v59, v59
    v_cvt_pk_bf16_f32 v120, v56, v57
    v_mfma_f32_32x32x16_bf16 v[72:87], v[140:143], v[20:23], v[72:87]
    ds_read_b128 v[136:139], v164 offset:4096
    ds_read_b128 v[140:143], v164 offset:5120
    v_exp_f32 v60, v60
    v_exp_f32 v61, v61
    v_cvt_pk_bf16_f32 v121, v58, v59
    v_exp_f32 v62, v62
    v_exp_f32 v63, v63
    v_mfma_f32_32x32x16_bf16 v[104:119], v[144:147], v[128:131], v[104:119]
    v_cvt_pk_bf16_f32 v122, v60, v61
    v_exp_f32 v64, v64
    v_exp_f32 v65, v65
    v_cvt_pk_bf16_f32 v123, v62, v63
    v_exp_f32 v66, v66
    v_mfma_f32_16x16x32_bf16 v[160:163], v[156:159], v[128:131], v[160:163]
    v_exp_f32 v67, v67
    v_cvt_pk_bf16_f32 v124, v64, v65
    v_mfma_f32_32x32x16_bf16 v[104:119], v[148:151], v[132:135], v[104:119]
    ds_read_b128 v[144:147], v164 offset:6144
    ds_read_b128 v[148:151], v164 offset:7168
    v_exp_f32 v68, v68
    v_exp_f32 v69, v69
    v_cvt_pk_bf16_f32 v125, v66, v67
    v_exp_f32 v70, v70
    v_exp_f32 v71, v71
    v_mfma_f32_16x16x32_bf16 v[160:163], v[156:159], v[132:135], v[160:163]
    v_cvt_pk_bf16_f32 v126, v68, v69
    v_cvt_pk_bf16_f32 v127, v70, v71
    s_waitcnt lgkmcnt(2)
    v_mfma_f32_32x32x16_bf16 v[56:71], v[136:139], v[8:11], v[24:39]
    buffer_store_dwordx4 v[248:251], v165, s[64:67], s68 offen offset:0 sc1
    s_add_u32 s68, s68, 110592
    v_exp_f32 v72, v72
    v_exp_f32 v73, v73
    v_exp_f32 v74, v74
    v_exp_f32 v75, v75
    v_cvt_pk_bf16_f32 v128, v72, v73
    v_mfma_f32_32x32x16_bf16 v[56:71], v[140:143], v[12:15], v[56:71]
    v_exp_f32 v76, v76
    v_exp_f32 v77, v77
    v_cvt_pk_bf16_f32 v129, v74, v75
    v_exp_f32 v78, v78
    v_exp_f32 v79, v79
    s_waitcnt lgkmcnt(0)
    v_mfma_f32_32x32x16_bf16 v[88:103], v[144:147], v[120:123], v[88:103]
    v_cvt_pk_bf16_f32 v130, v76, v77
    v_exp_f32 v80, v80
    v_exp_f32 v81, v81
    v_cvt_pk_bf16_f32 v131, v78, v79
    v_exp_f32 v82, v82
    v_mfma_f32_16x16x32_bf16 v[160:163], v[152:155], v[120:123], v[160:163]
    v_exp_f32 v83, v83
    v_cvt_pk_bf16_f32 v132, v80, v81
    v_mfma_f32_32x32x16_bf16 v[88:103], v[148:151], v[124:127], v[88:103]
    v_exp_f32 v84, v84
    v_exp_f32 v85, v85
    v_cvt_pk_bf16_f32 v133, v82, v83
    v_exp_f32 v86, v86
    v_exp_f32 v87, v87
    v_mfma_f32_16x16x32_bf16 v[160:163], v[152:155], v[124:127], v[160:163]
    v_cvt_pk_bf16_f32 v134, v84, v85
    v_cvt_pk_bf16_f32 v135, v86, v87
    s_setprio 1
    v_mfma_f32_32x32x16_bf16 v[72:87], v[136:139], v[16:19], v[40:55]
    buffer_store_dwordx4 v[188:191], v165, s[64:67], s68 offen offset:0 sc1
    v_exp_f32 v56, v56
    v_exp_f32 v57, v57
    v_exp_f32 v58, v58
    v_exp_f32 v59, v59
    v_cvt_pk_bf16_f32 v120, v56, v57
    v_mfma_f32_32x32x16_bf16 v[72:87], v[140:143], v[20:23], v[72:87]
    ds_read_b128 v[136:139], v164 offset:16384
    ds_read_b128 v[140:143], v164 offset:17408
    buffer_store_dwordx4 v[204:207], v165, s[64:67], s68 offen offset:1024 sc1
    v_exp_f32 v60, v60
    v_exp_f32 v61, v61
    v_cvt_pk_bf16_f32 v121, v58, v59
    v_exp_f32 v62, v62
    v_exp_f32 v63, v63
    v_mfma_f32_32x32x16_bf16 v[104:119], v[144:147], v[128:131], v[104:119]
    s_cmp_lg_u32 s26, 0
    s_cbranch_scc1 P3_r4
    s_lshl_b32 s23, s2, 2
    s_add_u32 s23, s23, s16
    s_lshl_b32 s82, s23, 11
    s_mov_b32 s72, s30
    s_and_b32 s73, s31, 0xffff
    s_mov_b32 s74, 2097152
P3_r4:
    v_cvt_pk_bf16_f32 v122, v60, v61
    v_exp_f32 v64, v64
    v_exp_f32 v65, v65
    v_cvt_pk_bf16_f32 v123, v62, v63
    v_exp_f32 v66, v66
    v_mfma_f32_16x16x32_bf16 v[160:163], v[156:159], v[128:131], v[160:163]
    s_cmp_lg_u32 s26, 0
    s_cbranch_scc1 P3_r10
    s_mov_b32 m0, s81
    s_nop 0
    buffer_load_dwordx4 v165, s[72:75], s82 offen lds
    buffer_load_dwordx4 v165, s[72:75], s82 offen offset:1024 lds
    s_add_u32 s82, s82, s84
P3_r10:
    v_exp_f32 v67, v67
    v_cvt_pk_bf16_f32 v124, v64, v65
    v_mfma_f32_32x32x16_bf16 v[104:119], v[148:151], v[132:135], v[104:119]
    ds_read_b128 v[144:147], v164 offset:18432
    ds_read_b128 v[148:151], v164 offset:19456
    v_exp_f32 v68, v68
    v_exp_f32 v69, v69
    v_cvt_pk_bf16_f32 v125, v66, v67
    v_exp_f32 v70, v70
    v_exp_f32 v71, v71
    v_mfma_f32_16x16x32_bf16 v[160:163], v[156:159], v[132:135], v[160:163]
    v_cvt_pk_bf16_f32 v126, v68, v69
    v_cvt_pk_bf16_f32 v127, v70, v71
    s_waitcnt lgkmcnt(2)
    v_mfma_f32_32x32x16_bf16 v[56:71], v[136:139], v[8:11], v[24:39]
    buffer_store_dwordx4 v[220:223], v165, s[64:67], s68 offen offset:2048 sc1
    v_exp_f32 v72, v72
    v_exp_f32 v73, v73
    v_exp_f32 v74, v74
    v_exp_f32 v75, v75
    v_cvt_pk_bf16_f32 v128, v72, v73
    v_mfma_f32_32x32x16_bf16 v[56:71], v[140:143], v[12:15], v[56:71]
    v_exp_f32 v76, v76
    v_exp_f32 v77, v77
    v_cvt_pk_bf16_f32 v129, v74, v75
    v_exp_f32 v78, v78
    v_exp_f32 v79, v79
    s_waitcnt lgkmcnt(0)
    v_mfma_f32_32x32x16_bf16 v[88:103], v[144:147], v[120:123], v[88:103]
    v_cvt_pk_bf16_f32 v130, v76, v77
    v_exp_f32 v80, v80
    v_exp_f32 v81, v81
    v_cvt_pk_bf16_f32 v131, v78, v79
    v_exp_f32 v82, v82
    v_mfma_f32_16x16x32_bf16 v[160:163], v[152:155], v[120:123], v[160:163]
    v_exp_f32 v83, v83
    v_cvt_pk_bf16_f32 v132, v80, v81
    v_mfma_f32_32x32x16_bf16 v[88:103], v[148:151], v[124:127], v[88:103]
    v_exp_f32 v84, v84
    v_exp_f32 v85, v85
    v_cvt_pk_bf16_f32 v133, v82, v83
    v_exp_f32 v86, v86
    v_exp_f32 v87, v87
    v_mfma_f32_16x16x32_bf16 v[160:163], v[152:155], v[124:127], v[160:163]
    v_cvt_pk_bf16_f32 v134, v84, v85
    v_cvt_pk_bf16_f32 v135, v86, v87
    s_setprio 0
    v_mfma_f32_32x32x16_bf16 v[72:87], v[136:139], v[16:19], v[40:55]
    buffer_store_dwordx4 v[236:239], v165, s[64:67], s68 offen offset:3072 sc1
    s_add_u32 s68, s68, 4096
    v_exp_f32 v56, v56
    v_exp_f32 v57, v57
    v_exp_f32 v58, v58
    v_exp_f32 v59, v59
    v_cvt_pk_bf16_f32 v120, v56, v57
    v_mfma_f32_32x32x16_bf16 v[72:87], v[140:143], v[20:23], v[72:87]
    ds_read_b128 v[136:139], v164 offset:20480
    ds_read_b128 v[140:143], v164 offset:21504
    v_exp_f32 v60, v60
    v_exp_f32 v61, v61
    v_cvt_pk_bf16_f32 v121, v58, v59
    v_exp_f32 v62, v62
    v_exp_f32 v63, v63
    v_mfma_f32_32x32x16_bf16 v[104:119], v[144:147], v[128:131], v[104:119]
    v_cvt_pk_bf16_f32 v122, v60, v61
    v_exp_f32 v64, v64
    v_exp_f32 v65, v65
    v_cvt_pk_bf16_f32 v123, v62, v63
    v_exp_f32 v66, v66
    v_mfma_f32_16x16x32_bf16 v[160:163], v[156:159], v[128:131], v[160:163]
    v_exp_f32 v67, v67
    v_cvt_pk_bf16_f32 v124, v64, v65
    v_mfma_f32_32x32x16_bf16 v[104:119], v[148:151], v[132:135], v[104:119]
    ds_read_b128 v[144:147], v164 offset:22528
    ds_read_b128 v[148:151], v164 offset:23552
    v_exp_f32 v68, v68
    v_exp_f32 v69, v69
    v_cvt_pk_bf16_f32 v125, v66, v67
    v_exp_f32 v70, v70
    v_exp_f32 v71, v71
    v_mfma_f32_16x16x32_bf16 v[160:163], v[156:159], v[132:135], v[160:163]
    v_cvt_pk_bf16_f32 v126, v68, v69
    v_cvt_pk_bf16_f32 v127, v70, v71
    s_waitcnt lgkmcnt(2)
    v_mfma_f32_32x32x16_bf16 v[56:71], v[136:139], v[8:11], v[24:39]
    buffer_store_dwordx4 v[252:255], v165, s[64:67], s68 offen offset:0 sc1
    s_add_u32 s68, s68, 110592
    v_exp_f32 v72, v72
    v_exp_f32 v73, v73
    v_exp_f32 v74, v74
    v_exp_f32 v75, v75
    v_cvt_pk_bf16_f32 v128, v72, v73
    v_mfma_f32_32x32x16_bf16 v[56:71], v[140:143], v[12:15], v[56:71]
    v_add_u32 v164, 4294934528, v164
    v_exp_f32 v76, v76
    v_exp_f32 v77, v77
    v_cvt_pk_bf16_f32 v129, v74, v75
    v_exp_f32 v78, v78
    v_exp_f32 v79, v79
    s_waitcnt lgkmcnt(0)
    v_mfma_f32_32x32x16_bf16 v[88:103], v[144:147], v[120:123], v[88:103]
    v_cvt_pk_bf16_f32 v130, v76, v77
    v_exp_f32 v80, v80
    v_exp_f32 v81, v81
    v_cvt_pk_bf16_f32 v131, v78, v79
    v_exp_f32 v82, v82
    v_mfma_f32_16x16x32_bf16 v[160:163], v[152:155], v[120:123], v[160:163]
    v_exp_f32 v83, v83
    v_cvt_pk_bf16_f32 v132, v80, v81
    v_mfma_f32_32x32x16_bf16 v[88:103], v[148:151], v[124:127], v[88:103]
    v_exp_f32 v84, v84
    v_exp_f32 v85, v85
    v_cvt_pk_bf16_f32 v133, v82, v83
    v_exp_f32 v86, v86
    v_exp_f32 v87, v87
    v_mfma_f32_16x16x32_bf16 v[160:163], v[152:155], v[124:127], v[160:163]
    v_cvt_pk_bf16_f32 v134, v84, v85
    v_cvt_pk_bf16_f32 v135, v86, v87
    s_cmp_lg_u32 s26, 1
    s_cbranch_scc1 P3_r19
    s_waitcnt vmcnt(0)
P3_r19:
    s_barrier
    s_setprio 3
    v_mfma_f32_32x32x16_bf16 v[72:87], v[136:139], v[16:19], v[40:55]
    s_cmp_lg_u32 s26, 1
    s_cbranch_scc1 P3_r11
    s_add_u32 m0, s81, 98304
    s_nop 0
    buffer_load_dwordx4 v165, s[12:15], s82 offen sc1 lds
    buffer_load_dwordx4 v165, s[12:15], s82 offen offset:1024 sc1 lds
    buffer_load_dwordx4 v173, s[12:15], s82 offen offset:2048 sc1 lds
    buffer_load_dwordx4 v173, s[12:15], s82 offen offset:3072 sc1 lds
    s_add_u32 s82, s82, 4096
P3_r11:
    v_exp_f32 v56, v56
    v_exp_f32 v57, v57
    v_exp_f32 v58, v58
    v_exp_f32 v59, v59
    v_cvt_pk_bf16_f32 v120, v56, v57
    v_mfma_f32_32x32x16_bf16 v[72:87], v[140:143], v[20:23], v[72:87]
    ds_read_b128 v[136:139], v164 offset:0
    ds_read_b128 v[140:143], v164 offset:1024
    v_exp_f32 v60, v60
    v_exp_f32 v61, v61
    v_cvt_pk_bf16_f32 v121, v58, v59
    v_exp_f32 v62, v62
    v_exp_f32 v63, v63
    v_mfma_f32_32x32x16_bf16 v[104:119], v[144:147], v[128:131], v[104:119]
    v_cvt_pk_bf16_f32 v122, v60, v61
    v_exp_f32 v64, v64
    v_exp_f32 v65, v65
    v_cvt_pk_bf16_f32 v123, v62, v63
    v_exp_f32 v66, v66
    v_mfma_f32_16x16x32_bf16 v[160:163], v[156:159], v[128:131], v[160:163]
    v_exp_f32 v67, v67
    v_cvt_pk_bf16_f32 v124, v64, v65
    v_mfma_f32_32x32x16_bf16 v[104:119], v[148:151], v[132:135], v[104:119]
    ds_read_b128 v[144:147], v164 offset:2048
    ds_read_b128 v[148:151], v164 offset:3072
    v_exp_f32 v68, v68
    v_exp_f32 v69, v69
    v_cvt_pk_bf16_f32 v125, v66, v67
    v_exp_f32 v70, v70
    v_exp_f32 v71, v71
    v_mfma_f32_16x16x32_bf16 v[160:163], v[156:159], v[132:135], v[160:163]
    v_cvt_pk_bf16_f32 v126, v68, v69
    v_cvt_pk_bf16_f32 v127, v70, v71
    s_waitcnt lgkmcnt(2)
    v_mfma_f32_32x32x16_bf16 v[56:71], v[136:139], v[8:11], v[24:39]
    s_cmp_lg_u32 s26, 0
    s_cbranch_scc1 P3_r5
    s_lshl_b32 s23, s2, 2
    s_add_u32 s23, s23, s16
    s_and_b32 s24, s23, 1
    s_mul_i32 s24, s24, 1792
    s_lshr_b32 s23, s23, 1
    s_add_u32 s24, s24, s23
    s_lshl_b32 s24, s24, 11
    s_cmp_lt_u32 s23, 448
    s_cselect_b32 s82, s24, 0x10000000
    s_mov_b32 s72, s6
    s_and_b32 s73, s7, 0xffff
    s_mov_b32 s74, 7340032
    s_mov_b32 s84, 917504
P3_r5:
    v_exp_f32 v72, v72
    v_exp_f32 v73, v73
    v_exp_f32 v74, v74
    v_exp_f32 v75, v75
    v_cvt_pk_bf16_f32 v128, v72, v73
    v_mfma_f32_32x32x16_bf16 v[56:71], v[140:143], v[12:15], v[56:71]
    s_cmp_lg_u32 s26, 1
    s_cbranch_scc1 P3_r12
    s_add_u32 m0, s81, 114688
    s_nop 0
    buffer_load_dwordx4 v165, s[12:15], s82 offen sc1 lds
    buffer_load_dwordx4 v165, s[12:15], s82 offen offset:1024 sc1 lds
    buffer_load_dwordx4 v173, s[12:15], s82 offen offset:2048 sc1 lds
    buffer_load_dwordx4 v173, s[12:15], s82 offen offset:3072 sc1 lds
    s_add_u32 s82, s82, 4096
P3_r12:
    v_exp_f32 v76, v76
    v_exp_f32 v77, v77
    v_cvt_pk_bf16_f32 v129, v74, v75
    v_exp_f32 v78, v78
    v_exp_f32 v79, v79
    s_waitcnt lgkmcnt(0)
    v_mfma_f32_32x32x16_bf16 v[88:103], v[144:147], v[120:123], v[88:103]
    v_cvt_pk_bf16_f32 v130, v76, v77
    v_exp_f32 v80, v80
    v_exp_f32 v81, v81
    v_cvt_pk_bf16_f32 v131, v78, v79
    v_exp_f32 v82, v82
    v_mfma_f32_16x16x32_bf16 v[160:163], v[152:155], v[120:123], v[160:163]
    v_exp_f32 v83, v83
    v_cvt_pk_bf16_f32 v132, v80, v81
    v_mfma_f32_32x32x16_bf16 v[88:103], v[148:151], v[124:127], v[88:103]
    v_exp_f32 v84, v84
    v_exp_f32 v85, v85
    v_cvt_pk_bf16_f32 v133, v82, v83
    v_exp_f32 v86, v86
    v_exp_f32 v87, v87
    v_mfma_f32_16x16x32_bf16 v[160:163], v[152:155], v[124:127], v[160:163]
    v_cvt_pk_bf16_f32 v134, v84, v85
    v_cvt_pk_bf16_f32 v135, v86, v87
    s_setprio 2
    v_mfma_f32_32x32x16_bf16 v[72:87], v[136:139], v[16:19], v[40:55]
    s_cmp_lg_u32 s26, 1
    s_cbranch_scc1 P3_r13
    s_add_u32 m0, s81, 0
    s_nop 0
    buffer_load_dwordx4 v165, s[12:15], s82 offen sc1 lds
    buffer_load_dwordx4 v165, s[12:15], s82 offen offset:1024 sc1 lds
    buffer_load_dwordx4 v173, s[12:15], s82 offen offset:2048 sc1 lds
    buffer_load_dwordx4 v173, s[12:15], s82 offen offset:3072 sc1 lds
    s_add_u32 s82, s82, 4096
P3_r13:
    v_exp_f32 v56, v56
    v_exp_f32 v57, v57
    v_exp_f32 v58, v58
    v_exp_f32 v59, v59
    v_cvt_pk_bf16_f32 v120, v56, v57
    v_mfma_f32_32x32x16_bf16 v[72:87], v[140:143], v[20:23], v[72:87]
    ds_read_b128 v[136:139], v164 offset:4096
    ds_read_b128 v[140:143], v164 offset:5120
    v_exp_f32 v60, v60
    v_exp_f32 v61, v61
    v_cvt_pk_bf16_f32 v121, v58, v59
    v_exp_f32 v62, v62
    v_exp_f32 v63, v63
    v_mfma_f32_32x32x16_bf16 v[104:119], v[144:147], v[128:131], v[104:119]
    v_cvt_pk_bf16_f32 v122, v60, v61
    v_exp_f32 v64, v64
    v_exp_f32 v65, v65
    v_cvt_pk_bf16_f32 v123, v62, v63
    v_exp_f32 v66, v66
    v_mfma_f32_16x16x32_bf16 v[160:163], v[156:159], v[128:131], v[160:163]
    v_exp_f32 v67, v67
    v_cvt_pk_bf16_f32 v124, v64, v65
    v_mfma_f32_32x32x16_bf16 v[104:119], v[148:151], v[132:135], v[104:119]
    ds_read_b128 v[144:147], v164 offset:6144
    ds_read_b128 v[148:151], v164 offset:7168
    v_exp_f32 v68, v68
    v_exp_f32 v69, v69
    v_cvt_pk_bf16_f32 v125, v66, v67
    v_exp_f32 v70, v70
    v_exp_f32 v71, v71
    v_mfma_f32_16x16x32_bf16 v[160:163], v[156:159], v[132:135], v[160:163]
    v_cvt_pk_bf16_f32 v126, v68, v69
    v_cvt_pk_bf16_f32 v127, v70, v71
    s_waitcnt lgkmcnt(2)
    v_mfma_f32_32x32x16_bf16 v[56:71], v[136:139], v[8:11], v[24:39]
    s_cmp_lg_u32 s26, 0
    s_cbranch_scc1 P3_r7
    s_waitcnt vmcnt(0)
    s_cmp_eq_u32 s59, 0
    s_cbranch_scc1 P3_hs6
    s_mov_b64 exec, 1
    v_mov_b32 v2, 1
    buffer_atomic_add v2, v175, s[60:63], s59 offen
    s_mov_b64 exec, -1
P3_hs6:
P3_r7:
    v_exp_f32 v72, v72
    v_exp_f32 v73, v73
    v_exp_f32 v74, v74
    v_exp_f32 v75, v75
    v_cvt_pk_bf16_f32 v128, v72, v73
    v_mfma_f32_32x32x16_bf16 v[56:71], v[140:143], v[12:15], v[56:71]
    v_exp_f32 v76, v76
    v_exp_f32 v77, v77
    v_cvt_pk_bf16_f32 v129, v74, v75
    v_exp_f32 v78, v78
    v_exp_f32 v79, v79
    s_waitcnt lgkmcnt(0)
    v_mfma_f32_32x32x16_bf16 v[88:103], v[144:147], v[120:123], v[88:103]
    v_cvt_pk_bf16_f32 v130, v76, v77
    v_exp_f32 v80, v80
    v_exp_f32 v81, v81
    v_cvt_pk_bf16_f32 v131, v78, v79
    v_exp_f32 v82, v82
    v_mfma_f32_16x16x32_bf16 v[160:163], v[152:155], v[120:123], v[160:163]
    v_exp_f32 v83, v83
    v_cvt_pk_bf16_f32 v132, v80, v81
    v_mfma_f32_32x32x16_bf16 v[88:103], v[148:151], v[124:127], v[88:103]
    v_exp_f32 v84, v84
    v_exp_f32 v85, v85
    v_cvt_pk_bf16_f32 v133, v82, v83
    v_exp_f32 v86, v86
    v_exp_f32 v87, v87
    v_mfma_f32_16x16x32_bf16 v[160:163], v[152:155], v[124:127], v[160:163]
    v_cvt_pk_bf16_f32 v134, v84, v85
    v_cvt_pk_bf16_f32 v135, v86, v87
    s_setprio 1
    v_mfma_f32_32x32x16_bf16 v[72:87], v[136:139], v[16:19], v[40:55]
    s_cmp_lg_u32 s26, 0
    s_cbranch_scc1 P3_r14
    s_mov_b32 m0, s81
    s_nop 0
    buffer_load_dwordx4 v165, s[72:75], s82 offen lds
    buffer_load_dwordx4 v165, s[72:75], s82 offen offset:1024 lds
    s_add_u32 s82, s82, s84
P3_r14:
    v_exp_f32 v56, v56
    v_exp_f32 v57, v57
    v_exp_f32 v58, v58
    v_exp_f32 v59, v59
    v_cvt_pk_bf16_f32 v120, v56, v57
    v_mfma_f32_32x32x16_bf16 v[72:87], v[140:143], v[20:23], v[72:87]
    ds_read_b128 v[136:139], v164 offset:16384
    ds_read_b128 v[140:143], v164 offset:17408
    v_exp_f32 v60, v60
    v_exp_f32 v61, v61
    v_cvt_pk_bf16_f32 v121, v58, v59
    v_exp_f32 v62, v62
    v_exp_f32 v63, v63
    v_mfma_f32_32x32x16_bf16 v[104:119], v[144:147], v[128:131], v[104:119]
    v_cvt_pk_bf16_f32 v122, v60, v61
    v_exp_f32 v64, v64
    v_exp_f32 v65, v65
    v_cvt_pk_bf16_f32 v123, v62, v63
    v_exp_f32 v66, v66
    v_mfma_f32_16x16x32_bf16 v[160:163], v[156:159], v[128:131], v[160:163]
    v_exp_f32 v67, v67
    v_cvt_pk_bf16_f32 v124, v64, v65
    v_mfma_f32_32x32x16_bf16 v[104:119], v[148:151], v[132:135], v[104:119]
    ds_read_b128 v[144:147], v164 offset:18432
    ds_read_b128 v[148:151], v164 offset:19456
    v_exp_f32 v68, v68
    v_exp_f32 v69, v69
    v_cvt_pk_bf16_f32 v125, v66, v67
    v_exp_f32 v70, v70
    v_exp_f32 v71, v71
    v_mfma_f32_16x16x32_bf16 v[160:163], v[156:159], v[132:135], v[160:163]
    v_cvt_pk_bf16_f32 v126, v68, v69
    v_cvt_pk_bf16_f32 v127, v70, v71
    s_waitcnt lgkmcnt(2)
    v_mfma_f32_32x32x16_bf16 v[56:71], v[136:139], v[8:11], v[24:39]
    v_and_b32 v2, 63, v0
    v_lshrrev_b32 v5, 5, v2
    v_mul_u32_u24 v3, 4096, v5
    v_bfe_u32 v4, v2, 2, 3
    v_lshl_add_u32 v3, v4, 7, v3
    v_and_b32 v5, 3, v2
    v_lshl_add_u32 v3, v5, 3, v3
    v_lshrrev_b32 v6, 1, v4
    s_and_b32 s23, s16, 3
    v_xor_b32 v5, s23, v6
    v_lshl_add_u32 v3, v5, 5, v3
    s_lshr_b32 s23, s16, 2
    s_mul_i32 s23, s23, 16384
    v_lshlrev_b32 v5, 4, v2
    v_add_u32 v5, s23, v5
    v_add_u32 v234, 34816, v3
    v_add_u32 v232, 32768, v5
    v_add_u32 v235, 100352, v3
    v_add_u32 v233, 98304, v5
    s_mul_i32 s46, s16, 4096
    s_mov_b32 s45, 0
    s_mov_b32 s44, 0
    v_exp_f32 v72, v72
    v_exp_f32 v73, v73
    v_exp_f32 v74, v74
    v_exp_f32 v75, v75
    v_cvt_pk_bf16_f32 v128, v72, v73
    v_mfma_f32_32x32x16_bf16 v[56:71], v[140:143], v[12:15], v[56:71]
    v_mov_b32 v176, 0
    v_mov_b32 v177, 0
    v_mov_b32 v178, 0
    v_mov_b32 v179, 0
    v_mov_b32 v180, 0
    v_mov_b32 v181, 0
    v_mov_b32 v182, 0
    v_mov_b32 v183, 0
    v_exp_f32 v76, v76
    v_exp_f32 v77, v77
    v_cvt_pk_bf16_f32 v129, v74, v75
    v_exp_f32 v78, v78
    v_exp_f32 v79, v79
    s_waitcnt lgkmcnt(0)
    v_mfma_f32_32x32x16_bf16 v[88:103], v[144:147], v[120:123], v[88:103]
    v_cvt_pk_bf16_f32 v130, v76, v77
    v_exp_f32 v80, v80
    v_exp_f32 v81, v81
    v_cvt_pk_bf16_f32 v131, v78, v79
    v_exp_f32 v82, v82
    v_mfma_f32_16x16x32_bf16 v[160:163], v[152:155], v[120:123], v[160:163]
    v_exp_f32 v83, v83
    v_cvt_pk_bf16_f32 v132, v80, v81
    v_mfma_f32_32x32x16_bf16 v[88:103], v[148:151], v[124:127], v[88:103]
    v_exp_f32 v84, v84
    v_exp_f32 v85, v85
    v_cvt_pk_bf16_f32 v133, v82, v83
    v_exp_f32 v86, v86
    v_exp_f32 v87, v87
    v_mfma_f32_16x16x32_bf16 v[160:163], v[152:155], v[124:127], v[160:163]
    v_cvt_pk_bf16_f32 v134, v84, v85
    v_cvt_pk_bf16_f32 v135, v86, v87
    s_setprio 0
    v_mfma_f32_32x32x16_bf16 v[72:87], v[136:139], v[16:19], v[40:55]
    v_mov_b32 v184, 0
    v_mov_b32 v185, 0
    v_mov_b32 v186, 0
    v_mov_b32 v187, 0
    v_mov_b32 v188, 0
    v_mov_b32 v189, 0
    v_mov_b32 v190, 0
    v_mov_b32 v191, 0
    v_exp_f32 v56, v56
    v_exp_f32 v57, v57
    v_exp_f32 v58, v58
    v_exp_f32 v59, v59
    v_cvt_pk_bf16_f32 v120, v56, v57
    v_mfma_f32_32x32x16_bf16 v[72:87], v[140:143], v[20:23], v[72:87]
    ds_read_b128 v[136:139], v164 offset:20480
    ds_read_b128 v[140:143], v164 offset:21504
    v_mov_b32 v192, 0
    v_mov_b32 v193, 0
    v_mov_b32 v194, 0
    v_mov_b32 v195, 0
    v_mov_b32 v196, 0
    v_mov_b32 v197, 0
    v_mov_b32 v198, 0
    v_mov_b32 v199, 0
    v_exp_f32 v60, v60
    v_exp_f32 v61, v61
    v_cvt_pk_bf16_f32 v121, v58, v59
    v_exp_f32 v62, v62
    v_exp_f32 v63, v63
    v_mfma_f32_32x32x16_bf16 v[104:119], v[144:147], v[128:131], v[104:119]
    v_mov_b32 v200, 0
    v_mov_b32 v201, 0
    v_mov_b32 v202, 0
    v_mov_b32 v203, 0
    v_mov_b32 v204, 0
    v_mov_b32 v205, 0
    v_mov_b32 v206, 0
    v_mov_b32 v207, 0
    v_cvt_pk_bf16_f32 v122, v60, v61
    v_exp_f32 v64, v64
    v_exp_f32 v65, v65
    v_cvt_pk_bf16_f32 v123, v62, v63
    v_exp_f32 v66, v66
    v_mfma_f32_16x16x32_bf16 v[160:163], v[156:159], v[128:131], v[160:163]
    v_exp_f32 v67, v67
    v_cvt_pk_bf16_f32 v124, v64, v65
    v_mfma_f32_32x32x16_bf16 v[104:119], v[148:151], v[132:135], v[104:119]
    ds_read_b128 v[144:147], v164 offset:22528
    ds_read_b128 v[148:151], v164 offset:23552
    v_exp_f32 v68, v68
    v_exp_f32 v69, v69
    v_cvt_pk_bf16_f32 v125, v66, v67
    v_exp_f32 v70, v70
    v_exp_f32 v71, v71
    v_mfma_f32_16x16x32_bf16 v[160:163], v[156:159], v[132:135], v[160:163]
    v_cvt_pk_bf16_f32 v126, v68, v69
    v_cvt_pk_bf16_f32 v127, v70, v71
    s_waitcnt lgkmcnt(2)
    v_mfma_f32_32x32x16_bf16 v[56:71], v[136:139], v[8:11], v[24:39]
    s_cmp_lg_u32 s26, 0
    s_cbranch_scc1 P3_r15
    s_mov_b32 m0, s81
    s_nop 0
    buffer_load_dwordx4 v165, s[72:75], s82 offen lds
    buffer_load_dwordx4 v165, s[72:75], s82 offen offset:1024 lds
    s_add_u32 s82, s82, s84
P3_r15:
    v_exp_f32 v72, v72
    v_exp_f32 v73, v73
    v_exp_f32 v74, v74
    v_exp_f32 v75, v75
    v_cvt_pk_bf16_f32 v128, v72, v73
    v_mfma_f32_32x32x16_bf16 v[56:71], v[140:143], v[12:15], v[56:71]
    v_add_u32 v164, 32768, v164
    v_exp_f32 v76, v76
    v_exp_f32 v77, v77
    v_cvt_pk_bf16_f32 v129, v74, v75
    v_exp_f32 v78, v78
    v_exp_f32 v79, v79
    s_waitcnt lgkmcnt(0)
    v_mfma_f32_32x32x16_bf16 v[88:103], v[144:147], v[120:123], v[88:103]
    v_cvt_pk_bf16_f32 v130, v76, v77
    v_exp_f32 v80, v80
    v_exp_f32 v81, v81
    v_cvt_pk_bf16_f32 v131, v78, v79
    v_exp_f32 v82, v82
    v_mfma_f32_16x16x32_bf16 v[160:163], v[152:155], v[120:123], v[160:163]
    v_exp_f32 v83, v83
    v_cvt_pk_bf16_f32 v132, v80, v81
    v_mfma_f32_32x32x16_bf16 v[88:103], v[148:151], v[124:127], v[88:103]
    v_exp_f32 v84, v84
    v_exp_f32 v85, v85
    v_cvt_pk_bf16_f32 v133, v82, v83
    v_exp_f32 v86, v86
    v_exp_f32 v87, v87
    v_mfma_f32_16x16x32_bf16 v[160:163], v[152:155], v[124:127], v[160:163]
    v_cvt_pk_bf16_f32 v134, v84, v85
    v_cvt_pk_bf16_f32 v135, v86, v87
    s_cmp_lg_u32 s26, 1
    s_cbranch_scc1 P3_r20
    s_waitcnt vmcnt(0)
P3_r20:
    s_barrier
    s_setprio 3
    v_mfma_f32_32x32x16_bf16 v[72:87], v[136:139], v[16:19], v[40:55]
    v_exp_f32 v56, v56
    v_exp_f32 v57, v57
    v_exp_f32 v58, v58
    v_exp_f32 v59, v59
    v_cvt_pk_bf16_f32 v120, v56, v57
    v_mfma_f32_32x32x16_bf16 v[72:87], v[140:143], v[20:23], v[72:87]
    ds_read_b128 v[136:139], v164 offset:0
    ds_read_b128 v[140:143], v164 offset:1024
    v_exp_f32 v60, v60
    v_exp_f32 v61, v61
    v_cvt_pk_bf16_f32 v121, v58, v59
    v_exp_f32 v62, v62
    v_exp_f32 v63, v63
    v_mfma_f32_32x32x16_bf16 v[104:119], v[144:147], v[128:131], v[104:119]
    v_cvt_pk_bf16_f32 v122, v60, v61
    v_exp_f32 v64, v64
    v_exp_f32 v65, v65
    v_cvt_pk_bf16_f32 v123, v62, v63
    v_exp_f32 v66, v66
    v_mfma_f32_16x16x32_bf16 v[160:163], v[156:159], v[128:131], v[160:163]
    v_exp_f32 v67, v67
    v_cvt_pk_bf16_f32 v124, v64, v65
    v_mfma_f32_32x32x16_bf16 v[104:119], v[148:151], v[132:135], v[104:119]
    ds_read_b128 v[144:147], v164 offset:2048
    ds_read_b128 v[148:151], v164 offset:3072
    v_exp_f32 v68, v68
    v_exp_f32 v69, v69
    v_cvt_pk_bf16_f32 v125, v66, v67
    v_exp_f32 v70, v70
    v_exp_f32 v71, v71
    v_mfma_f32_16x16x32_bf16 v[160:163], v[156:159], v[132:135], v[160:163]
    v_cvt_pk_bf16_f32 v126, v68, v69
    v_cvt_pk_bf16_f32 v127, v70, v71
    s_waitcnt lgkmcnt(2)
    v_mfma_f32_32x32x16_bf16 v[56:71], v[136:139], v[8:11], v[24:39]
    s_cmp_lg_u32 s16, 4
    s_cbranch_scc1 P3_hp
    s_add_u32 s3, s76, 32
    s_lshl_b32 s3, s3, 7
    buffer_load_dword v174, v175, s[60:63], s3 offen sc1
P3_hp:
    v_exp_f32 v72, v72
    v_exp_f32 v73, v73
    v_exp_f32 v74, v74
    v_exp_f32 v75, v75
    v_cvt_pk_bf16_f32 v128, v72, v73
    v_mfma_f32_32x32x16_bf16 v[56:71], v[140:143], v[12:15], v[56:71]
    v_exp_f32 v76, v76
    v_exp_f32 v77, v77
    v_cvt_pk_bf16_f32 v129, v74, v75
    v_exp_f32 v78, v78
    v_exp_f32 v79, v79
    s_waitcnt lgkmcnt(0)
    v_mfma_f32_32x32x16_bf16 v[88:103], v[144:147], v[120:123], v[88:103]
    v_cvt_pk_bf16_f32 v130, v76, v77
    v_exp_f32 v80, v80
    v_exp_f32 v81, v81
    v_cvt_pk_bf16_f32 v131, v78, v79
    v_exp_f32 v82, v82
    v_mfma_f32_16x16x32_bf16 v[160:163], v[152:155], v[120:123], v[160:163]
    v_exp_f32 v83, v83
    v_cvt_pk_bf16_f32 v132, v80, v81
    v_mfma_f32_32x32x16_bf16 v[88:103], v[148:151], v[124:127], v[88:103]
    v_exp_f32 v84, v84
    v_exp_f32 v85, v85
    v_cvt_pk_bf16_f32 v133, v82, v83
    v_exp_f32 v86, v86
    v_exp_f32 v87, v87
    v_mfma_f32_16x16x32_bf16 v[160:163], v[152:155], v[124:127], v[160:163]
    v_cvt_pk_bf16_f32 v134, v84, v85
    v_cvt_pk_bf16_f32 v135, v86, v87
    s_setprio 2
    v_mfma_f32_32x32x16_bf16 v[72:87], v[136:139], v[16:19], v[40:55]
    s_cmp_lg_u32 s26, 0
    s_cbranch_scc1 P3_r16
    s_mov_b32 m0, s81
    s_nop 0
    buffer_load_dwordx4 v165, s[72:75], s82 offen lds
    buffer_load_dwordx4 v165, s[72:75], s82 offen offset:1024 lds
    s_add_u32 s82, s82, s84
P3_r16:
    v_exp_f32 v56, v56
    v_exp_f32 v57, v57
    v_exp_f32 v58, v58
    v_exp_f32 v59, v59
    v_cvt_pk_bf16_f32 v120, v56, v57
    v_mfma_f32_32x32x16_bf16 v[72:87], v[140:143], v[20:23], v[72:87]
    ds_read_b128 v[136:139], v164 offset:4096
    ds_read_b128 v[140:143], v164 offset:5120
    v_exp_f32 v60, v60
    v_exp_f32 v61, v61
    v_cvt_pk_bf16_f32 v121, v58, v59
    v_exp_f32 v62, v62
    v_exp_f32 v63, v63
    v_mfma_f32_32x32x16_bf16 v[104:119], v[144:147], v[128:131], v[104:119]
    v_cvt_pk_bf16_f32 v122, v60, v61
    v_exp_f32 v64, v64
    v_exp_f32 v65, v65
    v_cvt_pk_bf16_f32 v123, v62, v63
    v_exp_f32 v66, v66
    v_mfma_f32_16x16x32_bf16 v[160:163], v[156:159], v[128:131], v[160:163]
    v_exp_f32 v67, v67
    v_cvt_pk_bf16_f32 v124, v64, v65
    v_mfma_f32_32x32x16_bf16 v[104:119], v[148:151], v[132:135], v[104:119]
    ds_read_b128 v[144:147], v164 offset:6144
    ds_read_b128 v[148:151], v164 offset:7168
    v_exp_f32 v68, v68
    v_exp_f32 v69, v69
    v_cvt_pk_bf16_f32 v125, v66, v67
    v_exp_f32 v70, v70
    v_exp_f32 v71, v71
    v_mfma_f32_16x16x32_bf16 v[160:163], v[156:159], v[132:135], v[160:163]
    v_cvt_pk_bf16_f32 v126, v68, v69
    v_cvt_pk_bf16_f32 v127, v70, v71
    s_waitcnt lgkmcnt(2)
    v_mfma_f32_32x32x16_bf16 v[56:71], v[136:139], v[8:11], v[24:39]
    v_exp_f32 v72, v72
    v_exp_f32 v73, v73
    v_exp_f32 v74, v74
    v_exp_f32 v75, v75
    v_cvt_pk_bf16_f32 v128, v72, v73
    v_mfma_f32_32x32x16_bf16 v[56:71], v[140:143], v[12:15], v[56:71]
    v_exp_f32 v76, v76
    v_exp_f32 v77, v77
    v_cvt_pk_bf16_f32 v129, v74, v75
    v_exp_f32 v78, v78
    v_exp_f32 v79, v79
    s_waitcnt lgkmcnt(0)
    v_mfma_f32_32x32x16_bf16 v[88:103], v[144:147], v[120:123], v[88:103]
    v_cvt_pk_bf16_f32 v130, v76, v77
    v_exp_f32 v80, v80
    v_exp_f32 v81, v81
    v_cvt_pk_bf16_f32 v131, v78, v79
    v_exp_f32 v82, v82
    v_mfma_f32_16x16x32_bf16 v[160:163], v[152:155], v[120:123], v[160:163]
    v_exp_f32 v83, v83
    v_cvt_pk_bf16_f32 v132, v80, v81
    v_mfma_f32_32x32x16_bf16 v[88:103], v[148:151], v[124:127], v[88:103]
    v_exp_f32 v84, v84
    v_exp_f32 v85, v85
    v_cvt_pk_bf16_f32 v133, v82, v83
    v_exp_f32 v86, v86
    v_exp_f32 v87, v87
    v_mfma_f32_16x16x32_bf16 v[160:163], v[152:155], v[124:127], v[160:163]
    v_cvt_pk_bf16_f32 v134, v84, v85
    v_cvt_pk_bf16_f32 v135, v86, v87
    s_cmp_lg_u32 s16, 4
    s_cbranch_scc1 P3_hok
    s_waitcnt vmcnt(0)
P3_hchk:
    v_readfirstlane_b32 s23, v174
    s_nop 0
    s_cmp_ge_u32 s23, 48
    s_cbranch_scc1 P3_hok
    s_sleep 4
    buffer_load_dword v174, v175, s[60:63], s3 offen sc1
    s_waitcnt vmcnt(0)
    s_branch P3_hchk
P3_hok:
    s_barrier
    s_setprio 1
    v_mfma_f32_32x32x16_bf16 v[72:87], v[136:139], v[16:19], v[40:55]
    s_add_u32 m0, s46, 32768
    s_nop 0
    buffer_load_dwordx4 v165, s[32:35], s45 offen sc1 lds
    v_exp_f32 v56, v56
    v_exp_f32 v57, v57
    v_exp_f32 v58, v58
    v_exp_f32 v59, v59
    v_cvt_pk_bf16_f32 v120, v56, v57
    v_mfma_f32_32x32x16_bf16 v[72:87], v[140:143], v[20:23], v[72:87]
    ds_read_b128 v[136:139], v164 offset:16384
    ds_read_b128 v[140:143], v164 offset:17408
    buffer_load_dwordx4 v165, s[32:35], s45 offen offset:1024 sc1 lds
    s_add_u32 s45, s45, 2048
    v_exp_f32 v60, v60
    v_exp_f32 v61, v61
    v_cvt_pk_bf16_f32 v121, v58, v59
    v_exp_f32 v62, v62
    v_exp_f32 v63, v63
    v_mfma_f32_32x32x16_bf16 v[104:119], v[144:147], v[128:131], v[104:119]
    s_add_u32 m0, s46, 34816
    s_nop 0
    buffer_load_dwordx4 v7, s[36:39], s44 offen lds
    v_cvt_pk_bf16_f32 v122, v60, v61
    v_exp_f32 v64, v64
    v_exp_f32 v65, v65
    v_cvt_pk_bf16_f32 v123, v62, v63
    v_exp_f32 v66, v66
    v_mfma_f32_16x16x32_bf16 v[160:163], v[156:159], v[128:131], v[160:163]
    s_add_u32 m0, s46, 35840
    s_nop 0
    buffer_load_dwordx4 v7, s[40:43], s44 offen lds
    s_add_u32 s44, s44, 131072
    v_exp_f32 v67, v67
    v_cvt_pk_bf16_f32 v124, v64, v65
    v_mfma_f32_32x32x16_bf16 v[104:119], v[148:151], v[132:135], v[104:119]
    ds_read_b128 v[144:147], v164 offset:18432
    ds_read_b128 v[148:151], v164 offset:19456
    v_exp_f32 v68, v68
    v_exp_f32 v69, v69
    v_cvt_pk_bf16_f32 v125, v66, v67
    v_exp_f32 v70, v70
    v_exp_f32 v71, v71
    v_mfma_f32_16x16x32_bf16 v[160:163], v[156:159], v[132:135], v[160:163]
    v_cvt_pk_bf16_f32 v126, v68, v69
    v_cvt_pk_bf16_f32 v127, v70, v71
    s_waitcnt lgkmcnt(2)
    v_mfma_f32_32x32x16_bf16 v[56:71], v[136:139], v[8:11], v[24:39]
    s_cmp_lg_u32 s26, 0
    s_cbranch_scc1 P3_r17
    s_mov_b32 m0, s81
    s_nop 0
    buffer_load_dwordx4 v165, s[72:75], s82 offen lds
    buffer_load_dwordx4 v165, s[72:75], s82 offen offset:1024 lds
    s_add_u32 s82, s82, s84
P3_r17:
    v_exp_f32 v72, v72
    v_exp_f32 v73, v73
    v_exp_f32 v74, v74
    v_exp_f32 v75, v75
    v_cvt_pk_bf16_f32 v128, v72, v73
    v_mfma_f32_32x32x16_bf16 v[56:71], v[140:143], v[12:15], v[56:71]
    s_add_u32 m0, s46, 65536
    s_nop 0
    buffer_load_dwordx4 v165, s[32:35], s45 offen sc1 lds
    v_exp_f32 v76, v76
    v_exp_f32 v77, v77
    v_cvt_pk_bf16_f32 v129, v74, v75
    v_exp_f32 v78, v78
    v_exp_f32 v79, v79
    s_waitcnt lgkmcnt(0)
    v_mfma_f32_32x32x16_bf16 v[88:103], v[144:147], v[120:123], v[88:103]
    buffer_load_dwordx4 v165, s[32:35], s45 offen offset:1024 sc1 lds
    s_add_u32 s45, s45, 2048
    v_cvt_pk_bf16_f32 v130, v76, v77
    v_exp_f32 v80, v80
    v_exp_f32 v81, v81
    v_cvt_pk_bf16_f32 v131, v78, v79
    v_exp_f32 v82, v82
    v_mfma_f32_16x16x32_bf16 v[160:163], v[152:155], v[120:123], v[160:163]
    s_add_u32 m0, s46, 67584
    s_nop 0
    buffer_load_dwordx4 v7, s[36:39], s44 offen lds
    v_exp_f32 v83, v83
    v_cvt_pk_bf16_f32 v132, v80, v81
    v_mfma_f32_32x32x16_bf16 v[88:103], v[148:151], v[124:127], v[88:103]
    s_add_u32 m0, s46, 68608
    s_nop 0
    buffer_load_dwordx4 v7, s[40:43], s44 offen lds
    s_add_u32 s44, s44, 131072
    v_exp_f32 v84, v84
    v_exp_f32 v85, v85
    v_cvt_pk_bf16_f32 v133, v82, v83
    v_exp_f32 v86, v86
    v_exp_f32 v87, v87
    v_mfma_f32_16x16x32_bf16 v[160:163], v[152:155], v[124:127], v[160:163]
    v_cvt_pk_bf16_f32 v134, v84, v85
    v_cvt_pk_bf16_f32 v135, v86, v87
    s_setprio 0
    v_mfma_f32_32x32x16_bf16 v[72:87], v[136:139], v[16:19], v[40:55]
    v_exp_f32 v56, v56
    v_exp_f32 v57, v57
    v_exp_f32 v58, v58
    v_exp_f32 v59, v59
    v_cvt_pk_bf16_f32 v120, v56, v57
    v_mfma_f32_32x32x16_bf16 v[72:87], v[140:143], v[20:23], v[72:87]
    ds_read_b128 v[136:139], v164 offset:20480
    ds_read_b128 v[140:143], v164 offset:21504
    v_exp_f32 v60, v60
    v_exp_f32 v61, v61
    v_cvt_pk_bf16_f32 v121, v58, v59
    v_exp_f32 v62, v62
    v_exp_f32 v63, v63
    v_mfma_f32_32x32x16_bf16 v[104:119], v[144:147], v[128:131], v[104:119]
    v_cvt_pk_bf16_f32 v122, v60, v61
    v_exp_f32 v64, v64
    v_exp_f32 v65, v65
    v_cvt_pk_bf16_f32 v123, v62, v63
    v_exp_f32 v66, v66
    v_mfma_f32_16x16x32_bf16 v[160:163], v[156:159], v[128:131], v[160:163]
    v_exp_f32 v67, v67
    v_cvt_pk_bf16_f32 v124, v64, v65
    v_mfma_f32_32x32x16_bf16 v[104:119], v[148:151], v[132:135], v[104:119]
    ds_read_b128 v[144:147], v164 offset:22528
    ds_read_b128 v[148:151], v164 offset:23552
    v_exp_f32 v68, v68
    v_exp_f32 v69, v69
    v_cvt_pk_bf16_f32 v125, v66, v67
    v_exp_f32 v70, v70
    v_exp_f32 v71, v71
    v_mfma_f32_16x16x32_bf16 v[160:163], v[156:159], v[132:135], v[160:163]
    v_cvt_pk_bf16_f32 v126, v68, v69
    v_cvt_pk_bf16_f32 v127, v70, v71
    s_waitcnt lgkmcnt(2)
    v_mfma_f32_32x32x16_bf16 v[56:71], v[136:139], v[8:11], v[24:39]
    v_add_u32 v164, 4294868992, v164
    v_exp_f32 v72, v72
    v_exp_f32 v73, v73
    v_exp_f32 v74, v74
    v_exp_f32 v75, v75
    v_cvt_pk_bf16_f32 v128, v72, v73
    v_mfma_f32_32x32x16_bf16 v[56:71], v[140:143], v[12:15], v[56:71]
    v_exp_f32 v76, v76
    v_exp_f32 v77, v77
    v_cvt_pk_bf16_f32 v129, v74, v75
    v_exp_f32 v78, v78
    v_exp_f32 v79, v79
    s_waitcnt lgkmcnt(0)
    v_mfma_f32_32x32x16_bf16 v[88:103], v[144:147], v[120:123], v[88:103]
    v_cvt_pk_bf16_f32 v130, v76, v77
    v_exp_f32 v80, v80
    v_exp_f32 v81, v81
    v_cvt_pk_bf16_f32 v131, v78, v79
    v_exp_f32 v82, v82
    v_mfma_f32_16x16x32_bf16 v[160:163], v[152:155], v[120:123], v[160:163]
    v_exp_f32 v83, v83
    v_cvt_pk_bf16_f32 v132, v80, v81
    v_mfma_f32_32x32x16_bf16 v[88:103], v[148:151], v[124:127], v[88:103]
    v_exp_f32 v84, v84
    v_exp_f32 v85, v85
    v_cvt_pk_bf16_f32 v133, v82, v83
    v_exp_f32 v86, v86
    v_exp_f32 v87, v87
    v_mfma_f32_16x16x32_bf16 v[160:163], v[152:155], v[124:127], v[160:163]
    v_cvt_pk_bf16_f32 v134, v84, v85
    v_cvt_pk_bf16_f32 v135, v86, v87
    s_mov_b32 s22, 16384
    s_add_u32 s18, s18, 32768
    s_mov_b32 s19, 4
    s_mov_b32 s83, 0
    s_mov_b32 s59, 0
    s_branch AT_pre
AT_loopB:
    s_cmp_lg_u32 s83, 0
    s_cbranch_scc1 ATb_now0
    s_waitcnt vmcnt(0)
ATb_now0:
    s_barrier
    s_cmp_lg_u32 s16, 0
    s_cbranch_scc1 ATb_nohp
    s_add_u32 s3, s76, 32
    s_lshl_b32 s3, s3, 7
    buffer_load_dword v174, v175, s[60:63], s3 offen sc1
ATb_nohp:
    s_setprio 3
    v_mfma_f32_32x32x16_bf16 v[72:87], v[136:139], v[16:19], v[40:55]
    s_add_u32 m0, s81, s22
    s_xor_b32 s22, s22, 16384
    buffer_load_dwordx4 v165, s[72:75], s82 offen sc1 lds
    v_exp_f32 v56, v56
    v_exp_f32 v57, v57
    v_exp_f32 v58, v58
    v_exp_f32 v59, v59
    v_cvt_pk_bf16_f32 v120, v56, v57
    v_mfma_f32_32x32x16_bf16 v[72:87], v[140:143], v[20:23], v[72:87]
    ds_read_b128 v[136:139], v164 offset:0
    ds_read_b128 v[140:143], v164 offset:1024
    buffer_load_dwordx4 v165, s[72:75], s82 offen offset:1024 sc1 lds
    v_exp_f32 v60, v60
    v_exp_f32 v61, v61
    v_cvt_pk_bf16_f32 v121, v58, v59
    v_exp_f32 v62, v62
    v_exp_f32 v63, v63
    v_mfma_f32_32x32x16_bf16 v[104:119], v[144:147], v[128:131], v[104:119]
    v_cvt_pk_bf16_f32 v122, v60, v61
    v_exp_f32 v64, v64
    v_exp_f32 v65, v65
    v_cvt_pk_bf16_f32 v123, v62, v63
    v_exp_f32 v66, v66
    v_mfma_f32_16x16x32_bf16 v[160:163], v[156:159], v[128:131], v[160:163]
    v_exp_f32 v67, v67
    v_cvt_pk_bf16_f32 v124, v64, v65
    v_mfma_f32_32x32x16_bf16 v[104:119], v[148:151], v[132:135], v[104:119]
    ds_read_b128 v[144:147], v164 offset:2048
    ds_read_b128 v[148:151], v164 offset:3072
    v_exp_f32 v68, v68
    v_exp_f32 v69, v69
    v_cvt_pk_bf16_f32 v125, v66, v67
    v_exp_f32 v70, v70
    v_exp_f32 v71, v71
    v_mfma_f32_16x16x32_bf16 v[160:163], v[156:159], v[132:135], v[160:163]
    v_cvt_pk_bf16_f32 v126, v68, v69
    v_cvt_pk_bf16_f32 v127, v70, v71
    s_setprio 2
    s_waitcnt lgkmcnt(2)
    v_mfma_f32_32x32x16_bf16 v[56:71], v[136:139], v[8:11], v[24:39]
    buffer_load_dwordx4 v173, s[72:75], s82 offen offset:2048 sc1 lds
    v_exp_f32 v72, v72
    v_exp_f32 v73, v73
    v_exp_f32 v74, v74
    v_exp_f32 v75, v75
    v_cvt_pk_bf16_f32 v128, v72, v73
    v_mfma_f32_32x32x16_bf16 v[56:71], v[140:143], v[12:15], v[56:71]
    buffer_load_dwordx4 v173, s[72:75], s82 offen offset:3072 sc1 lds
    s_add_u32 s82, s82, s84
    s_add_u32 s18, s18, 4096
    v_exp_f32 v76, v76
    v_exp_f32 v77, v77
    v_cvt_pk_bf16_f32 v129, v74, v75
    v_exp_f32 v78, v78
    v_exp_f32 v79, v79
    s_waitcnt lgkmcnt(0)
    v_mfma_f32_32x32x16_bf16 v[88:103], v[144:147], v[120:123], v[88:103]
    v_cvt_pk_bf16_f32 v130, v76, v77
    v_exp_f32 v80, v80
    v_exp_f32 v81, v81
    v_cvt_pk_bf16_f32 v131, v78, v79
    v_exp_f32 v82, v82
    v_mfma_f32_16x16x32_bf16 v[160:163], v[152:155], v[120:123], v[160:163]
    v_exp_f32 v83, v83
    v_cvt_pk_bf16_f32 v132, v80, v81
    v_mfma_f32_32x32x16_bf16 v[88:103], v[148:151], v[124:127], v[88:103]
    v_exp_f32 v84, v84
    v_exp_f32 v85, v85
    v_cvt_pk_bf16_f32 v133, v82, v83
    v_exp_f32 v86, v86
    v_exp_f32 v87, v87
    v_mfma_f32_16x16x32_bf16 v[160:163], v[152:155], v[124:127], v[160:163]
    v_cvt_pk_bf16_f32 v134, v84, v85
    v_cvt_pk_bf16_f32 v135, v86, v87
    s_setprio 1
    v_mfma_f32_32x32x16_bf16 v[72:87], v[136:139], v[16:19], v[40:55]
    v_exp_f32 v56, v56
    v_exp_f32 v57, v57
    v_exp_f32 v58, v58
    v_exp_f32 v59, v59
    v_cvt_pk_bf16_f32 v120, v56, v57
    v_mfma_f32_32x32x16_bf16 v[72:87], v[140:143], v[20:23], v[72:87]
    ds_read_b128 v[136:139], v164 offset:4096
    ds_read_b128 v[140:143], v164 offset:5120
    v_exp_f32 v60, v60
    v_exp_f32 v61, v61
    v_cvt_pk_bf16_f32 v121, v58, v59
    v_exp_f32 v62, v62
    v_exp_f32 v63, v63
    v_mfma_f32_32x32x16_bf16 v[104:119], v[144:147], v[128:131], v[104:119]
    v_cvt_pk_bf16_f32 v122, v60, v61
    v_exp_f32 v64, v64
    v_exp_f32 v65, v65
    v_cvt_pk_bf16_f32 v123, v62, v63
    v_exp_f32 v66, v66
    v_mfma_f32_16x16x32_bf16 v[160:163], v[156:159], v[128:131], v[160:163]
    v_exp_f32 v67, v67
    v_cvt_pk_bf16_f32 v124, v64, v65
    v_mfma_f32_32x32x16_bf16 v[104:119], v[148:151], v[132:135], v[104:119]
    ds_read_b128 v[144:147], v164 offset:6144
    ds_read_b128 v[148:151], v164 offset:7168
    v_exp_f32 v68, v68
    v_exp_f32 v69, v69
    v_cvt_pk_bf16_f32 v125, v66, v67
    v_exp_f32 v70, v70
    v_exp_f32 v71, v71
    v_mfma_f32_16x16x32_bf16 v[160:163], v[156:159], v[132:135], v[160:163]
    v_cvt_pk_bf16_f32 v126, v68, v69
    v_cvt_pk_bf16_f32 v127, v70, v71
    s_setprio 0
    s_waitcnt lgkmcnt(2)
    v_mfma_f32_32x32x16_bf16 v[56:71], v[136:139], v[8:11], v[24:39]
    v_xor_b32 v164, 16384, v164
    v_exp_f32 v72, v72
    v_exp_f32 v73, v73
    v_exp_f32 v74, v74
    v_exp_f32 v75, v75
    v_cvt_pk_bf16_f32 v128, v72, v73
    v_mfma_f32_32x32x16_bf16 v[56:71], v[140:143], v[12:15], v[56:71]
    v_exp_f32 v76, v76
    v_exp_f32 v77, v77
    v_cvt_pk_bf16_f32 v129, v74, v75
    v_exp_f32 v78, v78
    v_exp_f32 v79, v79
    s_waitcnt lgkmcnt(0)
    v_mfma_f32_32x32x16_bf16 v[88:103], v[144:147], v[120:123], v[88:103]
    v_cvt_pk_bf16_f32 v130, v76, v77
    v_exp_f32 v80, v80
    v_exp_f32 v81, v81
    v_cvt_pk_bf16_f32 v131, v78, v79
    v_exp_f32 v82, v82
    v_mfma_f32_16x16x32_bf16 v[160:163], v[152:155], v[120:123], v[160:163]
    v_exp_f32 v83, v83
    v_cvt_pk_bf16_f32 v132, v80, v81
    v_mfma_f32_32x32x16_bf16 v[88:103], v[148:151], v[124:127], v[88:103]
    v_exp_f32 v84, v84
    v_exp_f32 v85, v85
    v_cvt_pk_bf16_f32 v133, v82, v83
    v_exp_f32 v86, v86
    v_exp_f32 v87, v87
    v_mfma_f32_16x16x32_bf16 v[160:163], v[152:155], v[124:127], v[160:163]
    v_cvt_pk_bf16_f32 v134, v84, v85
    v_cvt_pk_bf16_f32 v135, v86, v87
    s_add_u32 s23, s80, 2
    s_cmp_eq_u32 s19, s23
    s_cselect_b32 s83, 0, s83
    s_cmp_lg_u32 s83, 0
    s_cbranch_scc1 ATb_now1
    s_waitcnt vmcnt(0)
ATb_now1:
    s_cmp_lg_u32 s16, 0
    s_cbranch_scc1 ATb_hok
    s_add_u32 s23, s80, 1
    s_cmp_lg_u32 s19, s23
    s_cbranch_scc1 ATb_hok
ATb_hchk:
    v_readfirstlane_b32 s23, v174
    s_nop 0
    s_cmp_ge_u32 s23, 48
    s_cbranch_scc1 ATb_hok
    s_sleep 4
    buffer_load_dword v174, v175, s[60:63], s3 offen sc1
    s_waitcnt vmcnt(0)
    s_branch ATb_hchk
ATb_hok:
    s_barrier
    s_cmp_lg_u32 s16, 0
    s_cbranch_scc1 ATb_nohs
    s_cmp_lg_u32 s83, 0
    s_cbranch_scc1 ATb_nohs
    s_cmp_eq_u32 s59, 0
    s_cbranch_scc1 ATb_nohs
    s_mov_b64 exec, 1
    v_mov_b32 v2, 1
    buffer_atomic_add v2, v175, s[60:63], s59 offen
    s_mov_b64 exec, -1
    s_mov_b32 s59, 0
ATb_nohs:
    s_add_u32 s23, s80, 1
    s_cmp_lg_u32 s19, s23
    s_cbranch_scc1 ATb_nofirst
    s_cmp_lg_u32 s20, 0
    s_cbranch_scc1 ATb_nofirst
    v_and_b32 v2, 63, v0
    v_lshrrev_b32 v5, 5, v2
    v_mul_u32_u24 v3, 4096, v5
    v_bfe_u32 v4, v2, 2, 3
    v_lshl_add_u32 v3, v4, 7, v3
    v_and_b32 v5, 3, v2
    v_lshl_add_u32 v3, v5, 3, v3
    v_lshrrev_b32 v6, 1, v4
    s_and_b32 s23, s16, 3
    v_xor_b32 v5, s23, v6
    v_lshl_add_u32 v3, v5, 5, v3
    s_lshr_b32 s23, s16, 2
    s_mul_i32 s23, s23, 16384
    v_lshlrev_b32 v5, 4, v2
    v_add_u32 v5, s23, v5
    v_add_u32 v234, 34816, v3
    v_add_u32 v232, 32768, v5
    v_add_u32 v235, 100352, v3
    v_add_u32 v233, 98304, v5
    s_mul_i32 s46, s16, 4096
    s_mov_b32 s45, 0
    s_mov_b32 s44, 0
    s_add_u32 m0, s46, 32768
    s_nop 0
    buffer_load_dwordx4 v165, s[32:35], s45 offen sc1 lds
    buffer_load_dwordx4 v165, s[32:35], s45 offen offset:1024 sc1 lds
    s_add_u32 s45, s45, 2048
    s_add_u32 m0, s46, 34816
    s_nop 0
    buffer_load_dwordx4 v7, s[36:39], s44 offen lds
    s_add_u32 m0, s46, 35840
    s_nop 0
    buffer_load_dwordx4 v7, s[40:43], s44 offen lds
    s_add_u32 s44, s44, 131072
    s_add_u32 m0, s46, 65536
    s_nop 0
    buffer_load_dwordx4 v165, s[32:35], s45 offen sc1 lds
    buffer_load_dwordx4 v165, s[32:35], s45 offen offset:1024 sc1 lds
    s_add_u32 s45, s45, 2048
    s_add_u32 m0, s46, 67584
    s_nop 0
    buffer_load_dwordx4 v7, s[36:39], s44 offen lds
    s_add_u32 m0, s46, 68608
    s_nop 0
    buffer_load_dwordx4 v7, s[40:43], s44 offen lds
    s_add_u32 s44, s44, 131072
    v_mov_b32 v176, 0
    v_mov_b32 v177, 0
    v_mov_b32 v178, 0
    v_mov_b32 v179, 0
    v_mov_b32 v180, 0
    v_mov_b32 v181, 0
    v_mov_b32 v182, 0
    v_mov_b32 v183, 0
    v_mov_b32 v184, 0
    v_mov_b32 v185, 0
    v_mov_b32 v186, 0
    v_mov_b32 v187, 0
    v_mov_b32 v188, 0
    v_mov_b32 v189, 0
    v_mov_b32 v190, 0
    v_mov_b32 v191, 0
    v_mov_b32 v192, 0
    v_mov_b32 v193, 0
    v_mov_b32 v194, 0
    v_mov_b32 v195, 0
    v_mov_b32 v196, 0
    v_mov_b32 v197, 0
    v_mov_b32 v198, 0
    v_mov_b32 v199, 0
    v_mov_b32 v200, 0
    v_mov_b32 v201, 0
    v_mov_b32 v202, 0
    v_mov_b32 v203, 0
    v_mov_b32 v204, 0
    v_mov_b32 v205, 0
    v_mov_b32 v206, 0
    v_mov_b32 v207, 0
ATb_nofirst:
    s_cmp_eq_u32 s19, 1
    s_cselect_b32 s18, 0x10000000, s18
    s_cselect_b32 s82, 0x10000000, s82
    s_setprio 3
    v_mfma_f32_32x32x16_bf16 v[72:87], v[136:139], v[16:19], v[40:55]
    s_add_u32 m0, s81, s22
    s_xor_b32 s22, s22, 16384
    buffer_load_dwordx4 v165, s[72:75], s82 offen sc1 lds
    v_exp_f32 v56, v56
    v_exp_f32 v57, v57
    v_exp_f32 v58, v58
    v_exp_f32 v59, v59
    v_cvt_pk_bf16_f32 v120, v56, v57
    v_mfma_f32_32x32x16_bf16 v[72:87], v[140:143], v[20:23], v[72:87]
    ds_read_b128 v[136:139], v164 offset:0
    ds_read_b128 v[140:143], v164 offset:1024
    buffer_load_dwordx4 v165, s[72:75], s82 offen offset:1024 sc1 lds
    v_exp_f32 v60, v60
    v_exp_f32 v61, v61
    v_cvt_pk_bf16_f32 v121, v58, v59
    v_exp_f32 v62, v62
    v_exp_f32 v63, v63
    v_mfma_f32_32x32x16_bf16 v[104:119], v[144:147], v[128:131], v[104:119]
    v_cvt_pk_bf16_f32 v122, v60, v61
    v_exp_f32 v64, v64
    v_exp_f32 v65, v65
    v_cvt_pk_bf16_f32 v123, v62, v63
    v_exp_f32 v66, v66
    v_mfma_f32_16x16x32_bf16 v[160:163], v[156:159], v[128:131], v[160:163]
    v_exp_f32 v67, v67
    v_cvt_pk_bf16_f32 v124, v64, v65
    v_mfma_f32_32x32x16_bf16 v[104:119], v[148:151], v[132:135], v[104:119]
    ds_read_b128 v[144:147], v164 offset:2048
    ds_read_b128 v[148:151], v164 offset:3072
    v_exp_f32 v68, v68
    v_exp_f32 v69, v69
    v_cvt_pk_bf16_f32 v125, v66, v67
    v_exp_f32 v70, v70
    v_exp_f32 v71, v71
    v_mfma_f32_16x16x32_bf16 v[160:163], v[156:159], v[132:135], v[160:163]
    v_cvt_pk_bf16_f32 v126, v68, v69
    v_cvt_pk_bf16_f32 v127, v70, v71
    s_setprio 2
    s_waitcnt lgkmcnt(2)
    v_mfma_f32_32x32x16_bf16 v[56:71], v[136:139], v[8:11], v[24:39]
    buffer_load_dwordx4 v173, s[72:75], s82 offen offset:2048 sc1 lds
    v_exp_f32 v72, v72
    v_exp_f32 v73, v73
    v_exp_f32 v74, v74
    v_exp_f32 v75, v75
    v_cvt_pk_bf16_f32 v128, v72, v73
    v_mfma_f32_32x32x16_bf16 v[56:71], v[140:143], v[12:15], v[56:71]
    buffer_load_dwordx4 v173, s[72:75], s82 offen offset:3072 sc1 lds
    s_add_u32 s82, s82, s84
    s_add_u32 s18, s18, 4096
    v_exp_f32 v76, v76
    v_exp_f32 v77, v77
    v_cvt_pk_bf16_f32 v129, v74, v75
    v_exp_f32 v78, v78
    v_exp_f32 v79, v79
    s_waitcnt lgkmcnt(0)
    v_mfma_f32_32x32x16_bf16 v[88:103], v[144:147], v[120:123], v[88:103]
    v_cvt_pk_bf16_f32 v130, v76, v77
    v_exp_f32 v80, v80
    v_exp_f32 v81, v81
    v_cvt_pk_bf16_f32 v131, v78, v79
    v_exp_f32 v82, v82
    v_mfma_f32_16x16x32_bf16 v[160:163], v[152:155], v[120:123], v[160:163]
    v_exp_f32 v83, v83
    v_cvt_pk_bf16_f32 v132, v80, v81
    v_mfma_f32_32x32x16_bf16 v[88:103], v[148:151], v[124:127], v[88:103]
    v_exp_f32 v84, v84
    v_exp_f32 v85, v85
    v_cvt_pk_bf16_f32 v133, v82, v83
    v_exp_f32 v86, v86
    v_exp_f32 v87, v87
    v_mfma_f32_16x16x32_bf16 v[160:163], v[152:155], v[124:127], v[160:163]
    v_cvt_pk_bf16_f32 v134, v84, v85
    v_cvt_pk_bf16_f32 v135, v86, v87
    s_setprio 1
    v_mfma_f32_32x32x16_bf16 v[72:87], v[136:139], v[16:19], v[40:55]
    v_exp_f32 v56, v56
    v_exp_f32 v57, v57
    v_exp_f32 v58, v58
    v_exp_f32 v59, v59
    v_cvt_pk_bf16_f32 v120, v56, v57
    v_mfma_f32_32x32x16_bf16 v[72:87], v[140:143], v[20:23], v[72:87]
    ds_read_b128 v[136:139], v164 offset:4096
    ds_read_b128 v[140:143], v164 offset:5120
    v_exp_f32 v60, v60
    v_exp_f32 v61, v61
    v_cvt_pk_bf16_f32 v121, v58, v59
    v_exp_f32 v62, v62
    v_exp_f32 v63, v63
    v_mfma_f32_32x32x16_bf16 v[104:119], v[144:147], v[128:131], v[104:119]
    v_cvt_pk_bf16_f32 v122, v60, v61
    v_exp_f32 v64, v64
    v_exp_f32 v65, v65
    v_cvt_pk_bf16_f32 v123, v62, v63
    v_exp_f32 v66, v66
    v_mfma_f32_16x16x32_bf16 v[160:163], v[156:159], v[128:131], v[160:163]
    v_exp_f32 v67, v67
    v_cvt_pk_bf16_f32 v124, v64, v65
    v_mfma_f32_32x32x16_bf16 v[104:119], v[148:151], v[132:135], v[104:119]
    ds_read_b128 v[144:147], v164 offset:6144
    ds_read_b128 v[148:151], v164 offset:7168
    v_exp_f32 v68, v68
    v_exp_f32 v69, v69
    v_cvt_pk_bf16_f32 v125, v66, v67
    v_exp_f32 v70, v70
    v_exp_f32 v71, v71
    v_mfma_f32_16x16x32_bf16 v[160:163], v[156:159], v[132:135], v[160:163]
    v_cvt_pk_bf16_f32 v126, v68, v69
    v_cvt_pk_bf16_f32 v127, v70, v71
    s_setprio 0
    s_waitcnt lgkmcnt(2)
    v_mfma_f32_32x32x16_bf16 v[56:71], v[136:139], v[8:11], v[24:39]
    v_xor_b32 v164, 16384, v164
    v_exp_f32 v72, v72
    v_exp_f32 v73, v73
    v_exp_f32 v74, v74
    v_exp_f32 v75, v75
    v_cvt_pk_bf16_f32 v128, v72, v73
    v_mfma_f32_32x32x16_bf16 v[56:71], v[140:143], v[12:15], v[56:71]
    s_sub_u32 s19, s19, 1
    v_exp_f32 v76, v76
    v_exp_f32 v77, v77
    v_cvt_pk_bf16_f32 v129, v74, v75
    v_exp_f32 v78, v78
    v_exp_f32 v79, v79
    s_waitcnt lgkmcnt(0)
    v_mfma_f32_32x32x16_bf16 v[88:103], v[144:147], v[120:123], v[88:103]
    s_cmp_lg_u32 s19, s80
    v_cvt_pk_bf16_f32 v130, v76, v77
    v_exp_f32 v80, v80
    v_exp_f32 v81, v81
    v_cvt_pk_bf16_f32 v131, v78, v79
    v_exp_f32 v82, v82
    v_mfma_f32_16x16x32_bf16 v[160:163], v[152:155], v[120:123], v[160:163]
    v_exp_f32 v83, v83
    v_cvt_pk_bf16_f32 v132, v80, v81
    v_mfma_f32_32x32x16_bf16 v[88:103], v[148:151], v[124:127], v[88:103]
    v_exp_f32 v84, v84
    v_exp_f32 v85, v85
    v_cvt_pk_bf16_f32 v133, v82, v83
    v_exp_f32 v86, v86
    v_exp_f32 v87, v87
    v_mfma_f32_16x16x32_bf16 v[160:163], v[152:155], v[124:127], v[160:163]
    v_cvt_pk_bf16_f32 v134, v84, v85
    v_cvt_pk_bf16_f32 v135, v86, v87
    s_cbranch_scc1 AT_loopB
AT_pre:
    s_load_dwordx2 s[64:65], s[0:1], 0
    s_load_dwordx2 s[68:69], s[0:1], 80
    s_load_dwordx2 s[72:73], s[0:1], 72
    v_and_b32 v2, 63, v0
    v_lshrrev_b32 v5, 5, v2
    v_mul_u32_u24 v3, 6144, v5
    v_bfe_u32 v4, v2, 2, 3
    v_lshl_add_u32 v3, v4, 7, v3
    v_and_b32 v5, 3, v2
    v_lshl_add_u32 v3, v5, 3, v3
    v_lshrrev_b32 v6, 1, v4
    s_and_b32 s23, s16, 3
    v_xor_b32 v5, s23, v6
    v_lshl_add_u32 v3, v5, 5, v3
    s_lshr_b32 s23, s16, 2
    s_mul_i32 s23, s23, 12288
    v_lshlrev_b32 v5, 4, v2
    v_add_u32 v5, s23, v5
    v_add_u32 v241, 34816, v3
    v_add_u32 v239, 32768, v5
    v_add_u32 v242, 100352, v3
    v_add_u32 v240, 98304, v5
    s_mul_i32 s58, s16, 3072
    s_mov_b32 s57, 0
    s_mov_b32 s56, 0
    s_waitcnt lgkmcnt(0)
    s_and_b32 s65, s65, 0xffff
    s_mov_b32 s66, 4194304
    s_mov_b32 s67, 0x00020000
    s_and_b32 s69, s69, 0xffff
    s_mov_b32 s70, 4194304
    s_mov_b32 s71, 0x00020000
    s_and_b32 s73, s73, 0xffff
    s_mov_b32 s74, 2048
    s_mov_b32 s75, 0x00020000
    s_lshr_b32 s6, s2, 4
    s_lshl_b32 s6, s6, 7
    s_lshl_b32 s47, s76, 7
    s_lshl_b32 s7, s2, 7
    s_add_u32 s7, s7, 32768
    s_xor_b32 s30, s7, 128
    s_lshl_b32 s31, s2, 15
    s_lshl_b32 s23, s16, 12
    s_add_u32 s31, s31, s23
    s_add_u32 s31, s31, 41943040
    s_lshl_b32 s23, s77, 8
    s_lshl_b32 s24, s78, 7
    s_add_u32 s23, s23, s24
    s_lshl_b32 s4, s76, 18
    s_add_u32 s4, s4, s23
    s_lshl_b32 s5, s26, 17
    s_add_u32 s5, s5, s4
    s_and_b32 s24, s16, 3
    s_lshl_b32 s24, s24, 5
    s_add_u32 s5, s5, s24
    s_add_u32 s3, s23, s24
    s_lshl_b32 s79, s16, 15
    s_add_u32 s4, s4, s79
    s_mov_b32 s85, 3216550459
    v_lshrrev_b32 v4, 4, v1
    v_lshlrev_b32 v4, 3, v4
    v_mov_b32 v246, v4
    v_and_b32 v3, 15, v1
    v_lshl_add_u32 v243, v3, 11, v4
    v_lshl_add_u32 v244, v3, 7, v4
    s_lshl_b32 s79, s26, 13
    s_add_u32 s79, s79, s24
    v_add_u32 v244, s79, v244
    v_lshrrev_b32 v2, 3, v1
    v_lshlrev_b32 v2, 11, v2
    v_and_b32 v3, 7, v1
    v_lshl_add_u32 v245, v3, 4, v2
    s_lshl_b32 s23, s16, 2
    s_add_u32 s7, s7, s23
    s_add_u32 s30, s30, s23
    s_cmp_eq_u32 s19, 0
    s_cbranch_scc1 AT_end
AT_loopA:
    s_waitcnt vmcnt(0)
    s_barrier
    s_setprio 3
    ds_read_b128 v[208:211], v232 offset:0
    ds_read_b64_tr_b16 v[224:225], v234 offset:0
    ds_read_b64_tr_b16 v[226:227], v234 offset:8192
    ds_read_b128 v[212:215], v232 offset:4096
    ds_read_b128 v[216:219], v232 offset:8192
    ds_read_b128 v[220:223], v232 offset:12288
    ds_read_b64_tr_b16 v[228:229], v234 offset:1024
    ds_read_b64_tr_b16 v[230:231], v234 offset:9216
    v_mfma_f32_32x32x16_bf16 v[72:87], v[136:139], v[16:19], v[40:55]
    s_add_u32 m0, s17, s22
    s_xor_b32 s22, s22, 16384
    buffer_load_dwordx4 v165, s[12:15], s18 offen sc1 lds
    v_exp_f32 v56, v56
    v_exp_f32 v57, v57
    v_exp_f32 v58, v58
    v_mfma_f32_32x32x16_bf16 v[72:87], v[140:143], v[20:23], v[72:87]
    ds_read_b128 v[136:139], v164 offset:0
    ds_read_b128 v[140:143], v164 offset:1024
    buffer_load_dwordx4 v165, s[12:15], s18 offen offset:1024 sc1 lds
    s_add_u32 s18, s18, 4096
    v_exp_f32 v59, v59
    v_cvt_pk_bf16_f32 v120, v56, v57
    v_exp_f32 v60, v60
    v_mfma_f32_32x32x16_bf16 v[104:119], v[144:147], v[128:131], v[104:119]
    s_add_u32 m0, s46, 98304
    s_nop 0
    buffer_load_dwordx4 v165, s[32:35], s45 offen sc1 lds
    v_exp_f32 v61, v61
    v_cvt_pk_bf16_f32 v121, v58, v59
    v_exp_f32 v62, v62
    v_mfma_f32_16x16x32_bf16 v[160:163], v[156:159], v[128:131], v[160:163]
    buffer_load_dwordx4 v165, s[32:35], s45 offen offset:1024 sc1 lds
    s_add_u32 s45, s45, 2048
    v_exp_f32 v63, v63
    v_mfma_f32_32x32x16_bf16 v[104:119], v[148:151], v[132:135], v[104:119]
    ds_read_b128 v[144:147], v164 offset:2048
    ds_read_b128 v[148:151], v164 offset:3072
    v_cvt_pk_bf16_f32 v122, v60, v61
    v_exp_f32 v64, v64
    v_exp_f32 v65, v65
    v_cvt_pk_bf16_f32 v123, v62, v63
    v_mfma_f32_16x16x32_bf16 v[160:163], v[156:159], v[132:135], v[160:163]
    v_exp_f32 v66, v66
    s_waitcnt lgkmcnt(4)
    v_mfma_f32_16x16x32_bf16 v[176:179], v[224:227], v[208:211], v[176:179]
    v_exp_f32 v67, v67
    v_mfma_f32_16x16x32_bf16 v[180:183], v[224:227], v[212:215], v[180:183]
    v_cvt_pk_bf16_f32 v124, v64, v65
    v_mfma_f32_16x16x32_bf16 v[184:187], v[224:227], v[216:219], v[184:187]
    v_exp_f32 v68, v68
    v_mfma_f32_16x16x32_bf16 v[188:191], v[224:227], v[220:223], v[188:191]
    v_exp_f32 v69, v69
    v_mfma_f32_16x16x32_bf16 v[204:207], v[228:231], v[220:223], v[204:207]
    v_cvt_pk_bf16_f32 v125, v66, v67
    v_mfma_f32_16x16x32_bf16 v[200:203], v[228:231], v[216:219], v[200:203]
    v_exp_f32 v70, v70
    v_mfma_f32_16x16x32_bf16 v[196:199], v[228:231], v[212:215], v[196:199]
    v_exp_f32 v71, v71
    v_mfma_f32_16x16x32_bf16 v[192:195], v[228:231], v[208:211], v[192:195]
    v_cvt_pk_bf16_f32 v126, v68, v69
    v_cvt_pk_bf16_f32 v127, v70, v71
    s_setprio 2
    s_waitcnt lgkmcnt(2)
    ds_read_b128 v[208:211], v232 offset:1024
    ds_read_b64_tr_b16 v[224:225], v234 offset:16384
    ds_read_b64_tr_b16 v[226:227], v234 offset:24576
    ds_read_b128 v[212:215], v232 offset:5120
    ds_read_b128 v[216:219], v232 offset:9216
    ds_read_b128 v[220:223], v232 offset:13312
    ds_read_b64_tr_b16 v[228:229], v234 offset:17408
    ds_read_b64_tr_b16 v[230:231], v234 offset:25600
    v_mfma_f32_32x32x16_bf16 v[56:71], v[136:139], v[8:11], v[24:39]
    s_add_u32 m0, s46, 100352
    s_nop 0
    buffer_load_dwordx4 v7, s[36:39], s44 offen lds
    v_exp_f32 v72, v72
    v_exp_f32 v73, v73
    v_exp_f32 v74, v74
    v_mfma_f32_32x32x16_bf16 v[56:71], v[140:143], v[12:15], v[56:71]
    s_add_u32 m0, s46, 101376
    s_nop 0
    buffer_load_dwordx4 v7, s[40:43], s44 offen lds
    s_add_u32 s44, s44, 131072
    v_exp_f32 v75, v75
    v_cvt_pk_bf16_f32 v128, v72, v73
    v_exp_f32 v76, v76
    s_waitcnt lgkmcnt(8)
    v_mfma_f32_32x32x16_bf16 v[88:103], v[144:147], v[120:123], v[88:103]
    s_add_u32 m0, s46, 131072
    s_nop 0
    buffer_load_dwordx4 v165, s[32:35], s45 offen sc1 lds
    v_exp_f32 v77, v77
    v_cvt_pk_bf16_f32 v129, v74, v75
    v_exp_f32 v78, v78
    v_mfma_f32_16x16x32_bf16 v[160:163], v[152:155], v[120:123], v[160:163]
    buffer_load_dwordx4 v165, s[32:35], s45 offen offset:1024 sc1 lds
    s_add_u32 s45, s45, 2048
    v_exp_f32 v79, v79
    v_mfma_f32_32x32x16_bf16 v[88:103], v[148:151], v[124:127], v[88:103]
    v_cvt_pk_bf16_f32 v130, v76, v77
    v_exp_f32 v80, v80
    v_exp_f32 v81, v81
    v_cvt_pk_bf16_f32 v131, v78, v79
    v_mfma_f32_16x16x32_bf16 v[160:163], v[152:155], v[124:127], v[160:163]
    v_exp_f32 v82, v82
    s_waitcnt lgkmcnt(0)
    v_mfma_f32_16x16x32_bf16 v[176:179], v[224:227], v[208:211], v[176:179]
    v_exp_f32 v83, v83
    v_mfma_f32_16x16x32_bf16 v[180:183], v[224:227], v[212:215], v[180:183]
    v_cvt_pk_bf16_f32 v132, v80, v81
    v_mfma_f32_16x16x32_bf16 v[184:187], v[224:227], v[216:219], v[184:187]
    v_exp_f32 v84, v84
    v_mfma_f32_16x16x32_bf16 v[188:191], v[224:227], v[220:223], v[188:191]
    v_exp_f32 v85, v85
    v_mfma_f32_16x16x32_bf16 v[204:207], v[228:231], v[220:223], v[204:207]
    v_cvt_pk_bf16_f32 v133, v82, v83
    v_mfma_f32_16x16x32_bf16 v[200:203], v[228:231], v[216:219], v[200:203]
    v_exp_f32 v86, v86
    v_mfma_f32_16x16x32_bf16 v[196:199], v[228:231], v[212:215], v[196:199]
    v_exp_f32 v87, v87
    v_mfma_f32_16x16x32_bf16 v[192:195], v[228:231], v[208:211], v[192:195]
    v_cvt_pk_bf16_f32 v134, v84, v85
    v_cvt_pk_bf16_f32 v135, v86, v87
    s_setprio 1
    ds_read_b128 v[208:211], v232 offset:32768
    ds_read_b64_tr_b16 v[224:225], v234 offset:32768
    ds_read_b64_tr_b16 v[226:227], v234 offset:40960
    ds_read_b128 v[212:215], v232 offset:36864
    ds_read_b128 v[216:219], v232 offset:40960
    ds_read_b128 v[220:223], v232 offset:45056
    ds_read_b64_tr_b16 v[228:229], v234 offset:33792
    ds_read_b64_tr_b16 v[230:231], v234 offset:41984
    v_mfma_f32_32x32x16_bf16 v[72:87], v[136:139], v[16:19], v[40:55]
    s_add_u32 m0, s46, 133120
    s_nop 0
    buffer_load_dwordx4 v7, s[36:39], s44 offen lds
    v_exp_f32 v56, v56
    v_exp_f32 v57, v57
    v_exp_f32 v58, v58
    v_mfma_f32_32x32x16_bf16 v[72:87], v[140:143], v[20:23], v[72:87]
    ds_read_b128 v[136:139], v164 offset:4096
    ds_read_b128 v[140:143], v164 offset:5120
    s_add_u32 m0, s46, 134144
    s_nop 0
    buffer_load_dwordx4 v7, s[40:43], s44 offen lds
    s_add_u32 s44, s44, 131072
    v_exp_f32 v59, v59
    v_cvt_pk_bf16_f32 v120, v56, v57
    v_exp_f32 v60, v60
    v_mfma_f32_32x32x16_bf16 v[104:119], v[144:147], v[128:131], v[104:119]
    v_exp_f32 v61, v61
    v_cvt_pk_bf16_f32 v121, v58, v59
    v_exp_f32 v62, v62
    v_mfma_f32_16x16x32_bf16 v[160:163], v[156:159], v[128:131], v[160:163]
    v_exp_f32 v63, v63
    v_mfma_f32_32x32x16_bf16 v[104:119], v[148:151], v[132:135], v[104:119]
    ds_read_b128 v[144:147], v164 offset:6144
    ds_read_b128 v[148:151], v164 offset:7168
    v_cvt_pk_bf16_f32 v122, v60, v61
    v_exp_f32 v64, v64
    v_exp_f32 v65, v65
    v_cvt_pk_bf16_f32 v123, v62, v63
    v_mfma_f32_16x16x32_bf16 v[160:163], v[156:159], v[132:135], v[160:163]
    v_exp_f32 v66, v66
    s_waitcnt lgkmcnt(4)
    v_mfma_f32_16x16x32_bf16 v[176:179], v[224:227], v[208:211], v[176:179]
    v_exp_f32 v67, v67
    v_mfma_f32_16x16x32_bf16 v[180:183], v[224:227], v[212:215], v[180:183]
    v_cvt_pk_bf16_f32 v124, v64, v65
    v_mfma_f32_16x16x32_bf16 v[184:187], v[224:227], v[216:219], v[184:187]
    v_exp_f32 v68, v68
    v_mfma_f32_16x16x32_bf16 v[188:191], v[224:227], v[220:223], v[188:191]
    v_exp_f32 v69, v69
    v_mfma_f32_16x16x32_bf16 v[204:207], v[228:231], v[220:223], v[204:207]
    v_cvt_pk_bf16_f32 v125, v66, v67
    v_mfma_f32_16x16x32_bf16 v[200:203], v[228:231], v[216:219], v[200:203]
    v_exp_f32 v70, v70
    v_mfma_f32_16x16x32_bf16 v[196:199], v[228:231], v[212:215], v[196:199]
    v_exp_f32 v71, v71
    v_mfma_f32_16x16x32_bf16 v[192:195], v[228:231], v[208:211], v[192:195]
    v_cvt_pk_bf16_f32 v126, v68, v69
    v_cvt_pk_bf16_f32 v127, v70, v71
    s_setprio 0
    s_waitcnt lgkmcnt(2)
    ds_read_b128 v[208:211], v232 offset:33792
    ds_read_b64_tr_b16 v[224:225], v234 offset:49152
    ds_read_b64_tr_b16 v[226:227], v234 offset:57344
    ds_read_b128 v[212:215], v232 offset:37888
    ds_read_b128 v[216:219], v232 offset:41984
    ds_read_b128 v[220:223], v232 offset:46080
    ds_read_b64_tr_b16 v[228:229], v234 offset:50176
    ds_read_b64_tr_b16 v[230:231], v234 offset:58368
    v_mfma_f32_32x32x16_bf16 v[56:71], v[136:139], v[8:11], v[24:39]
    v_xor_b32 v164, 16384, v164
    v_exp_f32 v72, v72
    v_exp_f32 v73, v73
    v_exp_f32 v74, v74
    v_mfma_f32_32x32x16_bf16 v[56:71], v[140:143], v[12:15], v[56:71]
    v_exp_f32 v75, v75
    v_cvt_pk_bf16_f32 v128, v72, v73
    v_exp_f32 v76, v76
    s_waitcnt lgkmcnt(8)
    v_mfma_f32_32x32x16_bf16 v[88:103], v[144:147], v[120:123], v[88:103]
    v_exp_f32 v77, v77
    v_cvt_pk_bf16_f32 v129, v74, v75
    v_exp_f32 v78, v78
    v_mfma_f32_16x16x32_bf16 v[160:163], v[152:155], v[120:123], v[160:163]
    v_exp_f32 v79, v79
    v_mfma_f32_32x32x16_bf16 v[88:103], v[148:151], v[124:127], v[88:103]
    v_cvt_pk_bf16_f32 v130, v76, v77
    v_exp_f32 v80, v80
    v_exp_f32 v81, v81
    v_cvt_pk_bf16_f32 v131, v78, v79
    v_mfma_f32_16x16x32_bf16 v[160:163], v[152:155], v[124:127], v[160:163]
    v_exp_f32 v82, v82
    s_waitcnt lgkmcnt(0)
    v_mfma_f32_16x16x32_bf16 v[176:179], v[224:227], v[208:211], v[176:179]
    v_exp_f32 v83, v83
    v_mfma_f32_16x16x32_bf16 v[180:183], v[224:227], v[212:215], v[180:183]
    v_cvt_pk_bf16_f32 v132, v80, v81
    v_mfma_f32_16x16x32_bf16 v[184:187], v[224:227], v[216:219], v[184:187]
    v_exp_f32 v84, v84
    v_mfma_f32_16x16x32_bf16 v[188:191], v[224:227], v[220:223], v[188:191]
    v_exp_f32 v85, v85
    v_mfma_f32_16x16x32_bf16 v[204:207], v[228:231], v[220:223], v[204:207]
    v_cvt_pk_bf16_f32 v133, v82, v83
    v_mfma_f32_16x16x32_bf16 v[200:203], v[228:231], v[216:219], v[200:203]
    v_exp_f32 v86, v86
    v_mfma_f32_16x16x32_bf16 v[196:199], v[228:231], v[212:215], v[196:199]
    v_exp_f32 v87, v87
    v_mfma_f32_16x16x32_bf16 v[192:195], v[228:231], v[208:211], v[192:195]
    v_cvt_pk_bf16_f32 v134, v84, v85
    v_cvt_pk_bf16_f32 v135, v86, v87
    s_waitcnt vmcnt(0)
    s_barrier
    s_cmp_eq_u32 s19, 1
    s_cselect_b32 s18, 0x10000000, s18
    s_setprio 3
    ds_read_b128 v[208:211], v233 offset:0
    ds_read_b64_tr_b16 v[224:225], v235 offset:0
    ds_read_b64_tr_b16 v[226:227], v235 offset:8192
    ds_read_b128 v[212:215], v233 offset:4096
    ds_read_b128 v[216:219], v233 offset:8192
    ds_read_b128 v[220:223], v233 offset:12288
    ds_read_b64_tr_b16 v[228:229], v235 offset:1024
    ds_read_b64_tr_b16 v[230:231], v235 offset:9216
    v_mfma_f32_32x32x16_bf16 v[72:87], v[136:139], v[16:19], v[40:55]
    s_add_u32 m0, s17, s22
    s_xor_b32 s22, s22, 16384
    buffer_load_dwordx4 v165, s[12:15], s18 offen sc1 lds
    v_exp_f32 v56, v56
    v_exp_f32 v57, v57
    v_exp_f32 v58, v58
    v_mfma_f32_32x32x16_bf16 v[72:87], v[140:143], v[20:23], v[72:87]
    ds_read_b128 v[136:139], v164 offset:0
    ds_read_b128 v[140:143], v164 offset:1024
    buffer_load_dwordx4 v165, s[12:15], s18 offen offset:1024 sc1 lds
    s_add_u32 s18, s18, 4096
    v_exp_f32 v59, v59
    v_cvt_pk_bf16_f32 v120, v56, v57
    v_exp_f32 v60, v60
    v_mfma_f32_32x32x16_bf16 v[104:119], v[144:147], v[128:131], v[104:119]
    s_add_u32 m0, s46, 32768
    s_nop 0
    buffer_load_dwordx4 v165, s[32:35], s45 offen sc1 lds
    v_exp_f32 v61, v61
    v_cvt_pk_bf16_f32 v121, v58, v59
    v_exp_f32 v62, v62
    v_mfma_f32_16x16x32_bf16 v[160:163], v[156:159], v[128:131], v[160:163]
    buffer_load_dwordx4 v165, s[32:35], s45 offen offset:1024 sc1 lds
    s_add_u32 s45, s45, 2048
    v_exp_f32 v63, v63
    v_mfma_f32_32x32x16_bf16 v[104:119], v[148:151], v[132:135], v[104:119]
    ds_read_b128 v[144:147], v164 offset:2048
    ds_read_b128 v[148:151], v164 offset:3072
    v_cvt_pk_bf16_f32 v122, v60, v61
    v_exp_f32 v64, v64
    v_exp_f32 v65, v65
    v_cvt_pk_bf16_f32 v123, v62, v63
    v_mfma_f32_16x16x32_bf16 v[160:163], v[156:159], v[132:135], v[160:163]
    v_exp_f32 v66, v66
    s_waitcnt lgkmcnt(4)
    v_mfma_f32_16x16x32_bf16 v[176:179], v[224:227], v[208:211], v[176:179]
    v_exp_f32 v67, v67
    v_mfma_f32_16x16x32_bf16 v[180:183], v[224:227], v[212:215], v[180:183]
    v_cvt_pk_bf16_f32 v124, v64, v65
    v_mfma_f32_16x16x32_bf16 v[184:187], v[224:227], v[216:219], v[184:187]
    v_exp_f32 v68, v68
    v_mfma_f32_16x16x32_bf16 v[188:191], v[224:227], v[220:223], v[188:191]
    v_exp_f32 v69, v69
    v_mfma_f32_16x16x32_bf16 v[204:207], v[228:231], v[220:223], v[204:207]
    v_cvt_pk_bf16_f32 v125, v66, v67
    v_mfma_f32_16x16x32_bf16 v[200:203], v[228:231], v[216:219], v[200:203]
    v_exp_f32 v70, v70
    v_mfma_f32_16x16x32_bf16 v[196:199], v[228:231], v[212:215], v[196:199]
    v_exp_f32 v71, v71
    v_mfma_f32_16x16x32_bf16 v[192:195], v[228:231], v[208:211], v[192:195]
    v_cvt_pk_bf16_f32 v126, v68, v69
    v_cvt_pk_bf16_f32 v127, v70, v71
    s_setprio 2
    s_waitcnt lgkmcnt(2)
    ds_read_b128 v[208:211], v233 offset:1024
    ds_read_b64_tr_b16 v[224:225], v235 offset:16384
    ds_read_b64_tr_b16 v[226:227], v235 offset:24576
    ds_read_b128 v[212:215], v233 offset:5120
    ds_read_b128 v[216:219], v233 offset:9216
    ds_read_b128 v[220:223], v233 offset:13312
    ds_read_b64_tr_b16 v[228:229], v235 offset:17408
    ds_read_b64_tr_b16 v[230:231], v235 offset:25600
    v_mfma_f32_32x32x16_bf16 v[56:71], v[136:139], v[8:11], v[24:39]
    s_add_u32 m0, s46, 34816
    s_nop 0
    buffer_load_dwordx4 v7, s[36:39], s44 offen lds
    v_exp_f32 v72, v72
    v_exp_f32 v73, v73
    v_exp_f32 v74, v74
    v_mfma_f32_32x32x16_bf16 v[56:71], v[140:143], v[12:15], v[56:71]
    s_add_u32 m0, s46, 35840
    s_nop 0
    buffer_load_dwordx4 v7, s[40:43], s44 offen lds
    s_add_u32 s44, s44, 131072
    v_exp_f32 v75, v75
    v_cvt_pk_bf16_f32 v128, v72, v73
    v_exp_f32 v76, v76
    s_waitcnt lgkmcnt(8)
    v_mfma_f32_32x32x16_bf16 v[88:103], v[144:147], v[120:123], v[88:103]
    s_add_u32 m0, s46, 65536
    s_nop 0
    buffer_load_dwordx4 v165, s[32:35], s45 offen sc1 lds
    v_exp_f32 v77, v77
    v_cvt_pk_bf16_f32 v129, v74, v75
    v_exp_f32 v78, v78
    v_mfma_f32_16x16x32_bf16 v[160:163], v[152:155], v[120:123], v[160:163]
    buffer_load_dwordx4 v165, s[32:35], s45 offen offset:1024 sc1 lds
    s_add_u32 s45, s45, 2048
    v_exp_f32 v79, v79
    v_mfma_f32_32x32x16_bf16 v[88:103], v[148:151], v[124:127], v[88:103]
    v_cvt_pk_bf16_f32 v130, v76, v77
    v_exp_f32 v80, v80
    v_exp_f32 v81, v81
    v_cvt_pk_bf16_f32 v131, v78, v79
    v_mfma_f32_16x16x32_bf16 v[160:163], v[152:155], v[124:127], v[160:163]
    v_exp_f32 v82, v82
    s_waitcnt lgkmcnt(0)
    v_mfma_f32_16x16x32_bf16 v[176:179], v[224:227], v[208:211], v[176:179]
    v_exp_f32 v83, v83
    v_mfma_f32_16x16x32_bf16 v[180:183], v[224:227], v[212:215], v[180:183]
    v_cvt_pk_bf16_f32 v132, v80, v81
    v_mfma_f32_16x16x32_bf16 v[184:187], v[224:227], v[216:219], v[184:187]
    v_exp_f32 v84, v84
    v_mfma_f32_16x16x32_bf16 v[188:191], v[224:227], v[220:223], v[188:191]
    v_exp_f32 v85, v85
    v_mfma_f32_16x16x32_bf16 v[204:207], v[228:231], v[220:223], v[204:207]
    v_cvt_pk_bf16_f32 v133, v82, v83
    v_mfma_f32_16x16x32_bf16 v[200:203], v[228:231], v[216:219], v[200:203]
    v_exp_f32 v86, v86
    v_mfma_f32_16x16x32_bf16 v[196:199], v[228:231], v[212:215], v[196:199]
    v_exp_f32 v87, v87
    v_mfma_f32_16x16x32_bf16 v[192:195], v[228:231], v[208:211], v[192:195]
    v_cvt_pk_bf16_f32 v134, v84, v85
    v_cvt_pk_bf16_f32 v135, v86, v87
    s_setprio 1
    ds_read_b128 v[208:211], v233 offset:32768
    ds_read_b64_tr_b16 v[224:225], v235 offset:32768
    ds_read_b64_tr_b16 v[226:227], v235 offset:40960
    ds_read_b128 v[212:215], v233 offset:36864
    ds_read_b128 v[216:219], v233 offset:40960
    ds_read_b128 v[220:223], v233 offset:45056
    ds_read_b64_tr_b16 v[228:229], v235 offset:33792
    ds_read_b64_tr_b16 v[230:231], v235 offset:41984
    v_mfma_f32_32x32x16_bf16 v[72:87], v[136:139], v[16:19], v[40:55]
    s_add_u32 m0, s46, 67584
    s_nop 0
    buffer_load_dwordx4 v7, s[36:39], s44 offen lds
    v_exp_f32 v56, v56
    v_exp_f32 v57, v57
    v_exp_f32 v58, v58
    v_mfma_f32_32x32x16_bf16 v[72:87], v[140:143], v[20:23], v[72:87]
    ds_read_b128 v[136:139], v164 offset:4096
    ds_read_b128 v[140:143], v164 offset:5120
    s_add_u32 m0, s46, 68608
    s_nop 0
    buffer_load_dwordx4 v7, s[40:43], s44 offen lds
    s_add_u32 s44, s44, 131072
    v_exp_f32 v59, v59
    v_cvt_pk_bf16_f32 v120, v56, v57
    v_exp_f32 v60, v60
    v_mfma_f32_32x32x16_bf16 v[104:119], v[144:147], v[128:131], v[104:119]
    v_exp_f32 v61, v61
    v_cvt_pk_bf16_f32 v121, v58, v59
    v_exp_f32 v62, v62
    v_mfma_f32_16x16x32_bf16 v[160:163], v[156:159], v[128:131], v[160:163]
    v_exp_f32 v63, v63
    v_mfma_f32_32x32x16_bf16 v[104:119], v[148:151], v[132:135], v[104:119]
    ds_read_b128 v[144:147], v164 offset:6144
    ds_read_b128 v[148:151], v164 offset:7168
    v_cvt_pk_bf16_f32 v122, v60, v61
    v_exp_f32 v64, v64
    v_exp_f32 v65, v65
    v_cvt_pk_bf16_f32 v123, v62, v63
    v_mfma_f32_16x16x32_bf16 v[160:163], v[156:159], v[132:135], v[160:163]
    v_exp_f32 v66, v66
    s_waitcnt lgkmcnt(4)
    v_mfma_f32_16x16x32_bf16 v[176:179], v[224:227], v[208:211], v[176:179]
    v_exp_f32 v67, v67
    v_mfma_f32_16x16x32_bf16 v[180:183], v[224:227], v[212:215], v[180:183]
    v_cvt_pk_bf16_f32 v124, v64, v65
    v_mfma_f32_16x16x32_bf16 v[184:187], v[224:227], v[216:219], v[184:187]
    v_exp_f32 v68, v68
    v_mfma_f32_16x16x32_bf16 v[188:191], v[224:227], v[220:223], v[188:191]
    v_exp_f32 v69, v69
    v_mfma_f32_16x16x32_bf16 v[204:207], v[228:231], v[220:223], v[204:207]
    v_cvt_pk_bf16_f32 v125, v66, v67
    v_mfma_f32_16x16x32_bf16 v[200:203], v[228:231], v[216:219], v[200:203]
    v_exp_f32 v70, v70
    v_mfma_f32_16x16x32_bf16 v[196:199], v[228:231], v[212:215], v[196:199]
    v_exp_f32 v71, v71
    v_mfma_f32_16x16x32_bf16 v[192:195], v[228:231], v[208:211], v[192:195]
    v_cvt_pk_bf16_f32 v126, v68, v69
    v_cvt_pk_bf16_f32 v127, v70, v71
    s_setprio 0
    s_waitcnt lgkmcnt(2)
    ds_read_b128 v[208:211], v233 offset:33792
    ds_read_b64_tr_b16 v[224:225], v235 offset:49152
    ds_read_b64_tr_b16 v[226:227], v235 offset:57344
    ds_read_b128 v[212:215], v233 offset:37888
    ds_read_b128 v[216:219], v233 offset:41984
    ds_read_b128 v[220:223], v233 offset:46080
    ds_read_b64_tr_b16 v[228:229], v235 offset:50176
    ds_read_b64_tr_b16 v[230:231], v235 offset:58368
    v_mfma_f32_32x32x16_bf16 v[56:71], v[136:139], v[8:11], v[24:39]
    v_xor_b32 v164, 16384, v164
    v_exp_f32 v72, v72
    v_exp_f32 v73, v73
    v_exp_f32 v74, v74
    v_mfma_f32_32x32x16_bf16 v[56:71], v[140:143], v[12:15], v[56:71]
    s_sub_u32 s19, s19, 1
    v_exp_f32 v75, v75
    v_cvt_pk_bf16_f32 v128, v72, v73
    v_exp_f32 v76, v76
    s_waitcnt lgkmcnt(8)
    v_mfma_f32_32x32x16_bf16 v[88:103], v[144:147], v[120:123], v[88:103]
    s_cmp_lg_u32 s19, 0
    v_exp_f32 v77, v77
    v_cvt_pk_bf16_f32 v129, v74, v75
    v_exp_f32 v78, v78
    v_mfma_f32_16x16x32_bf16 v[160:163], v[152:155], v[120:123], v[160:163]
    v_exp_f32 v79, v79
    v_mfma_f32_32x32x16_bf16 v[88:103], v[148:151], v[124:127], v[88:103]
    v_cvt_pk_bf16_f32 v130, v76, v77
    v_exp_f32 v80, v80
    v_exp_f32 v81, v81
    v_cvt_pk_bf16_f32 v131, v78, v79
    v_mfma_f32_16x16x32_bf16 v[160:163], v[152:155], v[124:127], v[160:163]
    v_exp_f32 v82, v82
    s_waitcnt lgkmcnt(0)
    v_mfma_f32_16x16x32_bf16 v[176:179], v[224:227], v[208:211], v[176:179]
    v_exp_f32 v83, v83
    v_mfma_f32_16x16x32_bf16 v[180:183], v[224:227], v[212:215], v[180:183]
    v_cvt_pk_bf16_f32 v132, v80, v81
    v_mfma_f32_16x16x32_bf16 v[184:187], v[224:227], v[216:219], v[184:187]
    v_exp_f32 v84, v84
    v_mfma_f32_16x16x32_bf16 v[188:191], v[224:227], v[220:223], v[188:191]
    v_exp_f32 v85, v85
    v_mfma_f32_16x16x32_bf16 v[204:207], v[228:231], v[220:223], v[204:207]
    v_cvt_pk_bf16_f32 v133, v82, v83
    v_mfma_f32_16x16x32_bf16 v[200:203], v[228:231], v[216:219], v[200:203]
    v_exp_f32 v86, v86
    v_mfma_f32_16x16x32_bf16 v[196:199], v[228:231], v[212:215], v[196:199]
    v_exp_f32 v87, v87
    v_mfma_f32_16x16x32_bf16 v[192:195], v[228:231], v[208:211], v[192:195]
    v_cvt_pk_bf16_f32 v134, v84, v85
    v_cvt_pk_bf16_f32 v135, v86, v87
    s_cbranch_scc1 AT_loopA
AT_end:
    s_setprio 0
    v_mfma_f32_32x32x16_bf16 v[104:119], v[144:147], v[128:131], v[104:119]
    v_mfma_f32_16x16x32_bf16 v[160:163], v[156:159], v[128:131], v[160:163]
    v_mfma_f32_32x32x16_bf16 v[104:119], v[148:151], v[132:135], v[104:119]
    v_mfma_f32_16x16x32_bf16 v[160:163], v[156:159], v[132:135], v[160:163]
    v_and_b32 v166, 16, v1
    v_cmp_ne_u32 vcc, 0, v166
    v_mov_b32 v170, 0
    s_lshl_b32 s23, s16, 12
    s_add_u32 s23, s23, 131072
    v_add_u32 v171, s23, v165
    v_lshlrev_b32 v172, 2, v1
    v_add_u32 v172, s17, v172
    v_cndmask_b32 v168, v160, v161, vcc
    v_cndmask_b32 v169, v162, v163, vcc
    s_waitcnt vmcnt(0)
    s_barrier
    ds_write_b128 v171, v[104:107] offset:0
    ds_write_b128 v171, v[108:111] offset:1024
    ds_write_b128 v171, v[112:115] offset:2048
    ds_write_b128 v171, v[116:119] offset:3072
    v_max3_f32 v170, |v88|, |v89|, v170
    v_max3_f32 v170, |v90|, |v91|, v170
    v_max3_f32 v170, |v92|, |v93|, v170
    v_max3_f32 v170, |v94|, |v95|, v170
    v_max3_f32 v170, |v96|, |v97|, v170
    v_max3_f32 v170, |v98|, |v99|, v170
    v_max3_f32 v170, |v100|, |v101|, v170
    v_max3_f32 v170, |v102|, |v103|, v170
    v_max3_f32 v170, |v104|, |v105|, v170
    v_max3_f32 v170, |v106|, |v107|, v170
    v_max3_f32 v170, |v108|, |v109|, v170
    v_max3_f32 v170, |v110|, |v111|, v170
    v_max3_f32 v170, |v112|, |v113|, v170
    v_max3_f32 v170, |v114|, |v115|, v170
    v_max3_f32 v170, |v116|, |v117|, v170
    v_max3_f32 v170, |v118|, |v119|, v170
    v_mov_b32 v167, 0x71800000
    v_cmp_nlt_f32 vcc, v168, v167
    v_cmp_nlt_f32 s[28:29], v169, v167
    s_nop 0
    s_or_b64 vcc, vcc, s[28:29]
    v_mov_b32 v167, 0x7e800000
    v_cmp_nlt_f32 s[28:29], v170, v167
    s_nop 0
    s_or_b64 vcc, vcc, s[28:29]
    s_cmp_lg_u64 vcc, 0
    s_cselect_b32 s23, 1, 0
    v_mov_b32 v167, s23
    s_waitcnt vmcnt(0)
    ds_write_b32 v172, v169
    ds_write_b32 v172, v167 offset:256
    v_xor_b32 v171, 16384, v171
    v_xor_b32 v172, 8192, v172
    v_and_b32 v166, 7, v1
    v_lshlrev_b32 v166, 11, v166
    s_waitcnt lgkmcnt(0)
    s_barrier
    ds_read_b32 v167, v166 offset:256
    ds_read_b32 v169, v172
    ds_read_b128 v[104:107], v171 offset:0
    ds_read_b128 v[108:111], v171 offset:1024
    ds_read_b128 v[112:115], v171 offset:2048
    ds_read_b128 v[116:119], v171 offset:3072
    s_waitcnt lgkmcnt(0)
    v_cmp_ne_u32 vcc, 0, v167
    s_cmp_lg_u32 s20, 0
    s_cbranch_scc1 AT_store
    s_cmp_eq_u64 vcc, 0
    s_cbranch_scc1 AT_store
    s_mov_b32 s20, 1
    s_mov_b32 s18, 0
    v_mov_b32 v166, 0xff800000
    v_mov_b32 v167, 0xff800000
AT_maxloop:
    buffer_load_dwordx4 v[136:139], v165, s[12:15], s18 offen sc1
    buffer_load_dwordx4 v[140:143], v165, s[12:15], s18 offen offset:1024 sc1
    s_waitcnt vmcnt(0)
    v_mfma_f32_32x32x16_bf16 v[56:71], v[136:139], v[8:11], 0
    v_mfma_f32_32x32x16_bf16 v[56:71], v[140:143], v[12:15], v[56:71]
    v_mfma_f32_32x32x16_bf16 v[72:87], v[136:139], v[16:19], 0
    v_mfma_f32_32x32x16_bf16 v[72:87], v[140:143], v[20:23], v[72:87]
    s_nop 9
    v_max3_f32 v166, v56, v57, v166
    v_max3_f32 v166, v58, v59, v166
    v_max3_f32 v166, v60, v61, v166
    v_max3_f32 v166, v62, v63, v166
    v_max3_f32 v166, v64, v65, v166
    v_max3_f32 v166, v66, v67, v166
    v_max3_f32 v166, v68, v69, v166
    v_max3_f32 v166, v70, v71, v166
    v_max3_f32 v167, v72, v73, v167
    v_max3_f32 v167, v74, v75, v167
    v_max3_f32 v167, v76, v77, v167
    v_max3_f32 v167, v78, v79, v167
    v_max3_f32 v167, v80, v81, v167
    v_max3_f32 v167, v82, v83, v167
    v_max3_f32 v167, v84, v85, v167
    v_max3_f32 v167, v86, v87, v167
    s_add_u32 s18, s18, 2048
    s_cmp_lt_u32 s18, 131072
    s_cbranch_scc1 AT_maxloop
    v_mov_b32 v170, v166
    s_nop 1
    v_permlane32_swap_b32 v170, v166
    v_max_f32 v166, v166, v170
    v_sub_f32 v24, 0, v166
    v_mov_b32 v25, v24
    v_mov_b32 v26, v24
    v_mov_b32 v27, v24
    v_mov_b32 v28, v24
    v_mov_b32 v29, v24
    v_mov_b32 v30, v24
    v_mov_b32 v31, v24
    v_mov_b32 v32, v24
    v_mov_b32 v33, v24
    v_mov_b32 v34, v24
    v_mov_b32 v35, v24
    v_mov_b32 v36, v24
    v_mov_b32 v37, v24
    v_mov_b32 v38, v24
    v_mov_b32 v39, v24
    v_mov_b32 v170, v167
    s_nop 1
    v_permlane32_swap_b32 v170, v167
    v_max_f32 v167, v167, v170
    v_sub_f32 v40, 0, v167
    v_mov_b32 v41, v40
    v_mov_b32 v42, v40
    v_mov_b32 v43, v40
    v_mov_b32 v44, v40
    v_mov_b32 v45, v40
    v_mov_b32 v46, v40
    v_mov_b32 v47, v40
    v_mov_b32 v48, v40
    v_mov_b32 v49, v40
    v_mov_b32 v50, v40
    v_mov_b32 v51, v40
    v_mov_b32 v52, v40
    v_mov_b32 v53, v40
    v_mov_b32 v54, v40
    v_mov_b32 v55, v40
    s_barrier
    s_branch AT_restart
AT_store:
    v_add_f32 v168, v168, v169
    v_rcp_f32 v168, v168
    v_and_b32 v166, 15, v1
    v_lshlrev_b32 v166, 4, v166
    v_lshrrev_b32 v167, 5, v1
    v_lshl_add_u32 v166, v167, 8, v166
    v_bfe_u32 v167, v1, 4, 1
    v_lshl_add_u32 v166, v167, 15, v166
    v_add_f32 v88, v88, v104
    v_add_f32 v89, v89, v105
    v_add_f32 v90, v90, v106
    v_add_f32 v91, v91, v107
    v_add_f32 v92, v92, v108
    v_add_f32 v93, v93, v109
    v_add_f32 v94, v94, v110
    v_add_f32 v95, v95, v111
    v_add_f32 v96, v96, v112
    v_add_f32 v97, v97, v113
    v_add_f32 v98, v98, v114
    v_add_f32 v99, v99, v115
    v_add_f32 v100, v100, v116
    v_add_f32 v101, v101, v117
    v_add_f32 v102, v102, v118
    v_add_f32 v103, v103, v119
    v_mul_f32 v88, v88, v168
    v_mul_f32 v89, v89, v168
    v_mul_f32 v90, v90, v168
    v_mul_f32 v91, v91, v168
    v_mul_f32 v92, v92, v168
    v_mul_f32 v93, v93, v168
    v_mul_f32 v94, v94, v168
    v_mul_f32 v95, v95, v168
    v_mul_f32 v96, v96, v168
    v_mul_f32 v97, v97, v168
    v_mul_f32 v98, v98, v168
    v_mul_f32 v99, v99, v168
    v_mul_f32 v100, v100, v168
    v_mul_f32 v101, v101, v168
    v_mul_f32 v102, v102, v168
    v_mul_f32 v103, v103, v168
    v_cvt_pk_bf16_f32 v120, v88, v89
    v_cvt_pk_bf16_f32 v121, v90, v91
    v_cvt_pk_bf16_f32 v122, v92, v93
    v_cvt_pk_bf16_f32 v123, v94, v95
    v_cvt_pk_bf16_f32 v124, v96, v97
    v_cvt_pk_bf16_f32 v125, v98, v99
    v_cvt_pk_bf16_f32 v126, v100, v101
    v_cvt_pk_bf16_f32 v127, v102, v103
    s_add_u32 m0, s46, 98304
    s_nop 0
    buffer_load_dwordx4 v165, s[32:35], s45 offen sc1 lds
    buffer_load_dwordx4 v165, s[32:35], s45 offen offset:1024 sc1 lds
    s_add_u32 s45, s45, 2048
    s_add_u32 m0, s46, 100352
    s_nop 0
    buffer_load_dwordx4 v7, s[36:39], s44 offen lds
    s_add_u32 m0, s46, 101376
    s_nop 0
    buffer_load_dwordx4 v7, s[40:43], s44 offen lds
    s_add_u32 s44, s44, 131072
    buffer_store_dwordx4 v[120:123], v166, s[8:11], s25 offen offset:0 sc1
    buffer_store_dwordx4 v[124:127], v166, s[8:11], s25 offen offset:512 sc1
    buffer_load_dwordx2 v[112:113], v246, s[72:75], s3 offen
    v_mov_b32 v56, 0
    v_mov_b32 v57, 0
    v_mov_b32 v58, 0
    v_mov_b32 v59, 0
    v_mov_b32 v60, 0
    v_mov_b32 v61, 0
    v_mov_b32 v62, 0
    v_mov_b32 v63, 0
    v_mov_b32 v64, 0
    v_mov_b32 v65, 0
    v_mov_b32 v66, 0
    v_mov_b32 v67, 0
    v_mov_b32 v68, 0
    v_mov_b32 v69, 0
    v_mov_b32 v70, 0
    v_mov_b32 v71, 0
    ds_read_b128 v[8:11], v232 offset:0
    ds_read_b64_tr_b16 v[24:25], v234 offset:0
    ds_read_b64_tr_b16 v[26:27], v234 offset:8192
    ds_read_b128 v[12:15], v232 offset:4096
    ds_read_b128 v[16:19], v232 offset:8192
    ds_read_b128 v[20:23], v232 offset:12288
    ds_read_b64_tr_b16 v[28:29], v234 offset:1024
    ds_read_b64_tr_b16 v[30:31], v234 offset:9216
    s_waitcnt lgkmcnt(0)
    v_mfma_f32_16x16x32_bf16 v[176:179], v[24:27], v[8:11], v[176:179]
    ds_read_b128 v[32:35], v232 offset:1024
    v_mfma_f32_16x16x32_bf16 v[180:183], v[24:27], v[12:15], v[180:183]
    ds_read_b64_tr_b16 v[48:49], v234 offset:16384
    v_mfma_f32_16x16x32_bf16 v[184:187], v[24:27], v[16:19], v[184:187]
    ds_read_b64_tr_b16 v[50:51], v234 offset:24576
    v_mfma_f32_16x16x32_bf16 v[188:191], v[24:27], v[20:23], v[188:191]
    ds_read_b128 v[36:39], v232 offset:5120
    v_mfma_f32_16x16x32_bf16 v[204:207], v[28:31], v[20:23], v[204:207]
    ds_read_b128 v[40:43], v232 offset:9216
    v_mfma_f32_16x16x32_bf16 v[200:203], v[28:31], v[16:19], v[200:203]
    ds_read_b128 v[44:47], v232 offset:13312
    v_mfma_f32_16x16x32_bf16 v[196:199], v[28:31], v[12:15], v[196:199]
    ds_read_b64_tr_b16 v[52:53], v234 offset:17408
    v_mfma_f32_16x16x32_bf16 v[192:195], v[28:31], v[8:11], v[192:195]
    ds_read_b64_tr_b16 v[54:55], v234 offset:25600
    s_waitcnt lgkmcnt(0)
    v_mfma_f32_16x16x32_bf16 v[176:179], v[48:51], v[32:35], v[176:179]
    s_barrier
    v_mfma_f32_16x16x32_bf16 v[180:183], v[48:51], v[36:39], v[180:183]
    ds_read_b128 v[8:11], v232 offset:32768
    ds_read_b64_tr_b16 v[24:25], v234 offset:32768
    ds_read_b64_tr_b16 v[26:27], v234 offset:40960
    v_mfma_f32_16x16x32_bf16 v[184:187], v[48:51], v[40:43], v[184:187]
    ds_read_b128 v[12:15], v232 offset:36864
    ds_read_b128 v[16:19], v232 offset:40960
    v_mfma_f32_16x16x32_bf16 v[188:191], v[48:51], v[44:47], v[188:191]
    ds_read_b128 v[20:23], v232 offset:45056
    ds_read_b64_tr_b16 v[28:29], v234 offset:33792
    v_mfma_f32_16x16x32_bf16 v[204:207], v[52:55], v[44:47], v[204:207]
    ds_read_b64_tr_b16 v[30:31], v234 offset:41984
    s_add_u32 m0, s46, 131072
    s_nop 0
    buffer_load_dwordx4 v165, s[32:35], s45 offen sc1 lds
    buffer_load_dwordx4 v165, s[32:35], s45 offen offset:1024 sc1 lds
    s_add_u32 s45, s45, 2048
    v_mfma_f32_16x16x32_bf16 v[200:203], v[52:55], v[40:43], v[200:203]
    s_add_u32 m0, s46, 133120
    s_nop 0
    buffer_load_dwordx4 v7, s[36:39], s44 offen lds
    s_add_u32 m0, s46, 134144
    s_nop 0
    buffer_load_dwordx4 v7, s[40:43], s44 offen lds
    s_add_u32 s44, s44, 131072
    v_mfma_f32_16x16x32_bf16 v[196:199], v[52:55], v[36:39], v[196:199]
    s_add_u32 m0, s46, 32768
    s_nop 0
    buffer_load_dwordx4 v165, s[32:35], s45 offen sc1 lds
    buffer_load_dwordx4 v165, s[32:35], s45 offen offset:1024 sc1 lds
    s_add_u32 s45, s45, 2048
    v_mfma_f32_16x16x32_bf16 v[192:195], v[52:55], v[32:35], v[192:195]
    s_add_u32 m0, s46, 34816
    s_nop 0
    buffer_load_dwordx4 v7, s[36:39], s44 offen lds
    s_add_u32 m0, s46, 35840
    s_nop 0
    buffer_load_dwordx4 v7, s[40:43], s44 offen lds
    s_add_u32 s44, s44, 131072
    s_waitcnt lgkmcnt(0)
    v_mfma_f32_16x16x32_bf16 v[176:179], v[24:27], v[8:11], v[176:179]
    ds_read_b128 v[32:35], v232 offset:33792
    v_mfma_f32_16x16x32_bf16 v[180:183], v[24:27], v[12:15], v[180:183]
    ds_read_b64_tr_b16 v[48:49], v234 offset:49152
    v_mfma_f32_16x16x32_bf16 v[184:187], v[24:27], v[16:19], v[184:187]
    ds_read_b64_tr_b16 v[50:51], v234 offset:57344
    v_mfma_f32_16x16x32_bf16 v[188:191], v[24:27], v[20:23], v[188:191]
    ds_read_b128 v[36:39], v232 offset:37888
    v_mfma_f32_16x16x32_bf16 v[204:207], v[28:31], v[20:23], v[204:207]
    ds_read_b128 v[40:43], v232 offset:41984
    v_mfma_f32_16x16x32_bf16 v[200:203], v[28:31], v[16:19], v[200:203]
    ds_read_b128 v[44:47], v232 offset:46080
    v_mfma_f32_16x16x32_bf16 v[196:199], v[28:31], v[12:15], v[196:199]
    ds_read_b64_tr_b16 v[52:53], v234 offset:50176
    v_mfma_f32_16x16x32_bf16 v[192:195], v[28:31], v[8:11], v[192:195]
    ds_read_b64_tr_b16 v[54:55], v234 offset:58368
    s_waitcnt lgkmcnt(0)
    v_mfma_f32_16x16x32_bf16 v[176:179], v[48:51], v[32:35], v[176:179]
    s_waitcnt vmcnt(9)
    s_barrier
    s_cmp_lg_u32 s16, 0
    s_cbranch_scc1 P3_w1
    s_mov_b64 exec, 1
    v_mov_b32 v2, 1
    buffer_atomic_add v2, v175, s[60:63], s6 offen
    s_mov_b64 exec, -1
P3_w1:
    v_mfma_f32_16x16x32_bf16 v[180:183], v[48:51], v[36:39], v[180:183]
    ds_read_b128 v[8:11], v233 offset:0
    ds_read_b64_tr_b16 v[24:25], v235 offset:0
    v_mfma_f32_16x16x32_bf16 v[184:187], v[48:51], v[40:43], v[184:187]
    ds_read_b64_tr_b16 v[26:27], v235 offset:8192
    ds_read_b128 v[12:15], v233 offset:4096
    v_mfma_f32_16x16x32_bf16 v[188:191], v[48:51], v[44:47], v[188:191]
    ds_read_b128 v[16:19], v233 offset:8192
    ds_read_b128 v[20:23], v233 offset:12288
    v_mfma_f32_16x16x32_bf16 v[204:207], v[52:55], v[44:47], v[204:207]
    ds_read_b64_tr_b16 v[28:29], v235 offset:1024
    ds_read_b64_tr_b16 v[30:31], v235 offset:9216
    v_mfma_f32_16x16x32_bf16 v[200:203], v[52:55], v[40:43], v[200:203]
    s_add_u32 m0, s46, 65536
    s_nop 0
    buffer_load_dwordx4 v165, s[32:35], s45 offen sc1 lds
    buffer_load_dwordx4 v165, s[32:35], s45 offen offset:1024 sc1 lds
    s_add_u32 s45, s45, 2048
    v_mfma_f32_16x16x32_bf16 v[196:199], v[52:55], v[36:39], v[196:199]
    s_add_u32 m0, s46, 67584
    s_nop 0
    buffer_load_dwordx4 v7, s[36:39], s44 offen lds
    s_add_u32 m0, s46, 68608
    s_nop 0
    buffer_load_dwordx4 v7, s[40:43], s44 offen lds
    s_add_u32 s44, s44, 131072
    v_mfma_f32_16x16x32_bf16 v[192:195], v[52:55], v[32:35], v[192:195]
    s_mov_b32 m0, s17
    s_nop 0
    buffer_load_dwordx4 v245, s[64:67], s4 offen lds
    s_add_u32 s4, s4, 15360
    buffer_load_dwordx4 v245, s[64:67], s4 offen offset:1024 lds
    s_waitcnt lgkmcnt(0)
    v_mfma_f32_16x16x32_bf16 v[176:179], v[24:27], v[8:11], v[176:179]
    ds_read_b128 v[32:35], v233 offset:1024
    v_mfma_f32_16x16x32_bf16 v[180:183], v[24:27], v[12:15], v[180:183]
    ds_read_b64_tr_b16 v[48:49], v235 offset:16384
    v_mfma_f32_16x16x32_bf16 v[184:187], v[24:27], v[16:19], v[184:187]
    ds_read_b64_tr_b16 v[50:51], v235 offset:24576
    v_mfma_f32_16x16x32_bf16 v[188:191], v[24:27], v[20:23], v[188:191]
    ds_read_b128 v[36:39], v233 offset:5120
    v_mfma_f32_16x16x32_bf16 v[204:207], v[28:31], v[20:23], v[204:207]
    ds_read_b128 v[40:43], v233 offset:9216
    v_mfma_f32_16x16x32_bf16 v[200:203], v[28:31], v[16:19], v[200:203]
    ds_read_b128 v[44:47], v233 offset:13312
    v_mfma_f32_16x16x32_bf16 v[196:199], v[28:31], v[12:15], v[196:199]
    ds_read_b64_tr_b16 v[52:53], v235 offset:17408
    v_mfma_f32_16x16x32_bf16 v[192:195], v[28:31], v[8:11], v[192:195]
    ds_read_b64_tr_b16 v[54:55], v235 offset:25600
    s_waitcnt lgkmcnt(0)
    v_mfma_f32_16x16x32_bf16 v[176:179], v[48:51], v[32:35], v[176:179]
    s_waitcnt vmcnt(10)
    s_barrier
    v_mfma_f32_16x16x32_bf16 v[180:183], v[48:51], v[36:39], v[180:183]
    ds_read_b128 v[8:11], v233 offset:32768
    ds_read_b64_tr_b16 v[24:25], v235 offset:32768
    v_mfma_f32_16x16x32_bf16 v[184:187], v[48:51], v[40:43], v[184:187]
    ds_read_b64_tr_b16 v[26:27], v235 offset:40960
    ds_read_b128 v[12:15], v233 offset:36864
    v_mfma_f32_16x16x32_bf16 v[188:191], v[48:51], v[44:47], v[188:191]
    ds_read_b128 v[16:19], v233 offset:40960
    ds_read_b128 v[20:23], v233 offset:45056
    v_mfma_f32_16x16x32_bf16 v[204:207], v[52:55], v[44:47], v[204:207]
    ds_read_b64_tr_b16 v[28:29], v235 offset:33792
    v_mfma_f32_16x16x32_bf16 v[200:203], v[52:55], v[40:43], v[200:203]
    ds_read_b64_tr_b16 v[30:31], v235 offset:41984
    s_add_u32 m0, s46, 98304
    s_nop 0
    buffer_load_dwordx4 v165, s[32:35], s45 offen sc1 lds
    v_mfma_f32_16x16x32_bf16 v[196:199], v[52:55], v[36:39], v[196:199]
    buffer_load_dwordx4 v165, s[32:35], s45 offen offset:1024 sc1 lds
    s_add_u32 s45, s45, 2048
    s_add_u32 m0, s46, 100352
    s_nop 0
    buffer_load_dwordx4 v7, s[36:39], s44 offen lds
    v_mfma_f32_16x16x32_bf16 v[192:195], v[52:55], v[32:35], v[192:195]
    s_add_u32 m0, s46, 101376
    s_nop 0
    buffer_load_dwordx4 v7, s[40:43], s44 offen lds
    s_add_u32 s44, s44, 131072
    s_waitcnt lgkmcnt(0)
    v_mfma_f32_16x16x32_bf16 v[176:179], v[24:27], v[8:11], v[176:179]
    ds_read_b128 v[32:35], v233 offset:33792
    v_mfma_f32_16x16x32_bf16 v[180:183], v[24:27], v[12:15], v[180:183]
    ds_read_b64_tr_b16 v[48:49], v235 offset:49152
    v_mfma_f32_16x16x32_bf16 v[184:187], v[24:27], v[16:19], v[184:187]
    ds_read_b64_tr_b16 v[50:51], v235 offset:57344
    v_mfma_f32_16x16x32_bf16 v[188:191], v[24:27], v[20:23], v[188:191]
    ds_read_b128 v[36:39], v233 offset:37888
    v_mfma_f32_16x16x32_bf16 v[204:207], v[28:31], v[20:23], v[204:207]
    ds_read_b128 v[40:43], v233 offset:41984
    v_mfma_f32_16x16x32_bf16 v[200:203], v[28:31], v[16:19], v[200:203]
    ds_read_b128 v[44:47], v233 offset:46080
    v_mfma_f32_16x16x32_bf16 v[196:199], v[28:31], v[12:15], v[196:199]
    ds_read_b64_tr_b16 v[52:53], v235 offset:50176
    v_mfma_f32_16x16x32_bf16 v[192:195], v[28:31], v[8:11], v[192:195]
    ds_read_b64_tr_b16 v[54:55], v235 offset:58368
    s_waitcnt lgkmcnt(0)
    v_mfma_f32_16x16x32_bf16 v[176:179], v[48:51], v[32:35], v[176:179]
    s_waitcnt vmcnt(10)
    s_barrier
    v_mfma_f32_16x16x32_bf16 v[180:183], v[48:51], v[36:39], v[180:183]
    ds_read_b128 v[8:11], v232 offset:0
    ds_read_b64_tr_b16 v[24:25], v234 offset:0
    v_mfma_f32_16x16x32_bf16 v[184:187], v[48:51], v[40:43], v[184:187]
    ds_read_b64_tr_b16 v[26:27], v234 offset:8192
    ds_read_b128 v[12:15], v232 offset:4096
    v_mfma_f32_16x16x32_bf16 v[188:191], v[48:51], v[44:47], v[188:191]
    ds_read_b128 v[16:19], v232 offset:8192
    ds_read_b128 v[20:23], v232 offset:12288
    v_mfma_f32_16x16x32_bf16 v[204:207], v[52:55], v[44:47], v[204:207]
    ds_read_b64_tr_b16 v[28:29], v234 offset:1024
    v_mfma_f32_16x16x32_bf16 v[200:203], v[52:55], v[40:43], v[200:203]
    ds_read_b64_tr_b16 v[30:31], v234 offset:9216
    s_add_u32 m0, s46, 131072
    s_nop 0
    buffer_load_dwordx4 v165, s[32:35], s45 offen sc1 lds
    v_mfma_f32_16x16x32_bf16 v[196:199], v[52:55], v[36:39], v[196:199]
    buffer_load_dwordx4 v165, s[32:35], s45 offen offset:1024 sc1 lds
    s_add_u32 s45, s45, 2048
    s_add_u32 m0, s46, 133120
    s_nop 0
    buffer_load_dwordx4 v7, s[36:39], s44 offen lds
    v_mfma_f32_16x16x32_bf16 v[192:195], v[52:55], v[32:35], v[192:195]
    s_add_u32 m0, s46, 134144
    s_nop 0
    buffer_load_dwordx4 v7, s[40:43], s44 offen lds
    s_add_u32 s44, s44, 131072
    s_waitcnt lgkmcnt(0)
    v_mfma_f32_16x16x32_bf16 v[176:179], v[24:27], v[8:11], v[176:179]
    ds_read_b128 v[32:35], v232 offset:1024
    v_mfma_f32_16x16x32_bf16 v[180:183], v[24:27], v[12:15], v[180:183]
    ds_read_b64_tr_b16 v[48:49], v234 offset:16384
    v_mfma_f32_16x16x32_bf16 v[184:187], v[24:27], v[16:19], v[184:187]
    ds_read_b64_tr_b16 v[50:51], v234 offset:24576
    v_mfma_f32_16x16x32_bf16 v[188:191], v[24:27], v[20:23], v[188:191]
    ds_read_b128 v[36:39], v232 offset:5120
    v_mfma_f32_16x16x32_bf16 v[204:207], v[28:31], v[20:23], v[204:207]
    ds_read_b128 v[40:43], v232 offset:9216
    v_mfma_f32_16x16x32_bf16 v[200:203], v[28:31], v[16:19], v[200:203]
    ds_read_b128 v[44:47], v232 offset:13312
    v_mfma_f32_16x16x32_bf16 v[196:199], v[28:31], v[12:15], v[196:199]
    ds_read_b64_tr_b16 v[52:53], v234 offset:17408
    v_mfma_f32_16x16x32_bf16 v[192:195], v[28:31], v[8:11], v[192:195]
    ds_read_b64_tr_b16 v[54:55], v234 offset:25600
    s_waitcnt lgkmcnt(0)
    v_mfma_f32_16x16x32_bf16 v[176:179], v[48:51], v[32:35], v[176:179]
    s_waitcnt vmcnt(10)
    s_barrier
    v_mfma_f32_16x16x32_bf16 v[180:183], v[48:51], v[36:39], v[180:183]
    ds_read_b128 v[8:11], v232 offset:32768
    ds_read_b64_tr_b16 v[24:25], v234 offset:32768
    v_mfma_f32_16x16x32_bf16 v[184:187], v[48:51], v[40:43], v[184:187]
    ds_read_b64_tr_b16 v[26:27], v234 offset:40960
    ds_read_b128 v[12:15], v232 offset:36864
    v_mfma_f32_16x16x32_bf16 v[188:191], v[48:51], v[44:47], v[188:191]
    ds_read_b128 v[16:19], v232 offset:40960
    ds_read_b128 v[20:23], v232 offset:45056
    v_mfma_f32_16x16x32_bf16 v[204:207], v[52:55], v[44:47], v[204:207]
    ds_read_b64_tr_b16 v[28:29], v234 offset:33792
    v_mfma_f32_16x16x32_bf16 v[200:203], v[52:55], v[40:43], v[200:203]
    ds_read_b64_tr_b16 v[30:31], v234 offset:41984
    s_add_u32 m0, s46, 32768
    s_nop 0
    buffer_load_dwordx4 v165, s[32:35], s45 offen sc1 lds
    v_mfma_f32_16x16x32_bf16 v[196:199], v[52:55], v[36:39], v[196:199]
    buffer_load_dwordx4 v165, s[32:35], s45 offen offset:1024 sc1 lds
    s_add_u32 s45, s45, 2048
    s_add_u32 m0, s46, 34816
    s_nop 0
    buffer_load_dwordx4 v7, s[36:39], s44 offen lds
    v_mfma_f32_16x16x32_bf16 v[192:195], v[52:55], v[32:35], v[192:195]
    s_add_u32 m0, s46, 35840
    s_nop 0
    buffer_load_dwordx4 v7, s[40:43], s44 offen lds
    s_add_u32 s44, s44, 131072
    s_waitcnt lgkmcnt(0)
    v_mfma_f32_16x16x32_bf16 v[176:179], v[24:27], v[8:11], v[176:179]
    ds_read_b128 v[32:35], v232 offset:33792
    v_mfma_f32_16x16x32_bf16 v[180:183], v[24:27], v[12:15], v[180:183]
    ds_read_b64_tr_b16 v[48:49], v234 offset:49152
    v_mfma_f32_16x16x32_bf16 v[184:187], v[24:27], v[16:19], v[184:187]
    ds_read_b64_tr_b16 v[50:51], v234 offset:57344
    v_mfma_f32_16x16x32_bf16 v[188:191], v[24:27], v[20:23], v[188:191]
    ds_read_b128 v[36:39], v232 offset:37888
    v_mfma_f32_16x16x32_bf16 v[204:207], v[28:31], v[20:23], v[204:207]
    ds_read_b128 v[40:43], v232 offset:41984
    v_mfma_f32_16x16x32_bf16 v[200:203], v[28:31], v[16:19], v[200:203]
    ds_read_b128 v[44:47], v232 offset:46080
    v_mfma_f32_16x16x32_bf16 v[196:199], v[28:31], v[12:15], v[196:199]
    ds_read_b64_tr_b16 v[52:53], v234 offset:50176
    v_mfma_f32_16x16x32_bf16 v[192:195], v[28:31], v[8:11], v[192:195]
    ds_read_b64_tr_b16 v[54:55], v234 offset:58368
    s_waitcnt lgkmcnt(0)
    v_mfma_f32_16x16x32_bf16 v[176:179], v[48:51], v[32:35], v[176:179]
    s_waitcnt vmcnt(8)
    s_barrier
    s_cmp_lg_u32 s16, 0
    s_cbranch_scc1 P3_w2
    buffer_load_dword v174, v175, s[60:63], s47 offen sc1
P3_w2:
    v_mfma_f32_16x16x32_bf16 v[180:183], v[48:51], v[36:39], v[180:183]
    ds_read_b128 v[8:11], v233 offset:0
    ds_read_b64_tr_b16 v[24:25], v235 offset:0
    v_mfma_f32_16x16x32_bf16 v[184:187], v[48:51], v[40:43], v[184:187]
    ds_read_b64_tr_b16 v[26:27], v235 offset:8192
    ds_read_b128 v[12:15], v233 offset:4096
    v_mfma_f32_16x16x32_bf16 v[188:191], v[48:51], v[44:47], v[188:191]
    ds_read_b128 v[16:19], v233 offset:8192
    ds_read_b128 v[20:23], v233 offset:12288
    v_mfma_f32_16x16x32_bf16 v[204:207], v[52:55], v[44:47], v[204:207]
    ds_read_b64_tr_b16 v[28:29], v235 offset:1024
    v_mfma_f32_16x16x32_bf16 v[200:203], v[52:55], v[40:43], v[200:203]
    ds_read_b64_tr_b16 v[30:31], v235 offset:9216
    s_add_u32 m0, s46, 65536
    s_nop 0
    buffer_load_dwordx4 v165, s[32:35], s45 offen sc1 lds
    v_mfma_f32_16x16x32_bf16 v[196:199], v[52:55], v[36:39], v[196:199]
    buffer_load_dwordx4 v165, s[32:35], s45 offen offset:1024 sc1 lds
    s_add_u32 s45, s45, 2048
    s_add_u32 m0, s46, 67584
    s_nop 0
    buffer_load_dwordx4 v7, s[36:39], s44 offen lds
    v_mfma_f32_16x16x32_bf16 v[192:195], v[52:55], v[32:35], v[192:195]
    s_add_u32 m0, s46, 68608
    s_nop 0
    buffer_load_dwordx4 v7, s[40:43], s44 offen lds
    s_add_u32 s44, s44, 131072
    s_waitcnt lgkmcnt(0)
    v_mfma_f32_16x16x32_bf16 v[176:179], v[24:27], v[8:11], v[176:179]
    ds_read_b128 v[32:35], v233 offset:1024
    v_mfma_f32_16x16x32_bf16 v[180:183], v[24:27], v[12:15], v[180:183]
    ds_read_b64_tr_b16 v[48:49], v235 offset:16384
    v_mfma_f32_16x16x32_bf16 v[184:187], v[24:27], v[16:19], v[184:187]
    ds_read_b64_tr_b16 v[50:51], v235 offset:24576
    v_mfma_f32_16x16x32_bf16 v[188:191], v[24:27], v[20:23], v[188:191]
    ds_read_b128 v[36:39], v233 offset:5120
    v_mfma_f32_16x16x32_bf16 v[204:207], v[28:31], v[20:23], v[204:207]
    ds_read_b128 v[40:43], v233 offset:9216
    v_mfma_f32_16x16x32_bf16 v[200:203], v[28:31], v[16:19], v[200:203]
    ds_read_b128 v[44:47], v233 offset:13312
    v_mfma_f32_16x16x32_bf16 v[196:199], v[28:31], v[12:15], v[196:199]
    ds_read_b64_tr_b16 v[52:53], v235 offset:17408
    v_mfma_f32_16x16x32_bf16 v[192:195], v[28:31], v[8:11], v[192:195]
    ds_read_b64_tr_b16 v[54:55], v235 offset:25600
    s_waitcnt lgkmcnt(0)
    v_mfma_f32_16x16x32_bf16 v[176:179], v[48:51], v[32:35], v[176:179]
    s_waitcnt vmcnt(8)
    s_barrier
    v_mfma_f32_16x16x32_bf16 v[180:183], v[48:51], v[36:39], v[180:183]
    ds_read_b128 v[8:11], v233 offset:32768
    ds_read_b64_tr_b16 v[24:25], v235 offset:32768
    v_mfma_f32_16x16x32_bf16 v[184:187], v[48:51], v[40:43], v[184:187]
    ds_read_b64_tr_b16 v[26:27], v235 offset:40960
    ds_read_b128 v[12:15], v233 offset:36864
    v_mfma_f32_16x16x32_bf16 v[188:191], v[48:51], v[44:47], v[188:191]
    ds_read_b128 v[16:19], v233 offset:40960
    ds_read_b128 v[20:23], v233 offset:45056
    v_mfma_f32_16x16x32_bf16 v[204:207], v[52:55], v[44:47], v[204:207]
    ds_read_b64_tr_b16 v[28:29], v235 offset:33792
    v_mfma_f32_16x16x32_bf16 v[200:203], v[52:55], v[40:43], v[200:203]
    ds_read_b64_tr_b16 v[30:31], v235 offset:41984
    s_add_u32 m0, s46, 98304
    s_nop 0
    buffer_load_dwordx4 v165, s[32:35], s45 offen sc1 lds
    v_mfma_f32_16x16x32_bf16 v[196:199], v[52:55], v[36:39], v[196:199]
    buffer_load_dwordx4 v165, s[32:35], s45 offen offset:1024 sc1 lds
    s_add_u32 s45, s45, 2048
    s_add_u32 m0, s46, 100352
    s_nop 0
    buffer_load_dwordx4 v7, s[36:39], s44 offen lds
    v_mfma_f32_16x16x32_bf16 v[192:195], v[52:55], v[32:35], v[192:195]
    s_add_u32 m0, s46, 101376
    s_nop 0
    buffer_load_dwordx4 v7, s[40:43], s44 offen lds
    s_add_u32 s44, s44, 131072
    s_waitcnt lgkmcnt(0)
    v_mfma_f32_16x16x32_bf16 v[176:179], v[24:27], v[8:11], v[176:179]
    ds_read_b128 v[32:35], v233 offset:33792
    v_mfma_f32_16x16x32_bf16 v[180:183], v[24:27], v[12:15], v[180:183]
    ds_read_b64_tr_b16 v[48:49], v235 offset:49152
    v_mfma_f32_16x16x32_bf16 v[184:187], v[24:27], v[16:19], v[184:187]
    ds_read_b64_tr_b16 v[50:51], v235 offset:57344
    v_mfma_f32_16x16x32_bf16 v[188:191], v[24:27], v[20:23], v[188:191]
    ds_read_b128 v[36:39], v233 offset:37888
    v_mfma_f32_16x16x32_bf16 v[204:207], v[28:31], v[20:23], v[204:207]
    ds_read_b128 v[40:43], v233 offset:41984
    v_mfma_f32_16x16x32_bf16 v[200:203], v[28:31], v[16:19], v[200:203]
    ds_read_b128 v[44:47], v233 offset:46080
    v_mfma_f32_16x16x32_bf16 v[196:199], v[28:31], v[12:15], v[196:199]
    ds_read_b64_tr_b16 v[52:53], v235 offset:50176
    v_mfma_f32_16x16x32_bf16 v[192:195], v[28:31], v[8:11], v[192:195]
    ds_read_b64_tr_b16 v[54:55], v235 offset:58368
    s_waitcnt lgkmcnt(0)
    v_mfma_f32_16x16x32_bf16 v[176:179], v[48:51], v[32:35], v[176:179]
    s_waitcnt vmcnt(8)
    s_cmp_lg_u32 s16, 0
    s_cbranch_scc1 P3_w3
    s_waitcnt vmcnt(8)
P3_o_chk:
    v_readfirstlane_b32 s23, v174
    s_nop 0
    s_cmp_ge_u32 s23, 16
    s_cbranch_scc1 P3_o_ok
    s_sleep 4
    buffer_load_dword v174, v175, s[60:63], s47 offen sc1
    s_waitcnt vmcnt(0)
    s_branch P3_o_chk
P3_o_ok:
P3_w3:
    s_barrier
    v_mfma_f32_16x16x32_bf16 v[180:183], v[48:51], v[36:39], v[180:183]
    ds_read_b128 v[8:11], v232 offset:0
    ds_read_b64_tr_b16 v[24:25], v234 offset:0
    v_mfma_f32_16x16x32_bf16 v[184:187], v[48:51], v[40:43], v[184:187]
    ds_read_b64_tr_b16 v[26:27], v234 offset:8192
    ds_read_b128 v[12:15], v232 offset:4096
    v_mfma_f32_16x16x32_bf16 v[188:191], v[48:51], v[44:47], v[188:191]
    ds_read_b128 v[16:19], v232 offset:8192
    ds_read_b128 v[20:23], v232 offset:12288
    v_mfma_f32_16x16x32_bf16 v[204:207], v[52:55], v[44:47], v[204:207]
    ds_read_b64_tr_b16 v[28:29], v234 offset:1024
    v_mfma_f32_16x16x32_bf16 v[200:203], v[52:55], v[40:43], v[200:203]
    ds_read_b64_tr_b16 v[30:31], v234 offset:9216
    s_add_u32 m0, s46, 131072
    s_nop 0
    buffer_load_dwordx4 v165, s[32:35], s45 offen sc1 lds
    v_mfma_f32_16x16x32_bf16 v[196:199], v[52:55], v[36:39], v[196:199]
    buffer_load_dwordx4 v165, s[32:35], s45 offen offset:1024 sc1 lds
    s_add_u32 s45, s45, 2048
    s_add_u32 m0, s46, 133120
    s_nop 0
    buffer_load_dwordx4 v7, s[36:39], s44 offen lds
    v_mfma_f32_16x16x32_bf16 v[192:195], v[52:55], v[32:35], v[192:195]
    s_add_u32 m0, s46, 134144
    s_nop 0
    buffer_load_dwordx4 v7, s[40:43], s44 offen lds
    s_add_u32 s44, s44, 131072
    s_waitcnt lgkmcnt(0)
    v_mfma_f32_16x16x32_bf16 v[176:179], v[24:27], v[8:11], v[176:179]
    ds_read_b128 v[32:35], v232 offset:1024
    v_mfma_f32_16x16x32_bf16 v[180:183], v[24:27], v[12:15], v[180:183]
    ds_read_b64_tr_b16 v[48:49], v234 offset:16384
    v_mfma_f32_16x16x32_bf16 v[184:187], v[24:27], v[16:19], v[184:187]
    ds_read_b64_tr_b16 v[50:51], v234 offset:24576
    v_mfma_f32_16x16x32_bf16 v[188:191], v[24:27], v[20:23], v[188:191]
    ds_read_b128 v[36:39], v232 offset:5120
    v_mfma_f32_16x16x32_bf16 v[204:207], v[28:31], v[20:23], v[204:207]
    ds_read_b128 v[40:43], v232 offset:9216
    v_mfma_f32_16x16x32_bf16 v[200:203], v[28:31], v[16:19], v[200:203]
    ds_read_b128 v[44:47], v232 offset:13312
    v_mfma_f32_16x16x32_bf16 v[196:199], v[28:31], v[12:15], v[196:199]
    ds_read_b64_tr_b16 v[52:53], v234 offset:17408
    v_mfma_f32_16x16x32_bf16 v[192:195], v[28:31], v[8:11], v[192:195]
    ds_read_b64_tr_b16 v[54:55], v234 offset:25600
    s_waitcnt lgkmcnt(0)
    v_mfma_f32_16x16x32_bf16 v[176:179], v[48:51], v[32:35], v[176:179]
    s_waitcnt vmcnt(8)
    s_barrier
    v_mfma_f32_16x16x32_bf16 v[180:183], v[48:51], v[36:39], v[180:183]
    ds_read_b128 v[8:11], v232 offset:32768
    ds_read_b64_tr_b16 v[24:25], v234 offset:32768
    v_mfma_f32_16x16x32_bf16 v[184:187], v[48:51], v[40:43], v[184:187]
    ds_read_b64_tr_b16 v[26:27], v234 offset:40960
    ds_read_b128 v[12:15], v232 offset:36864
    v_mfma_f32_16x16x32_bf16 v[188:191], v[48:51], v[44:47], v[188:191]
    ds_read_b128 v[16:19], v232 offset:40960
    v_mfma_f32_16x16x32_bf16 v[204:207], v[52:55], v[44:47], v[204:207]
    ds_read_b128 v[20:23], v232 offset:45056
    ds_read_b64_tr_b16 v[28:29], v234 offset:33792
    v_mfma_f32_16x16x32_bf16 v[200:203], v[52:55], v[40:43], v[200:203]
    ds_read_b64_tr_b16 v[30:31], v234 offset:41984
    v_mfma_f32_16x16x32_bf16 v[196:199], v[52:55], v[36:39], v[196:199]
    s_add_u32 m0, s58, 32768
    s_nop 0
    buffer_load_dwordx4 v165, s[48:51], s57 offen sc1 lds
    buffer_load_dwordx4 v165, s[48:51], s57 offen offset:1024 sc1 lds
    s_add_u32 s57, s57, 2048
    v_mfma_f32_16x16x32_bf16 v[192:195], v[52:55], v[32:35], v[192:195]
    s_add_u32 m0, s58, 34816
    s_nop 0
    buffer_load_dwordx4 v7, s[52:55], s56 offen lds
    s_add_u32 s56, s56, 131072
    s_waitcnt lgkmcnt(0)
    v_mfma_f32_16x16x32_bf16 v[176:179], v[24:27], v[8:11], v[176:179]
    ds_read_b128 v[32:35], v232 offset:33792
    v_mfma_f32_16x16x32_bf16 v[180:183], v[24:27], v[12:15], v[180:183]
    ds_read_b64_tr_b16 v[48:49], v234 offset:49152
    v_mfma_f32_16x16x32_bf16 v[184:187], v[24:27], v[16:19], v[184:187]
    ds_read_b64_tr_b16 v[50:51], v234 offset:57344
    v_mfma_f32_16x16x32_bf16 v[188:191], v[24:27], v[20:23], v[188:191]
    ds_read_b128 v[36:39], v232 offset:37888
    v_mfma_f32_16x16x32_bf16 v[204:207], v[28:31], v[20:23], v[204:207]
    ds_read_b128 v[40:43], v232 offset:41984
    v_mfma_f32_16x16x32_bf16 v[200:203], v[28:31], v[16:19], v[200:203]
    ds_read_b128 v[44:47], v232 offset:46080
    v_mfma_f32_16x16x32_bf16 v[196:199], v[28:31], v[12:15], v[196:199]
    ds_read_b64_tr_b16 v[52:53], v234 offset:50176
    v_mfma_f32_16x16x32_bf16 v[192:195], v[28:31], v[8:11], v[192:195]
    ds_read_b64_tr_b16 v[54:55], v234 offset:58368
    s_waitcnt lgkmcnt(0)
    v_mfma_f32_16x16x32_bf16 v[176:179], v[48:51], v[32:35], v[176:179]
    s_waitcnt vmcnt(7)
    s_barrier
    v_mfma_f32_16x16x32_bf16 v[180:183], v[48:51], v[36:39], v[180:183]
    ds_read_b128 v[8:11], v233 offset:0
    ds_read_b64_tr_b16 v[24:25], v235 offset:0
    v_mfma_f32_16x16x32_bf16 v[184:187], v[48:51], v[40:43], v[184:187]
    ds_read_b64_tr_b16 v[26:27], v235 offset:8192
    ds_read_b128 v[12:15], v233 offset:4096
    v_mfma_f32_16x16x32_bf16 v[188:191], v[48:51], v[44:47], v[188:191]
    ds_read_b128 v[16:19], v233 offset:8192
    v_mfma_f32_16x16x32_bf16 v[204:207], v[52:55], v[44:47], v[204:207]
    ds_read_b128 v[20:23], v233 offset:12288
    ds_read_b64_tr_b16 v[28:29], v235 offset:1024
    v_mfma_f32_16x16x32_bf16 v[200:203], v[52:55], v[40:43], v[200:203]
    ds_read_b64_tr_b16 v[30:31], v235 offset:9216
    v_mfma_f32_16x16x32_bf16 v[196:199], v[52:55], v[36:39], v[196:199]
    s_add_u32 m0, s58, 65536
    s_nop 0
    buffer_load_dwordx4 v165, s[48:51], s57 offen sc1 lds
    buffer_load_dwordx4 v165, s[48:51], s57 offen offset:1024 sc1 lds
    s_add_u32 s57, s57, 2048
    v_mfma_f32_16x16x32_bf16 v[192:195], v[52:55], v[32:35], v[192:195]
    s_add_u32 m0, s58, 67584
    s_nop 0
    buffer_load_dwordx4 v7, s[52:55], s56 offen lds
    s_add_u32 s56, s56, 131072
    s_waitcnt lgkmcnt(0)
    v_mfma_f32_16x16x32_bf16 v[176:179], v[24:27], v[8:11], v[176:179]
    ds_read_b128 v[32:35], v233 offset:1024
    v_mfma_f32_16x16x32_bf16 v[180:183], v[24:27], v[12:15], v[180:183]
    ds_read_b64_tr_b16 v[48:49], v235 offset:16384
    v_mfma_f32_16x16x32_bf16 v[184:187], v[24:27], v[16:19], v[184:187]
    ds_read_b64_tr_b16 v[50:51], v235 offset:24576
    v_mfma_f32_16x16x32_bf16 v[188:191], v[24:27], v[20:23], v[188:191]
    ds_read_b128 v[36:39], v233 offset:5120
    v_mfma_f32_16x16x32_bf16 v[204:207], v[28:31], v[20:23], v[204:207]
    ds_read_b128 v[40:43], v233 offset:9216
    v_mfma_f32_16x16x32_bf16 v[200:203], v[28:31], v[16:19], v[200:203]
    ds_read_b128 v[44:47], v233 offset:13312
    v_mfma_f32_16x16x32_bf16 v[196:199], v[28:31], v[12:15], v[196:199]
    ds_read_b64_tr_b16 v[52:53], v235 offset:17408
    v_mfma_f32_16x16x32_bf16 v[192:195], v[28:31], v[8:11], v[192:195]
    ds_read_b64_tr_b16 v[54:55], v235 offset:25600
    s_waitcnt lgkmcnt(0)
    v_mfma_f32_16x16x32_bf16 v[176:179], v[48:51], v[32:35], v[176:179]
    s_waitcnt vmcnt(6)
    s_barrier
    v_mfma_f32_16x16x32_bf16 v[180:183], v[48:51], v[36:39], v[180:183]
    ds_read_b128 v[8:11], v233 offset:32768
    ds_read_b64_tr_b16 v[24:25], v235 offset:32768
    v_mfma_f32_16x16x32_bf16 v[184:187], v[48:51], v[40:43], v[184:187]
    ds_read_b64_tr_b16 v[26:27], v235 offset:40960
    ds_read_b128 v[12:15], v233 offset:36864
    v_mfma_f32_16x16x32_bf16 v[188:191], v[48:51], v[44:47], v[188:191]
    ds_read_b128 v[16:19], v233 offset:40960
    v_mfma_f32_16x16x32_bf16 v[204:207], v[52:55], v[44:47], v[204:207]
    ds_read_b128 v[20:23], v233 offset:45056
    ds_read_b64_tr_b16 v[28:29], v235 offset:33792
    v_mfma_f32_16x16x32_bf16 v[200:203], v[52:55], v[40:43], v[200:203]
    ds_read_b64_tr_b16 v[30:31], v235 offset:41984
    v_mfma_f32_16x16x32_bf16 v[196:199], v[52:55], v[36:39], v[196:199]
    s_add_u32 m0, s58, 98304
    s_nop 0
    buffer_load_dwordx4 v165, s[48:51], s57 offen sc1 lds
    buffer_load_dwordx4 v165, s[48:51], s57 offen offset:1024 sc1 lds
    s_add_u32 s57, s57, 2048
    v_mfma_f32_16x16x32_bf16 v[192:195], v[52:55], v[32:35], v[192:195]
    s_add_u32 m0, s58, 100352
    s_nop 0
    buffer_load_dwordx4 v7, s[52:55], s56 offen lds
    s_add_u32 s56, s56, 131072
    s_waitcnt lgkmcnt(0)
    v_mfma_f32_16x16x32_bf16 v[176:179], v[24:27], v[8:11], v[176:179]
    ds_read_b128 v[32:35], v233 offset:33792
    v_mfma_f32_16x16x32_bf16 v[180:183], v[24:27], v[12:15], v[180:183]
    ds_read_b64_tr_b16 v[48:49], v235 offset:49152
    v_mfma_f32_16x16x32_bf16 v[184:187], v[24:27], v[16:19], v[184:187]
    ds_read_b64_tr_b16 v[50:51], v235 offset:57344
    v_mfma_f32_16x16x32_bf16 v[188:191], v[24:27], v[20:23], v[188:191]
    ds_read_b128 v[36:39], v233 offset:37888
    v_mfma_f32_16x16x32_bf16 v[204:207], v[28:31], v[20:23], v[204:207]
    ds_read_b128 v[40:43], v233 offset:41984
    v_mfma_f32_16x16x32_bf16 v[200:203], v[28:31], v[16:19], v[200:203]
    ds_read_b128 v[44:47], v233 offset:46080
    v_mfma_f32_16x16x32_bf16 v[196:199], v[28:31], v[12:15], v[196:199]
    ds_read_b64_tr_b16 v[52:53], v235 offset:50176
    v_mfma_f32_16x16x32_bf16 v[192:195], v[28:31], v[8:11], v[192:195]
    ds_read_b64_tr_b16 v[54:55], v235 offset:58368
    s_waitcnt lgkmcnt(0)
    v_mfma_f32_16x16x32_bf16 v[176:179], v[48:51], v[32:35], v[176:179]
    s_waitcnt vmcnt(6)
    s_barrier
    v_mfma_f32_16x16x32_bf16 v[180:183], v[48:51], v[36:39], v[180:183]
    ds_read_b128 v[8:11], v239 offset:0
    ds_read_b64_tr_b16 v[24:25], v241 offset:0
    v_mfma_f32_16x16x32_bf16 v[184:187], v[48:51], v[40:43], v[184:187]
    ds_read_b64_tr_b16 v[26:27], v241 offset:3072
    v_mfma_f32_16x16x32_bf16 v[188:191], v[48:51], v[44:47], v[188:191]
    ds_read_b128 v[12:15], v239 offset:3072
    v_mfma_f32_16x16x32_bf16 v[204:207], v[52:55], v[44:47], v[204:207]
    ds_read_b128 v[16:19], v239 offset:6144
    ds_read_b128 v[20:23], v239 offset:9216
    v_mfma_f32_16x16x32_bf16 v[200:203], v[52:55], v[40:43], v[200:203]
    s_add_u32 m0, s58, 131072
    s_nop 0
    buffer_load_dwordx4 v165, s[48:51], s57 offen sc1 lds
    v_mfma_f32_16x16x32_bf16 v[196:199], v[52:55], v[36:39], v[196:199]
    buffer_load_dwordx4 v165, s[48:51], s57 offen offset:1024 sc1 lds
    s_add_u32 s57, s57, 2048
    v_mfma_f32_16x16x32_bf16 v[192:195], v[52:55], v[32:35], v[192:195]
    s_add_u32 m0, s58, 133120
    s_nop 0
    buffer_load_dwordx4 v7, s[52:55], s56 offen lds
    s_add_u32 s56, s56, 131072
    s_nop 3
    buffer_store_dwordx4 v[192:195], v165, s[8:11], s31 offen offset:0 sc1
    buffer_store_dwordx4 v[196:199], v165, s[8:11], s31 offen offset:1024 sc1
    buffer_store_dwordx4 v[200:203], v165, s[8:11], s31 offen offset:2048 sc1
    buffer_store_dwordx4 v[204:207], v165, s[8:11], s31 offen offset:3072 sc1
    s_xor_b32 s31, s31, 32768
    s_waitcnt lgkmcnt(0)
    v_mfma_f32_16x16x32_bf16 v[56:59], v[24:27], v[8:11], v[56:59]
    ds_read_b128 v[28:31], v239 offset:1024
    ds_read_b64_tr_b16 v[44:45], v241 offset:12288
    v_mfma_f32_16x16x32_bf16 v[60:63], v[24:27], v[12:15], v[60:63]
    ds_read_b64_tr_b16 v[46:47], v241 offset:15360
    v_mfma_f32_16x16x32_bf16 v[64:67], v[24:27], v[16:19], v[64:67]
    ds_read_b128 v[32:35], v239 offset:4096
    ds_read_b128 v[36:39], v239 offset:7168
    v_mfma_f32_16x16x32_bf16 v[68:71], v[24:27], v[20:23], v[68:71]
    ds_read_b128 v[40:43], v239 offset:10240
    s_waitcnt lgkmcnt(0)
    v_mfma_f32_16x16x32_bf16 v[56:59], v[44:47], v[28:31], v[56:59]
    s_waitcnt vmcnt(10)
    s_barrier
    v_mfma_f32_16x16x32_bf16 v[60:63], v[44:47], v[32:35], v[60:63]
    ds_read_b128 v[8:11], v239 offset:32768
    ds_read_b64_tr_b16 v[24:25], v241 offset:32768
    ds_read_b64_tr_b16 v[26:27], v241 offset:35840
    v_mfma_f32_16x16x32_bf16 v[64:67], v[44:47], v[36:39], v[64:67]
    ds_read_b128 v[12:15], v239 offset:35840
    ds_read_b128 v[16:19], v239 offset:38912
    ds_read_b128 v[20:23], v239 offset:41984
    v_mfma_f32_16x16x32_bf16 v[68:71], v[44:47], v[40:43], v[68:71]
    s_add_u32 m0, s58, 32768
    s_nop 0
    buffer_load_dwordx4 v165, s[48:51], s57 offen sc1 lds
    buffer_load_dwordx4 v165, s[48:51], s57 offen offset:1024 sc1 lds
    s_add_u32 s57, s57, 2048
    s_add_u32 m0, s58, 34816
    s_nop 0
    buffer_load_dwordx4 v7, s[52:55], s56 offen lds
    s_add_u32 s56, s56, 131072
    ds_read_b64 v[88:89], v244 offset:0
    ds_read_b64 v[90:91], v244 offset:2048
    ds_read_b64 v[92:93], v244 offset:4096
    ds_read_b64 v[94:95], v244 offset:6144
    s_waitcnt lgkmcnt(0)
    v_mfma_f32_16x16x32_bf16 v[56:59], v[24:27], v[8:11], v[56:59]
    ds_read_b128 v[28:31], v239 offset:33792
    ds_read_b64_tr_b16 v[44:45], v241 offset:45056
    v_mfma_f32_16x16x32_bf16 v[60:63], v[24:27], v[12:15], v[60:63]
    ds_read_b64_tr_b16 v[46:47], v241 offset:48128
    v_mfma_f32_16x16x32_bf16 v[64:67], v[24:27], v[16:19], v[64:67]
    ds_read_b128 v[32:35], v239 offset:36864
    ds_read_b128 v[36:39], v239 offset:39936
    v_mfma_f32_16x16x32_bf16 v[68:71], v[24:27], v[20:23], v[68:71]
    ds_read_b128 v[40:43], v239 offset:43008
    s_waitcnt lgkmcnt(0)
    v_mfma_f32_16x16x32_bf16 v[56:59], v[44:47], v[28:31], v[56:59]
    s_waitcnt vmcnt(10)
    s_barrier
    v_mfma_f32_16x16x32_bf16 v[60:63], v[44:47], v[32:35], v[60:63]
    ds_read_b128 v[8:11], v240 offset:0
    ds_read_b64_tr_b16 v[24:25], v242 offset:0
    ds_read_b64_tr_b16 v[26:27], v242 offset:3072
    v_mfma_f32_16x16x32_bf16 v[64:67], v[44:47], v[36:39], v[64:67]
    ds_read_b128 v[12:15], v240 offset:3072
    ds_read_b128 v[16:19], v240 offset:6144
    ds_read_b128 v[20:23], v240 offset:9216
    v_mfma_f32_16x16x32_bf16 v[68:71], v[44:47], v[40:43], v[68:71]
    s_add_u32 m0, s58, 65536
    s_nop 0
    buffer_load_dwordx4 v165, s[48:51], s57 offen sc1 lds
    buffer_load_dwordx4 v165, s[48:51], s57 offen offset:1024 sc1 lds
    s_add_u32 s57, s57, 2048
    s_add_u32 m0, s58, 67584
    s_nop 0
    buffer_load_dwordx4 v7, s[52:55], s56 offen lds
    s_add_u32 s56, s56, 131072
    s_waitcnt lgkmcnt(0)
    v_mfma_f32_16x16x32_bf16 v[56:59], v[24:27], v[8:11], v[56:59]
    ds_read_b128 v[28:31], v240 offset:1024
    ds_read_b64_tr_b16 v[44:45], v242 offset:12288
    ds_read_b64_tr_b16 v[46:47], v242 offset:15360
    ds_read_b128 v[32:35], v240 offset:4096
    ds_read_b128 v[36:39], v240 offset:7168
    ds_read_b128 v[40:43], v240 offset:10240
    v_lshlrev_b32 v114, 16, v112
    v_and_b32 v115, 0xffff0000, v112
    v_lshlrev_b32 v116, 16, v113
    v_and_b32 v117, 0xffff0000, v113
    v_add_f32 v176, v176, v114
    v_mfma_f32_16x16x32_bf16 v[60:63], v[24:27], v[12:15], v[60:63]
    v_add_f32 v177, v177, v115
    v_add_f32 v178, v178, v116
    v_add_f32 v179, v179, v117
    v_lshlrev_b32 v96, 16, v88
    v_and_b32 v97, 0xffff0000, v88
    v_lshlrev_b32 v98, 16, v89
    v_and_b32 v99, 0xffff0000, v89
    v_add_f32 v180, v180, v114
    v_add_f32 v181, v181, v115
    v_add_f32 v182, v182, v116
    v_mfma_f32_16x16x32_bf16 v[64:67], v[24:27], v[16:19], v[64:67]
    v_add_f32 v183, v183, v117
    v_lshlrev_b32 v100, 16, v90
    v_and_b32 v101, 0xffff0000, v90
    v_lshlrev_b32 v102, 16, v91
    v_and_b32 v103, 0xffff0000, v91
    v_add_f32 v184, v184, v114
    v_add_f32 v185, v185, v115
    v_add_f32 v186, v186, v116
    v_add_f32 v187, v187, v117
    v_lshlrev_b32 v104, 16, v92
    v_and_b32 v105, 0xffff0000, v92
    v_mfma_f32_16x16x32_bf16 v[68:71], v[24:27], v[20:23], v[68:71]
    v_lshlrev_b32 v106, 16, v93
    v_and_b32 v107, 0xffff0000, v93
    v_add_f32 v188, v188, v114
    v_add_f32 v189, v189, v115
    v_add_f32 v190, v190, v116
    v_add_f32 v191, v191, v117
    v_lshlrev_b32 v108, 16, v94
    v_and_b32 v109, 0xffff0000, v94
    v_lshlrev_b32 v110, 16, v95
    v_and_b32 v111, 0xffff0000, v95
    s_waitcnt lgkmcnt(0)
    v_mfma_f32_16x16x32_bf16 v[56:59], v[44:47], v[28:31], v[56:59]
    s_waitcnt vmcnt(10)
    s_barrier
    v_mfma_f32_16x16x32_bf16 v[60:63], v[44:47], v[32:35], v[60:63]
    ds_read_b128 v[8:11], v240 offset:32768
    ds_read_b64_tr_b16 v[24:25], v242 offset:32768
    ds_read_b64_tr_b16 v[26:27], v242 offset:35840
    v_mfma_f32_16x16x32_bf16 v[64:67], v[44:47], v[36:39], v[64:67]
    ds_read_b128 v[12:15], v240 offset:35840
    ds_read_b128 v[16:19], v240 offset:38912
    ds_read_b128 v[20:23], v240 offset:41984
    v_mfma_f32_16x16x32_bf16 v[68:71], v[44:47], v[40:43], v[68:71]
    s_add_u32 m0, s58, 98304
    s_nop 0
    buffer_load_dwordx4 v165, s[48:51], s57 offen sc1 lds
    buffer_load_dwordx4 v165, s[48:51], s57 offen offset:1024 sc1 lds
    s_add_u32 s57, s57, 2048
    s_add_u32 m0, s58, 100352
    s_nop 0
    buffer_load_dwordx4 v7, s[52:55], s56 offen lds
    s_add_u32 s56, s56, 131072
    s_waitcnt lgkmcnt(0)
    v_mfma_f32_16x16x32_bf16 v[56:59], v[24:27], v[8:11], v[56:59]
    ds_read_b128 v[28:31], v240 offset:33792
    ds_read_b64_tr_b16 v[44:45], v242 offset:45056
    v_mfma_f32_16x16x32_bf16 v[60:63], v[24:27], v[12:15], v[60:63]
    ds_read_b64_tr_b16 v[46:47], v242 offset:48128
    v_mfma_f32_16x16x32_bf16 v[64:67], v[24:27], v[16:19], v[64:67]
    ds_read_b128 v[32:35], v240 offset:36864
    ds_read_b128 v[36:39], v240 offset:39936
    v_mfma_f32_16x16x32_bf16 v[68:71], v[24:27], v[20:23], v[68:71]
    ds_read_b128 v[40:43], v240 offset:43008
    s_waitcnt lgkmcnt(0)
    v_mfma_f32_16x16x32_bf16 v[56:59], v[44:47], v[28:31], v[56:59]
    s_waitcnt vmcnt(6)
    s_barrier
    v_mfma_f32_16x16x32_bf16 v[60:63], v[44:47], v[32:35], v[60:63]
    ds_read_b128 v[8:11], v239 offset:0
    ds_read_b64_tr_b16 v[24:25], v241 offset:0
    ds_read_b64_tr_b16 v[26:27], v241 offset:3072
    v_mfma_f32_16x16x32_bf16 v[64:67], v[44:47], v[36:39], v[64:67]
    ds_read_b128 v[12:15], v239 offset:3072
    ds_read_b128 v[16:19], v239 offset:6144
    ds_read_b128 v[20:23], v239 offset:9216
    v_mfma_f32_16x16x32_bf16 v[68:71], v[44:47], v[40:43], v[68:71]
    s_add_u32 m0, s58, 131072
    s_nop 0
    buffer_load_dwordx4 v165, s[48:51], s57 offen sc1 lds
    buffer_load_dwordx4 v165, s[48:51], s57 offen offset:1024 sc1 lds
    s_add_u32 s57, s57, 2048
    s_add_u32 m0, s58, 133120
    s_nop 0
    buffer_load_dwordx4 v7, s[52:55], s56 offen lds
    s_add_u32 s56, s56, 131072
    s_waitcnt lgkmcnt(0)
    v_mfma_f32_16x16x32_bf16 v[56:59], v[24:27], v[8:11], v[56:59]
    ds_read_b128 v[28:31], v239 offset:1024
    ds_read_b64_tr_b16 v[44:45], v241 offset:12288
    v_mfma_f32_16x16x32_bf16 v[60:63], v[24:27], v[12:15], v[60:63]
    ds_read_b64_tr_b16 v[46:47], v241 offset:15360
    v_mfma_f32_16x16x32_bf16 v[64:67], v[24:27], v[16:19], v[64:67]
    ds_read_b128 v[32:35], v239 offset:4096
    ds_read_b128 v[36:39], v239 offset:7168
    v_mfma_f32_16x16x32_bf16 v[68:71], v[24:27], v[20:23], v[68:71]
    ds_read_b128 v[40:43], v239 offset:10240
    s_waitcnt lgkmcnt(0)
    v_mfma_f32_16x16x32_bf16 v[56:59], v[44:47], v[28:31], v[56:59]
    s_waitcnt vmcnt(6)
    s_barrier
    v_mfma_f32_16x16x32_bf16 v[60:63], v[44:47], v[32:35], v[60:63]
    ds_read_b128 v[8:11], v239 offset:32768
    ds_read_b64_tr_b16 v[24:25], v241 offset:32768
    ds_read_b64_tr_b16 v[26:27], v241 offset:35840
    v_mfma_f32_16x16x32_bf16 v[64:67], v[44:47], v[36:39], v[64:67]
    ds_read_b128 v[12:15], v239 offset:35840
    ds_read_b128 v[16:19], v239 offset:38912
    ds_read_b128 v[20:23], v239 offset:41984
    v_mfma_f32_16x16x32_bf16 v[68:71], v[44:47], v[40:43], v[68:71]
    s_add_u32 m0, s58, 32768
    s_nop 0
    buffer_load_dwordx4 v165, s[48:51], s57 offen sc1 lds
    buffer_load_dwordx4 v165, s[48:51], s57 offen offset:1024 sc1 lds
    s_add_u32 s57, s57, 2048
    s_add_u32 m0, s58, 34816
    s_nop 0
    buffer_load_dwordx4 v7, s[52:55], s56 offen lds
    s_add_u32 s56, s56, 131072
    s_waitcnt lgkmcnt(0)
    v_mfma_f32_16x16x32_bf16 v[56:59], v[24:27], v[8:11], v[56:59]
    ds_read_b128 v[28:31], v239 offset:33792
    ds_read_b64_tr_b16 v[44:45], v241 offset:45056
    v_mfma_f32_16x16x32_bf16 v[60:63], v[24:27], v[12:15], v[60:63]
    ds_read_b64_tr_b16 v[46:47], v241 offset:48128
    v_mfma_f32_16x16x32_bf16 v[64:67], v[24:27], v[16:19], v[64:67]
    ds_read_b128 v[32:35], v239 offset:36864
    ds_read_b128 v[36:39], v239 offset:39936
    v_mfma_f32_16x16x32_bf16 v[68:71], v[24:27], v[20:23], v[68:71]
    ds_read_b128 v[40:43], v239 offset:43008
    s_waitcnt lgkmcnt(0)
    v_mfma_f32_16x16x32_bf16 v[56:59], v[44:47], v[28:31], v[56:59]
    s_waitcnt vmcnt(6)
    s_barrier
    v_mfma_f32_16x16x32_bf16 v[60:63], v[44:47], v[32:35], v[60:63]
    ds_read_b128 v[8:11], v240 offset:0
    ds_read_b64_tr_b16 v[24:25], v242 offset:0
    ds_read_b64_tr_b16 v[26:27], v242 offset:3072
    v_mfma_f32_16x16x32_bf16 v[64:67], v[44:47], v[36:39], v[64:67]
    ds_read_b128 v[12:15], v240 offset:3072
    ds_read_b128 v[16:19], v240 offset:6144
    ds_read_b128 v[20:23], v240 offset:9216
    v_mfma_f32_16x16x32_bf16 v[68:71], v[44:47], v[40:43], v[68:71]
    s_add_u32 m0, s58, 65536
    s_nop 0
    buffer_load_dwordx4 v165, s[48:51], s57 offen sc1 lds
    buffer_load_dwordx4 v165, s[48:51], s57 offen offset:1024 sc1 lds
    s_add_u32 s57, s57, 2048
    s_add_u32 m0, s58, 67584
    s_nop 0
    buffer_load_dwordx4 v7, s[52:55], s56 offen lds
    s_add_u32 s56, s56, 131072
    s_waitcnt lgkmcnt(0)
    v_mfma_f32_16x16x32_bf16 v[56:59], v[24:27], v[8:11], v[56:59]
    ds_read_b128 v[28:31], v240 offset:1024
    ds_read_b64_tr_b16 v[44:45], v242 offset:12288
    v_mfma_f32_16x16x32_bf16 v[60:63], v[24:27], v[12:15], v[60:63]
    ds_read_b64_tr_b16 v[46:47], v242 offset:15360
    v_mfma_f32_16x16x32_bf16 v[64:67], v[24:27], v[16:19], v[64:67]
    ds_read_b128 v[32:35], v240 offset:4096
    ds_read_b128 v[36:39], v240 offset:7168
    v_mfma_f32_16x16x32_bf16 v[68:71], v[24:27], v[20:23], v[68:71]
    ds_read_b128 v[40:43], v240 offset:10240
    s_waitcnt lgkmcnt(0)
    v_mfma_f32_16x16x32_bf16 v[56:59], v[44:47], v[28:31], v[56:59]
    s_waitcnt vmcnt(6)
    s_barrier
    v_mfma_f32_16x16x32_bf16 v[60:63], v[44:47], v[32:35], v[60:63]
    ds_read_b128 v[8:11], v240 offset:32768
    ds_read_b64_tr_b16 v[24:25], v242 offset:32768
    ds_read_b64_tr_b16 v[26:27], v242 offset:35840
    v_mfma_f32_16x16x32_bf16 v[64:67], v[44:47], v[36:39], v[64:67]
    ds_read_b128 v[12:15], v240 offset:35840
    ds_read_b128 v[16:19], v240 offset:38912
    ds_read_b128 v[20:23], v240 offset:41984
    v_mfma_f32_16x16x32_bf16 v[68:71], v[44:47], v[40:43], v[68:71]
    s_add_u32 m0, s58, 98304
    s_nop 0
    buffer_load_dwordx4 v165, s[48:51], s57 offen sc1 lds
    buffer_load_dwordx4 v165, s[48:51], s57 offen offset:1024 sc1 lds
    s_add_u32 s57, s57, 2048
    s_add_u32 m0, s58, 100352
    s_nop 0
    buffer_load_dwordx4 v7, s[52:55], s56 offen lds
    s_add_u32 s56, s56, 131072
    s_waitcnt vmcnt(21)
    s_mov_b64 exec, 1
    v_mov_b32 v2, 1
    buffer_store_dword v2, v175, s[60:63], s7 offen sc1
    s_mov_b64 exec, -1
    s_waitcnt lgkmcnt(0)
    v_mfma_f32_16x16x32_bf16 v[56:59], v[24:27], v[8:11], v[56:59]
    ds_read_b128 v[28:31], v240 offset:33792
    ds_read_b64_tr_b16 v[44:45], v242 offset:45056
    v_mfma_f32_16x16x32_bf16 v[60:63], v[24:27], v[12:15], v[60:63]
    ds_read_b64_tr_b16 v[46:47], v242 offset:48128
    v_mfma_f32_16x16x32_bf16 v[64:67], v[24:27], v[16:19], v[64:67]
    ds_read_b128 v[32:35], v240 offset:36864
    ds_read_b128 v[36:39], v240 offset:39936
    v_mfma_f32_16x16x32_bf16 v[68:71], v[24:27], v[20:23], v[68:71]
    ds_read_b128 v[40:43], v240 offset:43008
    s_waitcnt lgkmcnt(0)
    v_mfma_f32_16x16x32_bf16 v[56:59], v[44:47], v[28:31], v[56:59]
    s_waitcnt vmcnt(7)
    s_barrier
    v_mfma_f32_16x16x32_bf16 v[60:63], v[44:47], v[32:35], v[60:63]
    ds_read_b128 v[8:11], v239 offset:0
    ds_read_b64_tr_b16 v[24:25], v241 offset:0
    ds_read_b64_tr_b16 v[26:27], v241 offset:3072
    v_mfma_f32_16x16x32_bf16 v[64:67], v[44:47], v[36:39], v[64:67]
    ds_read_b128 v[12:15], v239 offset:3072
    ds_read_b128 v[16:19], v239 offset:6144
    ds_read_b128 v[20:23], v239 offset:9216
    v_mfma_f32_16x16x32_bf16 v[68:71], v[44:47], v[40:43], v[68:71]
    s_add_u32 m0, s58, 131072
    s_nop 0
    buffer_load_dwordx4 v165, s[48:51], s57 offen sc1 lds
    buffer_load_dwordx4 v165, s[48:51], s57 offen offset:1024 sc1 lds
    s_add_u32 s57, s57, 2048
    s_add_u32 m0, s58, 133120
    s_nop 0
    buffer_load_dwordx4 v7, s[52:55], s56 offen lds
    s_add_u32 s56, s56, 131072
    s_waitcnt lgkmcnt(0)
    v_mfma_f32_16x16x32_bf16 v[56:59], v[24:27], v[8:11], v[56:59]
    ds_read_b128 v[28:31], v239 offset:1024
    ds_read_b64_tr_b16 v[44:45], v241 offset:12288
    v_mfma_f32_16x16x32_bf16 v[60:63], v[24:27], v[12:15], v[60:63]
    ds_read_b64_tr_b16 v[46:47], v241 offset:15360
    v_mfma_f32_16x16x32_bf16 v[64:67], v[24:27], v[16:19], v[64:67]
    ds_read_b128 v[32:35], v239 offset:4096
    ds_read_b128 v[36:39], v239 offset:7168
    v_mfma_f32_16x16x32_bf16 v[68:71], v[24:27], v[20:23], v[68:71]
    ds_read_b128 v[40:43], v239 offset:10240
    s_waitcnt lgkmcnt(0)
    v_mfma_f32_16x16x32_bf16 v[56:59], v[44:47], v[28:31], v[56:59]
    s_waitcnt vmcnt(7)
    s_barrier
    v_mfma_f32_16x16x32_bf16 v[60:63], v[44:47], v[32:35], v[60:63]
    ds_read_b128 v[8:11], v239 offset:32768
    ds_read_b64_tr_b16 v[24:25], v241 offset:32768
    ds_read_b64_tr_b16 v[26:27], v241 offset:35840
    v_mfma_f32_16x16x32_bf16 v[64:67], v[44:47], v[36:39], v[64:67]
    ds_read_b128 v[12:15], v239 offset:35840
    ds_read_b128 v[16:19], v239 offset:38912
    ds_read_b128 v[20:23], v239 offset:41984
    v_mfma_f32_16x16x32_bf16 v[68:71], v[44:47], v[40:43], v[68:71]
    s_add_u32 m0, s58, 32768
    s_nop 0
    buffer_load_dwordx4 v165, s[48:51], s57 offen sc1 lds
    buffer_load_dwordx4 v165, s[48:51], s57 offen offset:1024 sc1 lds
    s_add_u32 s57, s57, 2048
    s_add_u32 m0, s58, 34816
    s_nop 0
    buffer_load_dwordx4 v7, s[52:55], s56 offen lds
    s_add_u32 s56, s56, 131072
    s_waitcnt lgkmcnt(0)
    v_mfma_f32_16x16x32_bf16 v[56:59], v[24:27], v[8:11], v[56:59]
    ds_read_b128 v[28:31], v239 offset:33792
    ds_read_b64_tr_b16 v[44:45], v241 offset:45056
    v_mfma_f32_16x16x32_bf16 v[60:63], v[24:27], v[12:15], v[60:63]
    ds_read_b64_tr_b16 v[46:47], v241 offset:48128
    v_mfma_f32_16x16x32_bf16 v[64:67], v[24:27], v[16:19], v[64:67]
    ds_read_b128 v[32:35], v239 offset:36864
    ds_read_b128 v[36:39], v239 offset:39936
    v_mfma_f32_16x16x32_bf16 v[68:71], v[24:27], v[20:23], v[68:71]
    ds_read_b128 v[40:43], v239 offset:43008
    s_waitcnt lgkmcnt(0)
    v_mfma_f32_16x16x32_bf16 v[56:59], v[44:47], v[28:31], v[56:59]
    s_waitcnt vmcnt(7)
    s_barrier
    v_mfma_f32_16x16x32_bf16 v[60:63], v[44:47], v[32:35], v[60:63]
    ds_read_b128 v[8:11], v240 offset:0
    ds_read_b64_tr_b16 v[24:25], v242 offset:0
    ds_read_b64_tr_b16 v[26:27], v242 offset:3072
    v_mfma_f32_16x16x32_bf16 v[64:67], v[44:47], v[36:39], v[64:67]
    ds_read_b128 v[12:15], v240 offset:3072
    ds_read_b128 v[16:19], v240 offset:6144
    ds_read_b128 v[20:23], v240 offset:9216
    v_mfma_f32_16x16x32_bf16 v[68:71], v[44:47], v[40:43], v[68:71]
    s_add_u32 m0, s58, 65536
    s_nop 0
    buffer_load_dwordx4 v165, s[48:51], s57 offen sc1 lds
    buffer_load_dwordx4 v165, s[48:51], s57 offen offset:1024 sc1 lds
    s_add_u32 s57, s57, 2048
    s_add_u32 m0, s58, 67584
    s_nop 0
    buffer_load_dwordx4 v7, s[52:55], s56 offen lds
    s_add_u32 s56, s56, 131072
    s_waitcnt lgkmcnt(0)
    v_mfma_f32_16x16x32_bf16 v[56:59], v[24:27], v[8:11], v[56:59]
    ds_read_b128 v[28:31], v240 offset:1024
    ds_read_b64_tr_b16 v[44:45], v242 offset:12288
    v_mfma_f32_16x16x32_bf16 v[60:63], v[24:27], v[12:15], v[60:63]
    ds_read_b64_tr_b16 v[46:47], v242 offset:15360
    v_mfma_f32_16x16x32_bf16 v[64:67], v[24:27], v[16:19], v[64:67]
    ds_read_b128 v[32:35], v240 offset:4096
    ds_read_b128 v[36:39], v240 offset:7168
    v_mfma_f32_16x16x32_bf16 v[68:71], v[24:27], v[20:23], v[68:71]
    ds_read_b128 v[40:43], v240 offset:10240
    s_waitcnt lgkmcnt(0)
    v_mfma_f32_16x16x32_bf16 v[56:59], v[44:47], v[28:31], v[56:59]
    s_waitcnt vmcnt(6)
    s_barrier
    v_mfma_f32_16x16x32_bf16 v[60:63], v[44:47], v[32:35], v[60:63]
    ds_read_b128 v[8:11], v240 offset:32768
    ds_read_b64_tr_b16 v[24:25], v242 offset:32768
    ds_read_b64_tr_b16 v[26:27], v242 offset:35840
    v_mfma_f32_16x16x32_bf16 v[64:67], v[44:47], v[36:39], v[64:67]
    ds_read_b128 v[12:15], v240 offset:35840
    ds_read_b128 v[16:19], v240 offset:38912
    ds_read_b128 v[20:23], v240 offset:41984
    v_mfma_f32_16x16x32_bf16 v[68:71], v[44:47], v[40:43], v[68:71]
    s_add_u32 m0, s58, 98304
    s_nop 0
    buffer_load_dwordx4 v165, s[48:51], s57 offen sc1 lds
    buffer_load_dwordx4 v165, s[48:51], s57 offen offset:1024 sc1 lds
    s_add_u32 s57, s57, 2048
    s_add_u32 m0, s58, 100352
    s_nop 0
    buffer_load_dwordx4 v7, s[52:55], s56 offen lds
    s_add_u32 s56, s56, 131072
    buffer_load_dword v174, v175, s[60:63], s30 offen sc1
    s_waitcnt lgkmcnt(0)
    v_mfma_f32_16x16x32_bf16 v[56:59], v[24:27], v[8:11], v[56:59]
    ds_read_b128 v[28:31], v240 offset:33792
    ds_read_b64_tr_b16 v[44:45], v242 offset:45056
    v_mfma_f32_16x16x32_bf16 v[60:63], v[24:27], v[12:15], v[60:63]
    ds_read_b64_tr_b16 v[46:47], v242 offset:48128
    v_mfma_f32_16x16x32_bf16 v[64:67], v[24:27], v[16:19], v[64:67]
    ds_read_b128 v[32:35], v240 offset:36864
    ds_read_b128 v[36:39], v240 offset:39936
    v_mfma_f32_16x16x32_bf16 v[68:71], v[24:27], v[20:23], v[68:71]
    ds_read_b128 v[40:43], v240 offset:43008
    s_waitcnt lgkmcnt(0)
    v_mfma_f32_16x16x32_bf16 v[56:59], v[44:47], v[28:31], v[56:59]
    s_waitcnt vmcnt(7)
    s_barrier
    v_mfma_f32_16x16x32_bf16 v[60:63], v[44:47], v[32:35], v[60:63]
    ds_read_b128 v[8:11], v239 offset:0
    ds_read_b64_tr_b16 v[24:25], v241 offset:0
    ds_read_b64_tr_b16 v[26:27], v241 offset:3072
    v_mfma_f32_16x16x32_bf16 v[64:67], v[44:47], v[36:39], v[64:67]
    ds_read_b128 v[12:15], v239 offset:3072
    ds_read_b128 v[16:19], v239 offset:6144
    ds_read_b128 v[20:23], v239 offset:9216
    v_mfma_f32_16x16x32_bf16 v[68:71], v[44:47], v[40:43], v[68:71]
    s_add_u32 m0, s58, 131072
    s_nop 0
    buffer_load_dwordx4 v165, s[48:51], s57 offen sc1 lds
    buffer_load_dwordx4 v165, s[48:51], s57 offen offset:1024 sc1 lds
    s_add_u32 s57, s57, 2048
    s_add_u32 m0, s58, 133120
    s_nop 0
    buffer_load_dwordx4 v7, s[52:55], s56 offen lds
    s_add_u32 s56, s56, 131072
    s_waitcnt lgkmcnt(0)
    v_mfma_f32_16x16x32_bf16 v[56:59], v[24:27], v[8:11], v[56:59]
    ds_read_b128 v[28:31], v239 offset:1024
    ds_read_b64_tr_b16 v[44:45], v241 offset:12288
    v_mfma_f32_16x16x32_bf16 v[60:63], v[24:27], v[12:15], v[60:63]
    ds_read_b64_tr_b16 v[46:47], v241 offset:15360
    v_mfma_f32_16x16x32_bf16 v[64:67], v[24:27], v[16:19], v[64:67]
    ds_read_b128 v[32:35], v239 offset:4096
    ds_read_b128 v[36:39], v239 offset:7168
    v_mfma_f32_16x16x32_bf16 v[68:71], v[24:27], v[20:23], v[68:71]
    ds_read_b128 v[40:43], v239 offset:10240
    s_waitcnt lgkmcnt(0)
    v_mfma_f32_16x16x32_bf16 v[56:59], v[44:47], v[28:31], v[56:59]
    s_waitcnt vmcnt(7)
    s_barrier
    v_mfma_f32_16x16x32_bf16 v[60:63], v[44:47], v[32:35], v[60:63]
    ds_read_b128 v[8:11], v239 offset:32768
    ds_read_b64_tr_b16 v[24:25], v241 offset:32768
    v_mfma_f32_16x16x32_bf16 v[64:67], v[44:47], v[36:39], v[64:67]
    ds_read_b64_tr_b16 v[26:27], v241 offset:35840
    ds_read_b128 v[12:15], v239 offset:35840
    v_mfma_f32_16x16x32_bf16 v[68:71], v[44:47], v[40:43], v[68:71]
    ds_read_b128 v[16:19], v239 offset:38912
    ds_read_b128 v[20:23], v239 offset:41984
    s_waitcnt vmcnt(3)
P3_x_chk:
    v_readfirstlane_b32 s23, v174
    s_nop 0
    s_cmp_ge_u32 s23, 1
    s_cbranch_scc1 P3_x_ok
    s_sleep 4
    buffer_load_dword v174, v175, s[60:63], s30 offen sc1
    s_waitcnt vmcnt(0)
    s_branch P3_x_chk
P3_x_ok:
    buffer_load_dwordx4 v[72:75], v165, s[8:11], s31 offen offset:0 sc1
    buffer_load_dwordx4 v[76:79], v165, s[8:11], s31 offen offset:1024 sc1
    buffer_load_dwordx4 v[80:83], v165, s[8:11], s31 offen offset:2048 sc1
    buffer_load_dwordx4 v[84:87], v165, s[8:11], s31 offen offset:3072 sc1
    s_waitcnt lgkmcnt(0)
    v_mfma_f32_16x16x32_bf16 v[56:59], v[24:27], v[8:11], v[56:59]
    ds_read_b128 v[28:31], v239 offset:33792
    ds_read_b64_tr_b16 v[44:45], v241 offset:45056
    v_mfma_f32_16x16x32_bf16 v[60:63], v[24:27], v[12:15], v[60:63]
    ds_read_b64_tr_b16 v[46:47], v241 offset:48128
    v_mfma_f32_16x16x32_bf16 v[64:67], v[24:27], v[16:19], v[64:67]
    ds_read_b128 v[32:35], v239 offset:36864
    ds_read_b128 v[36:39], v239 offset:39936
    v_mfma_f32_16x16x32_bf16 v[68:71], v[24:27], v[20:23], v[68:71]
    ds_read_b128 v[40:43], v239 offset:43008
    s_waitcnt lgkmcnt(0)
    v_mfma_f32_16x16x32_bf16 v[56:59], v[44:47], v[28:31], v[56:59]
    s_waitcnt vmcnt(8)
    s_barrier
    v_mfma_f32_16x16x32_bf16 v[60:63], v[44:47], v[32:35], v[60:63]
    ds_read_b128 v[8:11], v240 offset:0
    ds_read_b64_tr_b16 v[24:25], v242 offset:0
    v_mfma_f32_16x16x32_bf16 v[64:67], v[44:47], v[36:39], v[64:67]
    ds_read_b64_tr_b16 v[26:27], v242 offset:3072
    ds_read_b128 v[12:15], v240 offset:3072
    v_mfma_f32_16x16x32_bf16 v[68:71], v[44:47], v[40:43], v[68:71]
    ds_read_b128 v[16:19], v240 offset:6144
    ds_read_b128 v[20:23], v240 offset:9216
    s_waitcnt lgkmcnt(0)
    v_mfma_f32_16x16x32_bf16 v[56:59], v[24:27], v[8:11], v[56:59]
    ds_read_b128 v[28:31], v240 offset:1024
    ds_read_b64_tr_b16 v[44:45], v242 offset:12288
    v_mfma_f32_16x16x32_bf16 v[60:63], v[24:27], v[12:15], v[60:63]
    ds_read_b64_tr_b16 v[46:47], v242 offset:15360
    v_mfma_f32_16x16x32_bf16 v[64:67], v[24:27], v[16:19], v[64:67]
    ds_read_b128 v[32:35], v240 offset:4096
    ds_read_b128 v[36:39], v240 offset:7168
    v_mfma_f32_16x16x32_bf16 v[68:71], v[24:27], v[20:23], v[68:71]
    ds_read_b128 v[40:43], v240 offset:10240
    s_waitcnt lgkmcnt(0)
    v_mfma_f32_16x16x32_bf16 v[56:59], v[44:47], v[28:31], v[56:59]
    s_waitcnt vmcnt(4)
    s_barrier
    v_mfma_f32_16x16x32_bf16 v[60:63], v[44:47], v[32:35], v[60:63]
    ds_read_b128 v[8:11], v240 offset:32768
    ds_read_b64_tr_b16 v[24:25], v242 offset:32768
    v_mfma_f32_16x16x32_bf16 v[64:67], v[44:47], v[36:39], v[64:67]
    ds_read_b64_tr_b16 v[26:27], v242 offset:35840
    ds_read_b128 v[12:15], v240 offset:35840
    v_mfma_f32_16x16x32_bf16 v[68:71], v[44:47], v[40:43], v[68:71]
    ds_read_b128 v[16:19], v240 offset:38912
    ds_read_b128 v[20:23], v240 offset:41984
    s_waitcnt lgkmcnt(0)
    v_mfma_f32_16x16x32_bf16 v[56:59], v[24:27], v[8:11], v[56:59]
    ds_read_b128 v[28:31], v240 offset:33792
    ds_read_b64_tr_b16 v[44:45], v242 offset:45056
    v_mfma_f32_16x16x32_bf16 v[60:63], v[24:27], v[12:15], v[60:63]
    ds_read_b64_tr_b16 v[46:47], v242 offset:48128
    v_mfma_f32_16x16x32_bf16 v[64:67], v[24:27], v[16:19], v[64:67]
    ds_read_b128 v[32:35], v240 offset:36864
    ds_read_b128 v[36:39], v240 offset:39936
    v_mfma_f32_16x16x32_bf16 v[68:71], v[24:27], v[20:23], v[68:71]
    ds_read_b128 v[40:43], v240 offset:43008
    s_waitcnt lgkmcnt(0)
    v_mfma_f32_16x16x32_bf16 v[56:59], v[44:47], v[28:31], v[56:59]
    v_mfma_f32_16x16x32_bf16 v[60:63], v[44:47], v[32:35], v[60:63]
    v_mfma_f32_16x16x32_bf16 v[64:67], v[44:47], v[36:39], v[64:67]
    v_mfma_f32_16x16x32_bf16 v[68:71], v[44:47], v[40:43], v[68:71]
    s_waitcnt vmcnt(0)
    v_add_f32 v176, v176, v72
    v_add_f32 v177, v177, v73
    v_add_f32 v178, v178, v74
    v_add_f32 v179, v179, v75
    v_mul_f32 v72, s85, v176
    v_mul_f32 v73, s85, v177
    v_mul_f32 v74, s85, v178
    v_mul_f32 v75, s85, v179
    v_exp_f32 v72, v72
    v_exp_f32 v73, v73
    v_exp_f32 v74, v74
    v_exp_f32 v75, v75
    v_mul_f32 v176, v176, v56
    v_mul_f32 v177, v177, v57
    v_mul_f32 v178, v178, v58
    v_mul_f32 v179, v179, v59
    v_add_f32 v72, 1.0, v72
    v_add_f32 v73, 1.0, v73
    v_add_f32 v74, 1.0, v74
    v_add_f32 v75, 1.0, v75
    v_rcp_f32 v72, v72
    v_rcp_f32 v73, v73
    v_rcp_f32 v74, v74
    v_rcp_f32 v75, v75
    v_fma_f32 v176, v176, v72, v96
    v_fma_f32 v177, v177, v73, v97
    v_fma_f32 v178, v178, v74, v98
    v_fma_f32 v179, v179, v75, v99
    v_cvt_pk_bf16_f32 v88, v176, v177
    v_cvt_pk_bf16_f32 v89, v178, v179
    buffer_store_dwordx2 v[88:89], v243, s[68:71], s5 offen
    s_add_u32 s5, s5, 32768
    v_add_f32 v180, v180, v76
    v_add_f32 v181, v181, v77
    v_add_f32 v182, v182, v78
    v_add_f32 v183, v183, v79
    v_mul_f32 v76, s85, v180
    v_mul_f32 v77, s85, v181
    v_mul_f32 v78, s85, v182
    v_mul_f32 v79, s85, v183
    v_exp_f32 v76, v76
    v_exp_f32 v77, v77
    v_exp_f32 v78, v78
    v_exp_f32 v79, v79
    v_mul_f32 v180, v180, v60
    v_mul_f32 v181, v181, v61
    v_mul_f32 v182, v182, v62
    v_mul_f32 v183, v183, v63
    v_add_f32 v76, 1.0, v76
    v_add_f32 v77, 1.0, v77
    v_add_f32 v78, 1.0, v78
    v_add_f32 v79, 1.0, v79
    v_rcp_f32 v76, v76
    v_rcp_f32 v77, v77
    v_rcp_f32 v78, v78
    v_rcp_f32 v79, v79
    v_fma_f32 v180, v180, v76, v100
    v_fma_f32 v181, v181, v77, v101
    v_fma_f32 v182, v182, v78, v102
    v_fma_f32 v183, v183, v79, v103
    v_cvt_pk_bf16_f32 v90, v180, v181
    v_cvt_pk_bf16_f32 v91, v182, v183
    buffer_store_dwordx2 v[90:91], v243, s[68:71], s5 offen
    s_add_u32 s5, s5, 32768
    v_add_f32 v184, v184, v80
    v_add_f32 v185, v185, v81
    v_add_f32 v186, v186, v82
    v_add_f32 v187, v187, v83
    v_mul_f32 v80, s85, v184
    v_mul_f32 v81, s85, v185
    v_mul_f32 v82, s85, v186
    v_mul_f32 v83, s85, v187
    v_exp_f32 v80, v80
    v_exp_f32 v81, v81
    v_exp_f32 v82, v82
    v_exp_f32 v83, v83
    v_mul_f32 v184, v184, v64
    v_mul_f32 v185, v185, v65
    v_mul_f32 v186, v186, v66
    v_mul_f32 v187, v187, v67
    v_add_f32 v80, 1.0, v80
    v_add_f32 v81, 1.0, v81
    v_add_f32 v82, 1.0, v82
    v_add_f32 v83, 1.0, v83
    v_rcp_f32 v80, v80
    v_rcp_f32 v81, v81
    v_rcp_f32 v82, v82
    v_rcp_f32 v83, v83
    v_fma_f32 v184, v184, v80, v104
    v_fma_f32 v185, v185, v81, v105
    v_fma_f32 v186, v186, v82, v106
    v_fma_f32 v187, v187, v83, v107
    v_cvt_pk_bf16_f32 v92, v184, v185
    v_cvt_pk_bf16_f32 v93, v186, v187
    buffer_store_dwordx2 v[92:93], v243, s[68:71], s5 offen
    s_add_u32 s5, s5, 32768
    v_add_f32 v188, v188, v84
    v_add_f32 v189, v189, v85
    v_add_f32 v190, v190, v86
    v_add_f32 v191, v191, v87
    v_mul_f32 v84, s85, v188
    v_mul_f32 v85, s85, v189
    v_mul_f32 v86, s85, v190
    v_mul_f32 v87, s85, v191
    v_exp_f32 v84, v84
    v_exp_f32 v85, v85
    v_exp_f32 v86, v86
    v_exp_f32 v87, v87
    v_mul_f32 v188, v188, v68
    v_mul_f32 v189, v189, v69
    v_mul_f32 v190, v190, v70
    v_mul_f32 v191, v191, v71
    v_add_f32 v84, 1.0, v84
    v_add_f32 v85, 1.0, v85
    v_add_f32 v86, 1.0, v86
    v_add_f32 v87, 1.0, v87
    v_rcp_f32 v84, v84
    v_rcp_f32 v85, v85
    v_rcp_f32 v86, v86
    v_rcp_f32 v87, v87
    v_fma_f32 v188, v188, v84, v108
    v_fma_f32 v189, v189, v85, v109
    v_fma_f32 v190, v190, v86, v110
    v_fma_f32 v191, v191, v87, v111
    v_cvt_pk_bf16_f32 v94, v188, v189
    v_cvt_pk_bf16_f32 v95, v190, v191
    buffer_store_dwordx2 v[94:95], v243, s[68:71], s5 offen
MG_done:
    s_endpgm
MG_end:
.section .rodata,"a"
.p2align 6
.amdhsa_kernel ln_kernel
  .amdhsa_next_free_vgpr 66
  .amdhsa_next_free_sgpr 56
  .amdhsa_accum_offset 68
  .amdhsa_group_segment_fixed_size 0
  .amdhsa_kernarg_size 104
  .amdhsa_user_sgpr_count 2
  .amdhsa_user_sgpr_kernarg_segment_ptr 1
  .amdhsa_system_sgpr_workgroup_id_x 1
  .amdhsa_float_denorm_mode_32 3
.end_amdhsa_kernel
.p2align 6
.amdhsa_kernel mega_kernel
  .amdhsa_next_free_vgpr 256
  .amdhsa_next_free_sgpr 102
  .amdhsa_accum_offset 256
  .amdhsa_group_segment_fixed_size 0
  .amdhsa_kernarg_size 104
  .amdhsa_user_sgpr_count 2
  .amdhsa_user_sgpr_kernarg_segment_ptr 1
  .amdhsa_system_sgpr_workgroup_id_x 1
  .amdhsa_float_denorm_mode_32 3
.end_amdhsa_kernel
```
